```python
import torch

def _softmax(x, axis=-1):
    return torch.softmax(x, dim=axis)

def _gelu(x):
    return torch.nn.functional.gelu(x, approximate='tanh')

def _silu(x):
    return torch.nn.functional.silu(x)

def _sigmoid(x):
    return torch.sigmoid(x)

def _layernorm(x, axis=-1, eps=1e-05):
    m = x.mean(dim=axis, keepdim=True)
    v = x.var(dim=axis, keepdim=True, unbiased=False)
    return (x - m) / torch.sqrt(v + eps)

def _scatter_add(tgt, idx, src, axis=0):
    return tgt.clone().index_add_(axis, idx, src)

def _segment_sum(src, seg, n):
    out = torch.zeros((n,) + src.shape[1:], dtype=src.dtype)
    return out.index_add_(0, seg, src)

def _pad(x, pw):
    flat = tuple((v for pair in reversed(pw) for v in pair))
    return torch.nn.functional.pad(x, flat)
kernel_name = 'adaLN_cond__compressed_kv_cla__glu_gated_bilinear__prompt'

def setup_inputs():

    _w = lambda a: (lambda t: t.to(torch.bfloat16) if t.is_floating_point() else t)(torch.as_tensor(a))

    def _A_setup():
        B, H, Sq, Sk, D, M = (1, 32, 2048, 2048, 128, 512)
        Dc = 4 * D
        return {'x': _w((lambda *s: torch.randn(*s, dtype=torch.bfloat16) * 0.05)(B, Sq, M)), 'c_kv': _w((lambda *s: torch.randn(*s, dtype=torch.bfloat16) * 0.8)(B, Sk, Dc)), 'w_q': _w((lambda *s: torch.randn(*s, dtype=torch.bfloat16) * 1.6)(M, H, D) * M ** (-0.5)), 'w_uk': _w((lambda *s: torch.randn(*s, dtype=torch.bfloat16) * 1.6)(Dc, H, D) * Dc ** (-0.5)), 'w_uv': _w((lambda *s: torch.randn(*s, dtype=torch.bfloat16) * 0.8)(Dc, H, D) * Dc ** (-0.5)), 'w_o': _w((lambda *s: torch.randn(*s, dtype=torch.bfloat16) * 0.8)(H, D, M) * (H * D) ** (-0.5))}
    _A_in = _A_setup()

    def _B_setup():
        B, S, D, F = (1, 2048, 512, 1792)
        return {'x': _w((lambda *s: torch.randn(*s, dtype=torch.bfloat16) * 0.05)(B, S, D)), 'w_gate': _w((lambda *s: torch.randn(*s, dtype=torch.bfloat16) * 0.4)(D, F) * D ** (-0.5)), 'w_up': _w((lambda *s: torch.randn(*s, dtype=torch.bfloat16) * 0.4)(D, F) * D ** (-0.5)), 'w_down': _w((lambda *s: torch.randn(*s, dtype=torch.bfloat16) * 0.4)(F, D) * F ** (-0.5))}
    _B_in = _B_setup()
    return {'A_x': _A_in['x'], 'A_c_kv': _A_in['c_kv'], 'A_w_q': _A_in['w_q'], 'A_w_uk': _A_in['w_uk'], 'A_w_uv': _A_in['w_uv'], 'A_w_o': _A_in['w_o'], 'B_x': _B_in['x'], 'B_w_gate': _B_in['w_gate'], 'B_w_up': _B_in['w_up'], 'B_w_down': _B_in['w_down'], 'c': _w((lambda *s: torch.randn(*s, dtype=torch.bfloat16) * 0.2)(1, 512) * 8.0), 'w_mod': _w((lambda *s: torch.randn(*s, dtype=torch.bfloat16) * 0.2)(512, 6 * 512) * 512 ** (-0.5) * 8.0)}

def reference(A_x, A_c_kv, A_w_q, A_w_uk, A_w_uv, A_w_o, B_x, B_w_gate, B_w_up, B_w_down, c, w_mod):

    def _A_ref(x, c_kv, w_q, w_uk, w_uv, w_o):
        B, Sq, M = (x.shape[0], x.shape[1], x.shape[2])
        Sk = c_kv.shape[1]
        H, D = (w_q.shape[1], w_q.shape[2])
        q = torch.einsum('bqm,mhd->bhqd', x, w_q)
        k = torch.einsum('bkc,chd->bhkd', c_kv, w_uk)
        v = torch.einsum('bkc,chd->bhkd', c_kv, w_uv)
        scores = torch.einsum('bhqd,bhkd->bhqk', q, k) * D ** (-0.5)
        off = Sk - Sq
        qi = torch.arange(Sq)[:, None]
        kj = torch.arange(Sk)[None, :]
        cmask = kj <= qi + off
        scores = torch.where(cmask[None, None], scores, -1000000000.0)
        p = _softmax(scores, axis=-1)
        ctx = torch.einsum('bhqk,bhkd->bhqd', p, v)
        return torch.einsum('bhqd,hdm->bqm', ctx, w_o)

    def _B_ref(x, w_gate, w_up, w_down):
        g = torch.einsum('bsd,df->bsf', x, w_gate)
        u = torch.einsum('bsd,df->bsf', x, w_up)
        h = g * u
        return torch.einsum('bsf,fd->bsd', h, w_down)
    x = A_x
    mod = (_silu(c) @ w_mod).reshape(c.shape[0], 6, 1, -1)
    sa, ca, ga, sb, cb, gb = (mod[:, 0].clone(), mod[:, 1].clone(), mod[:, 2].clone(), mod[:, 3].clone(), mod[:, 4].clone(), mod[:, 5].clone())
    h = _layernorm(x, axis=-1) * (1 + ca) + sa
    x = x + ga * _A_ref(h, A_c_kv, A_w_q, A_w_uk, A_w_uv, A_w_o)
    h = _layernorm(x, axis=-1) * (1 + cb) + sb
    x = x + gb * _B_ref(h, B_w_gate, B_w_up, B_w_down)
    return x
```

```asm
; @launch kernel=prep_kernel grid=(352,1,1) block=(256,1,1) lds=8192
; @launch kernel=kv_kernel grid=(256,1,1) block=(512,1,1) lds=132096
; @launch kernel=attn_kernel grid=(256,1,1) block=(512,1,1) lds=163840
; @launch kernel=op_kernel grid=(256,1,1) block=(512,1,1) lds=131072
; @launch kernel=ln2_kernel grid=(256,1,1) block=(256,1,1) lds=512
; @launch kernel=gu_kernel grid=(224,1,1) block=(512,1,1) lds=122880
; @launch kernel=dn_kernel grid=(256,1,1) block=(256,1,1) lds=114688
.amdgcn_target "amdgcn-amd-amdhsa--gfx950"
.text
.globl prep_kernel
.p2align 8
.type prep_kernel,@function
prep_kernel:
    s_load_dwordx2 s[4:5], s[0:1], 8
    s_load_dwordx4 s[8:11], s[0:1], 80
    s_load_dwordx2 s[6:7], s[0:1], 112
    s_load_dwordx4 s[28:31], s[0:1], 24
    s_cmp_ge_u32 s2, 352
    s_cbranch_scc1 prep_end
    s_waitcnt lgkmcnt(0)
    s_cmp_ge_u32 s2, 96
    s_cbranch_scc1 prep_relayout
    s_mov_b32 s12, s8
    s_mov_b32 s13, s9
    s_mov_b32 s14, 1024
    s_mov_b32 s15, 0x00020000
    s_mov_b32 s16, s10
    s_mov_b32 s17, s11
    s_mov_b32 s18, 3145728
    s_mov_b32 s19, 0x00020000
    s_mov_b32 s20, s6
    s_mov_b32 s21, s7
    s_mov_b32 s22, 12288
    s_mov_b32 s23, 0x00020000
    v_lshrrev_b32 v1, 2, v0
    v_lshlrev_b32 v2, 4, v1
    buffer_load_dwordx4 v[4:7], v2, s[12:15], 0 offen
    v_mul_u32_u24 v2, 49152, v1
    v_and_b32 v3, 3, v0
    v_lshl_add_u32 v2, v3, 4, v2
    s_lshl_b32 s24, s2, 6
    buffer_load_dwordx4 v[32:35], v2, s[16:19], s24 offen
    s_add_u32 s24, s24, 6144
    buffer_load_dwordx4 v[36:39], v2, s[16:19], s24 offen
    s_add_u32 s24, s24, 6144
    buffer_load_dwordx4 v[40:43], v2, s[16:19], s24 offen
    s_add_u32 s24, s24, 6144
    buffer_load_dwordx4 v[44:47], v2, s[16:19], s24 offen
    s_add_u32 s24, s24, 6144
    buffer_load_dwordx4 v[48:51], v2, s[16:19], s24 offen
    s_add_u32 s24, s24, 6144
    buffer_load_dwordx4 v[52:55], v2, s[16:19], s24 offen
    s_add_u32 s24, s24, 6144
    buffer_load_dwordx4 v[56:59], v2, s[16:19], s24 offen
    s_add_u32 s24, s24, 6144
    buffer_load_dwordx4 v[60:63], v2, s[16:19], s24 offen
    s_add_u32 s24, s24, 6144
    s_waitcnt vmcnt(8)
    v_and_b32 v13, 0xffff0000, v4
    v_lshlrev_b32 v12, 16, v4
    v_and_b32 v15, 0xffff0000, v5
    v_lshlrev_b32 v14, 16, v5
    v_and_b32 v17, 0xffff0000, v6
    v_lshlrev_b32 v16, 16, v6
    v_and_b32 v19, 0xffff0000, v7
    v_lshlrev_b32 v18, 16, v7
    v_mul_f32 v28, 0xbfb8aa3b, v12
    v_exp_f32 v28, v28
    s_nop 0
    v_add_f32 v28, 1.0, v28
    v_rcp_f32 v28, v28
    s_nop 0
    v_mul_f32 v12, v12, v28
    v_cvt_pk_bf16_f32 v12, v12, v12
    v_lshlrev_b32 v12, 16, v12
    v_mul_f32 v28, 0xbfb8aa3b, v13
    v_exp_f32 v28, v28
    s_nop 0
    v_add_f32 v28, 1.0, v28
    v_rcp_f32 v28, v28
    s_nop 0
    v_mul_f32 v13, v13, v28
    v_cvt_pk_bf16_f32 v13, v13, v13
    v_lshlrev_b32 v13, 16, v13
    v_mul_f32 v28, 0xbfb8aa3b, v14
    v_exp_f32 v28, v28
    s_nop 0
    v_add_f32 v28, 1.0, v28
    v_rcp_f32 v28, v28
    s_nop 0
    v_mul_f32 v14, v14, v28
    v_cvt_pk_bf16_f32 v14, v14, v14
    v_lshlrev_b32 v14, 16, v14
    v_mul_f32 v28, 0xbfb8aa3b, v15
    v_exp_f32 v28, v28
    s_nop 0
    v_add_f32 v28, 1.0, v28
    v_rcp_f32 v28, v28
    s_nop 0
    v_mul_f32 v15, v15, v28
    v_cvt_pk_bf16_f32 v15, v15, v15
    v_lshlrev_b32 v15, 16, v15
    v_mul_f32 v28, 0xbfb8aa3b, v16
    v_exp_f32 v28, v28
    s_nop 0
    v_add_f32 v28, 1.0, v28
    v_rcp_f32 v28, v28
    s_nop 0
    v_mul_f32 v16, v16, v28
    v_cvt_pk_bf16_f32 v16, v16, v16
    v_lshlrev_b32 v16, 16, v16
    v_mul_f32 v28, 0xbfb8aa3b, v17
    v_exp_f32 v28, v28
    s_nop 0
    v_add_f32 v28, 1.0, v28
    v_rcp_f32 v28, v28
    s_nop 0
    v_mul_f32 v17, v17, v28
    v_cvt_pk_bf16_f32 v17, v17, v17
    v_lshlrev_b32 v17, 16, v17
    v_mul_f32 v28, 0xbfb8aa3b, v18
    v_exp_f32 v28, v28
    s_nop 0
    v_add_f32 v28, 1.0, v28
    v_rcp_f32 v28, v28
    s_nop 0
    v_mul_f32 v18, v18, v28
    v_cvt_pk_bf16_f32 v18, v18, v18
    v_lshlrev_b32 v18, 16, v18
    v_mul_f32 v28, 0xbfb8aa3b, v19
    v_exp_f32 v28, v28
    s_nop 0
    v_add_f32 v28, 1.0, v28
    v_rcp_f32 v28, v28
    s_nop 0
    v_mul_f32 v19, v19, v28
    v_cvt_pk_bf16_f32 v19, v19, v19
    v_lshlrev_b32 v19, 16, v19
    v_mov_b32 v4, 0
    v_mov_b32 v5, 0
    v_mov_b32 v6, 0
    v_mov_b32 v7, 0
    v_mov_b32 v8, 0
    v_mov_b32 v9, 0
    v_mov_b32 v10, 0
    v_mov_b32 v11, 0
    s_waitcnt vmcnt(7)
    v_and_b32 v29, 0xffff0000, v32
    v_lshlrev_b32 v28, 16, v32
    v_fmac_f32 v4, v28, v12
    v_fmac_f32 v5, v29, v12
    v_and_b32 v29, 0xffff0000, v33
    v_lshlrev_b32 v28, 16, v33
    v_fmac_f32 v6, v28, v12
    v_fmac_f32 v7, v29, v12
    v_and_b32 v29, 0xffff0000, v34
    v_lshlrev_b32 v28, 16, v34
    v_fmac_f32 v8, v28, v12
    v_fmac_f32 v9, v29, v12
    v_and_b32 v29, 0xffff0000, v35
    v_lshlrev_b32 v28, 16, v35
    v_fmac_f32 v10, v28, v12
    v_fmac_f32 v11, v29, v12
    s_waitcnt vmcnt(6)
    v_and_b32 v29, 0xffff0000, v36
    v_lshlrev_b32 v28, 16, v36
    v_fmac_f32 v4, v28, v13
    v_fmac_f32 v5, v29, v13
    v_and_b32 v29, 0xffff0000, v37
    v_lshlrev_b32 v28, 16, v37
    v_fmac_f32 v6, v28, v13
    v_fmac_f32 v7, v29, v13
    v_and_b32 v29, 0xffff0000, v38
    v_lshlrev_b32 v28, 16, v38
    v_fmac_f32 v8, v28, v13
    v_fmac_f32 v9, v29, v13
    v_and_b32 v29, 0xffff0000, v39
    v_lshlrev_b32 v28, 16, v39
    v_fmac_f32 v10, v28, v13
    v_fmac_f32 v11, v29, v13
    s_waitcnt vmcnt(5)
    v_and_b32 v29, 0xffff0000, v40
    v_lshlrev_b32 v28, 16, v40
    v_fmac_f32 v4, v28, v14
    v_fmac_f32 v5, v29, v14
    v_and_b32 v29, 0xffff0000, v41
    v_lshlrev_b32 v28, 16, v41
    v_fmac_f32 v6, v28, v14
    v_fmac_f32 v7, v29, v14
    v_and_b32 v29, 0xffff0000, v42
    v_lshlrev_b32 v28, 16, v42
    v_fmac_f32 v8, v28, v14
    v_fmac_f32 v9, v29, v14
    v_and_b32 v29, 0xffff0000, v43
    v_lshlrev_b32 v28, 16, v43
    v_fmac_f32 v10, v28, v14
    v_fmac_f32 v11, v29, v14
    s_waitcnt vmcnt(4)
    v_and_b32 v29, 0xffff0000, v44
    v_lshlrev_b32 v28, 16, v44
    v_fmac_f32 v4, v28, v15
    v_fmac_f32 v5, v29, v15
    v_and_b32 v29, 0xffff0000, v45
    v_lshlrev_b32 v28, 16, v45
    v_fmac_f32 v6, v28, v15
    v_fmac_f32 v7, v29, v15
    v_and_b32 v29, 0xffff0000, v46
    v_lshlrev_b32 v28, 16, v46
    v_fmac_f32 v8, v28, v15
    v_fmac_f32 v9, v29, v15
    v_and_b32 v29, 0xffff0000, v47
    v_lshlrev_b32 v28, 16, v47
    v_fmac_f32 v10, v28, v15
    v_fmac_f32 v11, v29, v15
    s_waitcnt vmcnt(3)
    v_and_b32 v29, 0xffff0000, v48
    v_lshlrev_b32 v28, 16, v48
    v_fmac_f32 v4, v28, v16
    v_fmac_f32 v5, v29, v16
    v_and_b32 v29, 0xffff0000, v49
    v_lshlrev_b32 v28, 16, v49
    v_fmac_f32 v6, v28, v16
    v_fmac_f32 v7, v29, v16
    v_and_b32 v29, 0xffff0000, v50
    v_lshlrev_b32 v28, 16, v50
    v_fmac_f32 v8, v28, v16
    v_fmac_f32 v9, v29, v16
    v_and_b32 v29, 0xffff0000, v51
    v_lshlrev_b32 v28, 16, v51
    v_fmac_f32 v10, v28, v16
    v_fmac_f32 v11, v29, v16
    s_waitcnt vmcnt(2)
    v_and_b32 v29, 0xffff0000, v52
    v_lshlrev_b32 v28, 16, v52
    v_fmac_f32 v4, v28, v17
    v_fmac_f32 v5, v29, v17
    v_and_b32 v29, 0xffff0000, v53
    v_lshlrev_b32 v28, 16, v53
    v_fmac_f32 v6, v28, v17
    v_fmac_f32 v7, v29, v17
    v_and_b32 v29, 0xffff0000, v54
    v_lshlrev_b32 v28, 16, v54
    v_fmac_f32 v8, v28, v17
    v_fmac_f32 v9, v29, v17
    v_and_b32 v29, 0xffff0000, v55
    v_lshlrev_b32 v28, 16, v55
    v_fmac_f32 v10, v28, v17
    v_fmac_f32 v11, v29, v17
    s_waitcnt vmcnt(1)
    v_and_b32 v29, 0xffff0000, v56
    v_lshlrev_b32 v28, 16, v56
    v_fmac_f32 v4, v28, v18
    v_fmac_f32 v5, v29, v18
    v_and_b32 v29, 0xffff0000, v57
    v_lshlrev_b32 v28, 16, v57
    v_fmac_f32 v6, v28, v18
    v_fmac_f32 v7, v29, v18
    v_and_b32 v29, 0xffff0000, v58
    v_lshlrev_b32 v28, 16, v58
    v_fmac_f32 v8, v28, v18
    v_fmac_f32 v9, v29, v18
    v_and_b32 v29, 0xffff0000, v59
    v_lshlrev_b32 v28, 16, v59
    v_fmac_f32 v10, v28, v18
    v_fmac_f32 v11, v29, v18
    s_waitcnt vmcnt(0)
    v_and_b32 v29, 0xffff0000, v60
    v_lshlrev_b32 v28, 16, v60
    v_fmac_f32 v4, v28, v19
    v_fmac_f32 v5, v29, v19
    v_and_b32 v29, 0xffff0000, v61
    v_lshlrev_b32 v28, 16, v61
    v_fmac_f32 v6, v28, v19
    v_fmac_f32 v7, v29, v19
    v_and_b32 v29, 0xffff0000, v62
    v_lshlrev_b32 v28, 16, v62
    v_fmac_f32 v8, v28, v19
    v_fmac_f32 v9, v29, v19
    v_and_b32 v29, 0xffff0000, v63
    v_lshlrev_b32 v28, 16, v63
    v_fmac_f32 v10, v28, v19
    v_fmac_f32 v11, v29, v19
    v_lshlrev_b32 v2, 5, v0
    ds_write_b128 v2, v[4:7]
    ds_write_b128 v2, v[8:11] offset:16
    v_readfirstlane_b32 s26, v0
    s_waitcnt lgkmcnt(0)
    s_barrier
    s_cmp_lg_u32 s26, 0
    s_cbranch_scc1 prep_end
    v_and_b32 v2, 31, v0
    v_lshlrev_b32 v2, 2, v2
    v_lshrrev_b32 v3, 5, v0
    v_lshl_add_u32 v3, v3, 12, v2
    ds_read2_b32 v[32:33], v3 offset0:0 offset1:32
    ds_read2_b32 v[34:35], v3 offset0:64 offset1:96
    ds_read2_b32 v[36:37], v3 offset0:128 offset1:160
    ds_read2_b32 v[38:39], v3 offset0:192 offset1:224
    v_add_u32 v3, 1024, v3
    ds_read2_b32 v[40:41], v3 offset0:0 offset1:32
    ds_read2_b32 v[42:43], v3 offset0:64 offset1:96
    ds_read2_b32 v[44:45], v3 offset0:128 offset1:160
    ds_read2_b32 v[46:47], v3 offset0:192 offset1:224
    v_add_u32 v3, 1024, v3
    s_waitcnt lgkmcnt(0)
    ds_read2_b32 v[48:49], v3 offset0:0 offset1:32
    ds_read2_b32 v[50:51], v3 offset0:64 offset1:96
    ds_read2_b32 v[52:53], v3 offset0:128 offset1:160
    ds_read2_b32 v[54:55], v3 offset0:192 offset1:224
    v_add_u32 v3, 1024, v3
    ds_read2_b32 v[56:57], v3 offset0:0 offset1:32
    ds_read2_b32 v[58:59], v3 offset0:64 offset1:96
    ds_read2_b32 v[60:61], v3 offset0:128 offset1:160
    ds_read2_b32 v[62:63], v3 offset0:192 offset1:224
    v_add_u32 v3, 1024, v3
    s_waitcnt lgkmcnt(0)
    v_add_f32 v32, v32, v34
    v_add_f32 v33, v33, v35
    v_add_f32 v32, v32, v36
    v_add_f32 v33, v33, v37
    v_add_f32 v32, v32, v38
    v_add_f32 v33, v33, v39
    v_add_f32 v32, v32, v40
    v_add_f32 v33, v33, v41
    v_add_f32 v32, v32, v42
    v_add_f32 v33, v33, v43
    v_add_f32 v32, v32, v44
    v_add_f32 v33, v33, v45
    v_add_f32 v32, v32, v46
    v_add_f32 v33, v33, v47
    v_add_f32 v32, v32, v48
    v_add_f32 v33, v33, v49
    v_add_f32 v32, v32, v50
    v_add_f32 v33, v33, v51
    v_add_f32 v32, v32, v52
    v_add_f32 v33, v33, v53
    v_add_f32 v32, v32, v54
    v_add_f32 v33, v33, v55
    v_add_f32 v32, v32, v56
    v_add_f32 v33, v33, v57
    v_add_f32 v32, v32, v58
    v_add_f32 v33, v33, v59
    v_add_f32 v32, v32, v60
    v_add_f32 v33, v33, v61
    v_add_f32 v32, v32, v62
    v_add_f32 v33, v33, v63
    v_add_f32 v32, v32, v33
    v_mov_b32 v33, v32
    s_nop 1
    v_permlane32_swap_b32 v33, v32
    s_nop 1
    v_add_f32 v32, v32, v33
    v_cvt_pk_bf16_f32 v32, v32, v32
    v_lshlrev_b32 v32, 16, v32
    s_lshr_b32 s24, s2, 4
    s_cmp_eq_u32 s24, 1
    s_cselect_b32 s25, 1.0, 0
    s_cmp_eq_u32 s24, 4
    s_cselect_b32 s25, 1.0, s25
    v_add_f32 v32, s25, v32
    v_cvt_pk_bf16_f32 v32, v32, v32
    v_lshlrev_b32 v32, 16, v32
    s_lshl_b32 s24, s2, 7
    buffer_store_dword v32, v2, s[20:23], s24 offen
    s_endpgm
prep_relayout:
    s_mov_b32 s12, s4
    s_mov_b32 s13, s5
    s_mov_b32 s14, 2097152
    s_mov_b32 s15, 0x00020000
    s_add_u32 s16, s6, 1048576
    s_addc_u32 s17, s7, 0
    s_mov_b32 s18, 2097152
    s_mov_b32 s19, 0x00020000
    s_sub_u32 s2, s2, 96
    v_and_b32 v1, 7, v0
    v_bfe_u32 v2, v0, 3, 1
    v_lshrrev_b32 v3, 4, v0
    v_lshlrev_b32 v4, 10, v1
    v_lshl_add_u32 v4, v2, 3, v4
    v_lshl_add_u32 v4, v3, 5, v4
    s_lshl_b32 s24, s2, 13
    buffer_load_dwordx2 v[8:9], v4, s[12:15], s24 offen
    buffer_load_dwordx2 v[10:11], v4, s[12:15], s24 offen offset:16
    buffer_load_dwordx2 v[12:13], v4, s[12:15], s24 offen offset:512
    buffer_load_dwordx2 v[14:15], v4, s[12:15], s24 offen offset:528
    v_lshlrev_b32 v5, 4, v1
    v_lshl_add_u32 v5, v2, 9, v5
    v_lshl_add_u32 v5, v3, 10, v5
    v_add_u32 v6, 0x4000, v5
    s_lshr_b32 s25, s2, 2
    s_lshl_b32 s25, s25, 15
    s_and_b32 s26, s2, 3
    s_lshl_b32 s26, s26, 7
    s_add_u32 s25, s25, s26
    s_mov_b32 s32, s28
    s_mov_b32 s33, s29
    s_mov_b32 s34, 4194304
    s_mov_b32 s35, 0x00020000
    s_mov_b32 s36, s30
    s_mov_b32 s37, s31
    s_mov_b32 s38, 4194304
    s_mov_b32 s39, 0x00020000
    v_lshlrev_b32 v1, 4, v0
    s_mul_i32 s24, s2, 8192
    buffer_load_dwordx4 v[16:19], v1, s[32:35], s24 offen
    buffer_load_dwordx4 v[20:23], v1, s[36:39], s24 offen
    s_add_u32 s24, s24, 4096
    buffer_load_dwordx4 v[16:19], v1, s[32:35], s24 offen
    buffer_load_dwordx4 v[20:23], v1, s[36:39], s24 offen
    s_add_u32 s24, s24, 4096
    s_waitcnt vmcnt(4)
    buffer_store_dwordx4 v[8:11], v5, s[16:19], s25 offen sc0 sc1
    buffer_store_dwordx4 v[12:15], v6, s[16:19], s25 offen sc0 sc1
    s_waitcnt vmcnt(0)
prep_end:
    s_endpgm
.text
.globl kv_kernel
.p2align 8
.type kv_kernel,@function
kv_kernel:
    s_load_dwordx2 s[4:5], s[0:1], 0
    s_load_dwordx4 s[8:11], s[0:1], 24
    s_load_dwordx2 s[56:57], s[0:1], 16
    s_load_dwordx2 s[6:7], s[0:1], 112
    s_cmp_ge_u32 s2, 256
    s_cbranch_scc1 kv_end
    s_and_b32 s33, s2, 7
    s_lshl_b32 s33, s33, 1
    s_bfe_u32 s34, s2, 0x10003
    s_add_u32 s33, s33, s34
    s_and_b32 s34, s2, 16
    s_add_u32 s33, s33, s34
    s_lshr_b32 s34, s2, 5
    v_and_b32 v1, 63, v0
    v_lshrrev_b32 v2, 6, v0
    s_nop 0
    v_readfirstlane_b32 s40, v2
    v_lshrrev_b32 v8, 3, v1
    v_and_b32 v9, 7, v1
    v_bfe_u32 v10, v1, 4, 1
    v_lshrrev_b32 v11, 2, v9
    v_xor_b32 v10, v10, v11
    v_and_b32 v9, 3, v9
    v_mul_u32_u24 v8, 8192, v8
    v_lshl_add_u32 v8, v10, 6, v8
    v_lshl_add_u32 v8, v9, 4, v8
    s_lshr_b32 s41, s40, 2
    s_and_b32 s42, s40, 3
    v_lshrrev_b32 v4, 5, v1
    v_lshlrev_b32 v4, 9, v4
    v_bfe_u32 v5, v1, 2, 2
    v_lshl_add_u32 v4, v5, 7, v4
    v_bfe_u32 v5, v1, 4, 1
    v_lshl_add_u32 v4, v5, 5, v4
    v_and_b32 v5, 3, v1
    v_lshl_add_u32 v4, v5, 3, v4
    v_bfe_u32 v5, v1, 3, 1
    v_lshl_add_u32 v4, v5, 6, v4
    v_lshlrev_b32 v1, 4, v1
    s_mul_i32 s43, s41, 8192
    s_add_u32 s43, s43, 0
    v_add_u32 v2, s43, v1
    v_add_u32 v3, 0x10000, v2
    v_add_u32 v4, 0, v4
    s_mul_i32 s43, s42, 4096
    v_add_u32 v4, s43, v4
    v_xor_b32 v6, 64, v4
    v_add_u32 v5, 0x10000, v4
    v_add_u32 v7, 0x10000, v6
    v_add_u32 v9, 64512, v8
    s_mul_i32 s44, s40, 2048
    s_mul_i32 s45, s40, 2048
    s_add_u32 s45, s45, 16384
    s_add_u32 s44, s44, 0
    s_waitcnt lgkmcnt(0)
    s_cmp_ge_u32 s33, 16
    s_cselect_b32 s8, s10, s8
    s_cselect_b32 s9, s11, s9
    s_and_b32 s35, s33, 15
    s_add_u32 s12, s6, 1048576
    s_addc_u32 s13, s7, 0
    s_mov_b32 s14, 2097152
    s_mov_b32 s15, 0x00020000
    s_mov_b32 s16, s8
    s_mov_b32 s17, s9
    s_mov_b32 s18, 4194304
    s_mov_b32 s19, 0x00020000
    s_mov_b32 s20, s4
    s_mov_b32 s21, s5
    s_mov_b32 s22, 2097152
    s_mov_b32 s23, 0x00020000
    s_mov_b32 s24, s6
    s_mov_b32 s25, s7
    s_mov_b32 s26, 12288
    s_mov_b32 s27, 0x00020000
    s_add_u32 s28, s6, 3145728
    s_addc_u32 s29, s7, 0
    s_mov_b32 s30, 2097152
    s_mov_b32 s31, 0x00020000
    s_lshl_b32 s46, s34, 3
    s_add_u32 s46, s46, s40
    s_lshl_b32 s46, s46, 15
    s_lshr_b32 s47, s40, 1
    s_lshl_b32 s47, s47, 7
    s_and_b32 s36, s40, 1
    s_lshl_b32 s36, s36, 17
    s_add_u32 s47, s47, s36
    s_lshl_b32 s36, s35, 9
    s_add_u32 s47, s47, s36
    s_mov_b32 s64, 0
    s_mov_b32 s62, s46
    s_mov_b32 s63, s47
    s_add_u32 s60, s46, 32768
    s_add_u32 s61, s47, 4194304
    s_mul_i32 s65, s64, 2048
    s_add_u32 s46, s46, s65
    s_mul_i32 s65, s64, 262144
    s_add_u32 s47, s47, s65
    s_add_u32 m0, s44, 1024
    s_nop 0
    buffer_load_dwordx4 v1, s[12:15], s46 offen offset:0 lds
    buffer_load_dwordx4 v1, s[12:15], s46 offen offset:1024 lds
    s_add_u32 s46, s46, 2048
    s_cmp_eq_u32 s46, s60
    s_cselect_b32 s46, s62, s46
    s_add_u32 m0, s45, 1024
    s_nop 0
    buffer_load_dwordx4 v8, s[16:19], s47 offen offset:0 lds
    buffer_load_dwordx4 v9, s[16:19], s47 offen offset:1024 lds
    s_add_u32 s47, s47, 262144
    s_cmp_eq_u32 s47, s61
    s_cselect_b32 s47, s63, s47
    s_add_u32 m0, s44, 33792
    s_nop 0
    buffer_load_dwordx4 v1, s[12:15], s46 offen offset:0 lds
    buffer_load_dwordx4 v1, s[12:15], s46 offen offset:1024 lds
    s_add_u32 s46, s46, 2048
    s_cmp_eq_u32 s46, s60
    s_cselect_b32 s46, s62, s46
    s_add_u32 m0, s45, 33792
    s_nop 0
    buffer_load_dwordx4 v8, s[16:19], s47 offen offset:0 lds
    buffer_load_dwordx4 v9, s[16:19], s47 offen offset:1024 lds
    s_add_u32 s47, s47, 262144
    s_cmp_eq_u32 s47, s61
    s_cselect_b32 s47, s63, s47
    s_add_u32 m0, s44, 66560
    s_nop 0
    buffer_load_dwordx4 v1, s[12:15], s46 offen offset:0 lds
    buffer_load_dwordx4 v1, s[12:15], s46 offen offset:1024 lds
    s_add_u32 s46, s46, 2048
    s_cmp_eq_u32 s46, s60
    s_cselect_b32 s46, s62, s46
    s_add_u32 m0, s45, 66560
    s_nop 0
    buffer_load_dwordx4 v8, s[16:19], s47 offen offset:0 lds
    buffer_load_dwordx4 v9, s[16:19], s47 offen offset:1024 lds
    s_add_u32 s47, s47, 262144
    s_cmp_eq_u32 s47, s61
    s_cselect_b32 s47, s63, s47
    s_add_u32 m0, s44, 99328
    s_nop 0
    buffer_load_dwordx4 v1, s[12:15], s46 offen offset:0 lds
    buffer_load_dwordx4 v1, s[12:15], s46 offen offset:1024 lds
    s_add_u32 s46, s46, 2048
    s_cmp_eq_u32 s46, s60
    s_cselect_b32 s46, s62, s46
    s_add_u32 m0, s45, 99328
    s_nop 0
    buffer_load_dwordx4 v8, s[16:19], s47 offen offset:0 lds
    buffer_load_dwordx4 v9, s[16:19], s47 offen offset:1024 lds
    s_add_u32 s47, s47, 262144
    s_cmp_eq_u32 s47, s61
    s_cselect_b32 s47, s63, s47
    v_and_b32 v188, 7, v0
    v_bfe_u32 v189, v0, 3, 1
    v_lshrrev_b32 v190, 4, v0
    v_lshlrev_b32 v192, 10, v188
    v_lshl_add_u32 v192, v189, 3, v192
    v_lshl_add_u32 v192, v190, 5, v192
    s_lshl_b32 s38, s2, 13
    s_mov_b32 s58, 0x400000
    s_mov_b32 s59, 0x00020000
    s_lshl_b32 s66, s2, 14
    s_lshl_b32 s67, s40, 11
    s_add_u32 s66, s66, s67
    v_lshlrev_b32 v193, 4, v189
    v_lshl_add_u32 v193, v190, 6, v193
    v_lshlrev_b32 v191, 4, v188
    v_lshl_add_u32 v191, v189, 9, v191
    v_lshl_add_u32 v191, v190, 10, v191
    s_lshr_b32 s39, s2, 2
    s_lshl_b32 s39, s39, 15
    s_and_b32 s37, s2, 3
    s_lshl_b32 s37, s37, 7
    s_add_u32 s39, s39, s37
    s_lshl_b32 s36, s35, 1
    s_lshr_b32 s37, s42, 1
    s_add_u32 s36, s36, s37
    s_lshl_b32 s36, s36, 19
    s_lshl_b32 s37, s34, 16
    s_add_u32 s36, s36, s37
    s_lshl_b32 s37, s41, 15
    s_add_u32 s36, s36, s37
    s_and_b32 s37, s42, 1
    s_cmp_ge_u32 s33, 16
    s_cbranch_scc1 kv_v
    s_lshl_b32 s37, s37, 12
    s_add_u32 s36, s36, s37
    s_add_u32 s52, s6, 16777216
    s_addc_u32 s53, s7, 0
    s_mov_b32 s54, 16777216
    s_mov_b32 s55, 0x00020000
    s_waitcnt vmcnt(12)
    s_barrier
    ds_read_b64_tr_b16 v[28:29], v4 offset:17408
    ds_read_b64_tr_b16 v[30:31], v4 offset:18432
    ds_read_b128 v[12:15], v2 offset:1024
    ds_read_b64_tr_b16 v[32:33], v6 offset:17408
    ds_read_b64_tr_b16 v[34:35], v6 offset:18432
    ds_read_b128 v[16:19], v2 offset:3072
    ds_read_b128 v[20:23], v2 offset:5120
    ds_read_b128 v[24:27], v2 offset:7168
    ds_read_b64_tr_b16 v[52:53], v4 offset:19456
    ds_read_b64_tr_b16 v[54:55], v4 offset:20480
    ds_read_b128 v[36:39], v2 offset:2048
    ds_read_b64_tr_b16 v[56:57], v6 offset:19456
    ds_read_b64_tr_b16 v[58:59], v6 offset:20480
    ds_read_b128 v[40:43], v2 offset:4096
    ds_read_b128 v[44:47], v2 offset:6144
    ds_read_b128 v[48:51], v2 offset:8192
    s_waitcnt lgkmcnt(8)
    v_mfma_f32_32x32x16_bf16 v[60:75], v[28:31], v[12:15], 0
    v_mfma_f32_32x32x16_bf16 v[76:91], v[32:35], v[12:15], 0
    v_mfma_f32_32x32x16_bf16 v[92:107], v[28:31], v[16:19], 0
    v_mfma_f32_32x32x16_bf16 v[108:123], v[32:35], v[16:19], 0
    v_mfma_f32_32x32x16_bf16 v[124:139], v[28:31], v[20:23], 0
    v_mfma_f32_32x32x16_bf16 v[140:155], v[32:35], v[20:23], 0
    v_mfma_f32_32x32x16_bf16 v[156:171], v[28:31], v[24:27], 0
    v_mfma_f32_32x32x16_bf16 v[172:187], v[32:35], v[24:27], 0
    s_waitcnt vmcnt(8) lgkmcnt(0)
    s_barrier
    ds_read_b64_tr_b16 v[28:29], v4 offset:50176
    ds_read_b64_tr_b16 v[30:31], v4 offset:51200
    ds_read_b128 v[12:15], v2 offset:33792
    ds_read_b64_tr_b16 v[32:33], v6 offset:50176
    ds_read_b64_tr_b16 v[34:35], v6 offset:51200
    ds_read_b128 v[16:19], v2 offset:35840
    ds_read_b128 v[20:23], v2 offset:37888
    ds_read_b128 v[24:27], v2 offset:39936
    v_mfma_f32_32x32x16_bf16 v[60:75], v[52:55], v[36:39], v[60:75]
    s_add_u32 m0, s44, 1024
    s_nop 0
    buffer_load_dwordx4 v1, s[12:15], s46 offen offset:0 lds
    v_mfma_f32_32x32x16_bf16 v[76:91], v[56:59], v[36:39], v[76:91]
    v_mfma_f32_32x32x16_bf16 v[92:107], v[52:55], v[40:43], v[92:107]
    buffer_load_dwordx4 v1, s[12:15], s46 offen offset:1024 lds
    s_add_u32 s46, s46, 2048
    s_cmp_eq_u32 s46, s60
    s_cselect_b32 s46, s62, s46
    v_mfma_f32_32x32x16_bf16 v[108:123], v[56:59], v[40:43], v[108:123]
    v_mfma_f32_32x32x16_bf16 v[124:139], v[52:55], v[44:47], v[124:139]
    s_add_u32 m0, s45, 1024
    s_nop 0
    buffer_load_dwordx4 v8, s[16:19], s47 offen offset:0 lds
    v_mfma_f32_32x32x16_bf16 v[140:155], v[56:59], v[44:47], v[140:155]
    v_mfma_f32_32x32x16_bf16 v[156:171], v[52:55], v[48:51], v[156:171]
    buffer_load_dwordx4 v9, s[16:19], s47 offen offset:1024 lds
    s_add_u32 s47, s47, 262144
    s_cmp_eq_u32 s47, s61
    s_cselect_b32 s47, s63, s47
    v_mfma_f32_32x32x16_bf16 v[172:187], v[56:59], v[48:51], v[172:187]
    ds_read_b64_tr_b16 v[52:53], v4 offset:52224
    ds_read_b64_tr_b16 v[54:55], v4 offset:53248
    ds_read_b128 v[36:39], v2 offset:34816
    ds_read_b64_tr_b16 v[56:57], v6 offset:52224
    ds_read_b64_tr_b16 v[58:59], v6 offset:53248
    ds_read_b128 v[40:43], v2 offset:36864
    ds_read_b128 v[44:47], v2 offset:38912
    ds_read_b128 v[48:51], v2 offset:40960
    s_waitcnt lgkmcnt(8)
    v_mfma_f32_32x32x16_bf16 v[60:75], v[28:31], v[12:15], v[60:75]
    v_mfma_f32_32x32x16_bf16 v[76:91], v[32:35], v[12:15], v[76:91]
    v_mfma_f32_32x32x16_bf16 v[92:107], v[28:31], v[16:19], v[92:107]
    v_mfma_f32_32x32x16_bf16 v[108:123], v[32:35], v[16:19], v[108:123]
    v_mfma_f32_32x32x16_bf16 v[124:139], v[28:31], v[20:23], v[124:139]
    v_mfma_f32_32x32x16_bf16 v[140:155], v[32:35], v[20:23], v[140:155]
    v_mfma_f32_32x32x16_bf16 v[156:171], v[28:31], v[24:27], v[156:171]
    v_mfma_f32_32x32x16_bf16 v[172:187], v[32:35], v[24:27], v[172:187]
    s_waitcnt vmcnt(8) lgkmcnt(0)
    s_barrier
    ds_read_b64_tr_b16 v[28:29], v5 offset:17408
    ds_read_b64_tr_b16 v[30:31], v5 offset:18432
    ds_read_b128 v[12:15], v3 offset:1024
    ds_read_b64_tr_b16 v[32:33], v7 offset:17408
    ds_read_b64_tr_b16 v[34:35], v7 offset:18432
    ds_read_b128 v[16:19], v3 offset:3072
    ds_read_b128 v[20:23], v3 offset:5120
    ds_read_b128 v[24:27], v3 offset:7168
    v_mfma_f32_32x32x16_bf16 v[60:75], v[52:55], v[36:39], v[60:75]
    s_add_u32 m0, s44, 33792
    s_nop 0
    buffer_load_dwordx4 v1, s[12:15], s46 offen offset:0 lds
    v_mfma_f32_32x32x16_bf16 v[76:91], v[56:59], v[36:39], v[76:91]
    v_mfma_f32_32x32x16_bf16 v[92:107], v[52:55], v[40:43], v[92:107]
    buffer_load_dwordx4 v1, s[12:15], s46 offen offset:1024 lds
    s_add_u32 s46, s46, 2048
    s_cmp_eq_u32 s46, s60
    s_cselect_b32 s46, s62, s46
    v_mfma_f32_32x32x16_bf16 v[108:123], v[56:59], v[40:43], v[108:123]
    v_mfma_f32_32x32x16_bf16 v[124:139], v[52:55], v[44:47], v[124:139]
    s_add_u32 m0, s45, 33792
    s_nop 0
    buffer_load_dwordx4 v8, s[16:19], s47 offen offset:0 lds
    v_mfma_f32_32x32x16_bf16 v[140:155], v[56:59], v[44:47], v[140:155]
    v_mfma_f32_32x32x16_bf16 v[156:171], v[52:55], v[48:51], v[156:171]
    buffer_load_dwordx4 v9, s[16:19], s47 offen offset:1024 lds
    s_add_u32 s47, s47, 262144
    s_cmp_eq_u32 s47, s61
    s_cselect_b32 s47, s63, s47
    v_mfma_f32_32x32x16_bf16 v[172:187], v[56:59], v[48:51], v[172:187]
    ds_read_b64_tr_b16 v[52:53], v5 offset:19456
    ds_read_b64_tr_b16 v[54:55], v5 offset:20480
    ds_read_b128 v[36:39], v3 offset:2048
    ds_read_b64_tr_b16 v[56:57], v7 offset:19456
    ds_read_b64_tr_b16 v[58:59], v7 offset:20480
    ds_read_b128 v[40:43], v3 offset:4096
    ds_read_b128 v[44:47], v3 offset:6144
    ds_read_b128 v[48:51], v3 offset:8192
    s_waitcnt lgkmcnt(8)
    v_mfma_f32_32x32x16_bf16 v[60:75], v[28:31], v[12:15], v[60:75]
    v_mfma_f32_32x32x16_bf16 v[76:91], v[32:35], v[12:15], v[76:91]
    v_mfma_f32_32x32x16_bf16 v[92:107], v[28:31], v[16:19], v[92:107]
    v_mfma_f32_32x32x16_bf16 v[108:123], v[32:35], v[16:19], v[108:123]
    v_mfma_f32_32x32x16_bf16 v[124:139], v[28:31], v[20:23], v[124:139]
    v_mfma_f32_32x32x16_bf16 v[140:155], v[32:35], v[20:23], v[140:155]
    v_mfma_f32_32x32x16_bf16 v[156:171], v[28:31], v[24:27], v[156:171]
    v_mfma_f32_32x32x16_bf16 v[172:187], v[32:35], v[24:27], v[172:187]
    s_waitcnt vmcnt(8) lgkmcnt(0)
    s_barrier
    ds_read_b64_tr_b16 v[28:29], v5 offset:50176
    ds_read_b64_tr_b16 v[30:31], v5 offset:51200
    ds_read_b128 v[12:15], v3 offset:33792
    ds_read_b64_tr_b16 v[32:33], v7 offset:50176
    ds_read_b64_tr_b16 v[34:35], v7 offset:51200
    ds_read_b128 v[16:19], v3 offset:35840
    ds_read_b128 v[20:23], v3 offset:37888
    ds_read_b128 v[24:27], v3 offset:39936
    v_mfma_f32_32x32x16_bf16 v[60:75], v[52:55], v[36:39], v[60:75]
    s_add_u32 m0, s44, 66560
    s_nop 0
    buffer_load_dwordx4 v1, s[12:15], s46 offen offset:0 lds
    v_mfma_f32_32x32x16_bf16 v[76:91], v[56:59], v[36:39], v[76:91]
    v_mfma_f32_32x32x16_bf16 v[92:107], v[52:55], v[40:43], v[92:107]
    buffer_load_dwordx4 v1, s[12:15], s46 offen offset:1024 lds
    s_add_u32 s46, s46, 2048
    s_cmp_eq_u32 s46, s60
    s_cselect_b32 s46, s62, s46
    v_mfma_f32_32x32x16_bf16 v[108:123], v[56:59], v[40:43], v[108:123]
    v_mfma_f32_32x32x16_bf16 v[124:139], v[52:55], v[44:47], v[124:139]
    s_add_u32 m0, s45, 66560
    s_nop 0
    buffer_load_dwordx4 v8, s[16:19], s47 offen offset:0 lds
    v_mfma_f32_32x32x16_bf16 v[140:155], v[56:59], v[44:47], v[140:155]
    v_mfma_f32_32x32x16_bf16 v[156:171], v[52:55], v[48:51], v[156:171]
    buffer_load_dwordx4 v9, s[16:19], s47 offen offset:1024 lds
    s_add_u32 s47, s47, 262144
    s_cmp_eq_u32 s47, s61
    s_cselect_b32 s47, s63, s47
    v_mfma_f32_32x32x16_bf16 v[172:187], v[56:59], v[48:51], v[172:187]
    ds_read_b64_tr_b16 v[52:53], v5 offset:52224
    ds_read_b64_tr_b16 v[54:55], v5 offset:53248
    ds_read_b128 v[36:39], v3 offset:34816
    ds_read_b64_tr_b16 v[56:57], v7 offset:52224
    ds_read_b64_tr_b16 v[58:59], v7 offset:53248
    ds_read_b128 v[40:43], v3 offset:36864
    ds_read_b128 v[44:47], v3 offset:38912
    ds_read_b128 v[48:51], v3 offset:40960
    s_waitcnt lgkmcnt(8)
    v_mfma_f32_32x32x16_bf16 v[60:75], v[28:31], v[12:15], v[60:75]
    v_mfma_f32_32x32x16_bf16 v[76:91], v[32:35], v[12:15], v[76:91]
    v_mfma_f32_32x32x16_bf16 v[92:107], v[28:31], v[16:19], v[92:107]
    v_mfma_f32_32x32x16_bf16 v[108:123], v[32:35], v[16:19], v[108:123]
    v_mfma_f32_32x32x16_bf16 v[124:139], v[28:31], v[20:23], v[124:139]
    v_mfma_f32_32x32x16_bf16 v[140:155], v[32:35], v[20:23], v[140:155]
    v_mfma_f32_32x32x16_bf16 v[156:171], v[28:31], v[24:27], v[156:171]
    v_mfma_f32_32x32x16_bf16 v[172:187], v[32:35], v[24:27], v[172:187]
    s_waitcnt vmcnt(8) lgkmcnt(0)
    s_barrier
    ds_read_b64_tr_b16 v[28:29], v4 offset:17408
    ds_read_b64_tr_b16 v[30:31], v4 offset:18432
    ds_read_b128 v[12:15], v2 offset:1024
    ds_read_b64_tr_b16 v[32:33], v6 offset:17408
    ds_read_b64_tr_b16 v[34:35], v6 offset:18432
    ds_read_b128 v[16:19], v2 offset:3072
    ds_read_b128 v[20:23], v2 offset:5120
    ds_read_b128 v[24:27], v2 offset:7168
    v_mfma_f32_32x32x16_bf16 v[60:75], v[52:55], v[36:39], v[60:75]
    s_add_u32 m0, s44, 99328
    s_nop 0
    buffer_load_dwordx4 v1, s[12:15], s46 offen offset:0 lds
    v_mfma_f32_32x32x16_bf16 v[76:91], v[56:59], v[36:39], v[76:91]
    v_mfma_f32_32x32x16_bf16 v[92:107], v[52:55], v[40:43], v[92:107]
    buffer_load_dwordx4 v1, s[12:15], s46 offen offset:1024 lds
    s_add_u32 s46, s46, 2048
    s_cmp_eq_u32 s46, s60
    s_cselect_b32 s46, s62, s46
    v_mfma_f32_32x32x16_bf16 v[108:123], v[56:59], v[40:43], v[108:123]
    v_mfma_f32_32x32x16_bf16 v[124:139], v[52:55], v[44:47], v[124:139]
    s_add_u32 m0, s45, 99328
    s_nop 0
    buffer_load_dwordx4 v8, s[16:19], s47 offen offset:0 lds
    v_mfma_f32_32x32x16_bf16 v[140:155], v[56:59], v[44:47], v[140:155]
    v_mfma_f32_32x32x16_bf16 v[156:171], v[52:55], v[48:51], v[156:171]
    buffer_load_dwordx4 v9, s[16:19], s47 offen offset:1024 lds
    s_add_u32 s47, s47, 262144
    s_cmp_eq_u32 s47, s61
    s_cselect_b32 s47, s63, s47
    v_mfma_f32_32x32x16_bf16 v[172:187], v[56:59], v[48:51], v[172:187]
    ds_read_b64_tr_b16 v[52:53], v4 offset:19456
    ds_read_b64_tr_b16 v[54:55], v4 offset:20480
    ds_read_b128 v[36:39], v2 offset:2048
    ds_read_b64_tr_b16 v[56:57], v6 offset:19456
    ds_read_b64_tr_b16 v[58:59], v6 offset:20480
    ds_read_b128 v[40:43], v2 offset:4096
    ds_read_b128 v[44:47], v2 offset:6144
    ds_read_b128 v[48:51], v2 offset:8192
    s_waitcnt lgkmcnt(8)
    v_mfma_f32_32x32x16_bf16 v[60:75], v[28:31], v[12:15], v[60:75]
    v_mfma_f32_32x32x16_bf16 v[76:91], v[32:35], v[12:15], v[76:91]
    v_mfma_f32_32x32x16_bf16 v[92:107], v[28:31], v[16:19], v[92:107]
    v_mfma_f32_32x32x16_bf16 v[108:123], v[32:35], v[16:19], v[108:123]
    v_mfma_f32_32x32x16_bf16 v[124:139], v[28:31], v[20:23], v[124:139]
    v_mfma_f32_32x32x16_bf16 v[140:155], v[32:35], v[20:23], v[140:155]
    v_mfma_f32_32x32x16_bf16 v[156:171], v[28:31], v[24:27], v[156:171]
    v_mfma_f32_32x32x16_bf16 v[172:187], v[32:35], v[24:27], v[172:187]
    s_waitcnt vmcnt(8) lgkmcnt(0)
    s_barrier
    ds_read_b64_tr_b16 v[28:29], v4 offset:50176
    ds_read_b64_tr_b16 v[30:31], v4 offset:51200
    ds_read_b128 v[12:15], v2 offset:33792
    ds_read_b64_tr_b16 v[32:33], v6 offset:50176
    ds_read_b64_tr_b16 v[34:35], v6 offset:51200
    ds_read_b128 v[16:19], v2 offset:35840
    ds_read_b128 v[20:23], v2 offset:37888
    ds_read_b128 v[24:27], v2 offset:39936
    v_mfma_f32_32x32x16_bf16 v[60:75], v[52:55], v[36:39], v[60:75]
    s_add_u32 m0, s44, 1024
    s_nop 0
    buffer_load_dwordx4 v1, s[12:15], s46 offen offset:0 lds
    v_mfma_f32_32x32x16_bf16 v[76:91], v[56:59], v[36:39], v[76:91]
    v_mfma_f32_32x32x16_bf16 v[92:107], v[52:55], v[40:43], v[92:107]
    buffer_load_dwordx4 v1, s[12:15], s46 offen offset:1024 lds
    s_add_u32 s46, s46, 2048
    s_cmp_eq_u32 s46, s60
    s_cselect_b32 s46, s62, s46
    v_mfma_f32_32x32x16_bf16 v[108:123], v[56:59], v[40:43], v[108:123]
    v_mfma_f32_32x32x16_bf16 v[124:139], v[52:55], v[44:47], v[124:139]
    s_add_u32 m0, s45, 1024
    s_nop 0
    buffer_load_dwordx4 v8, s[16:19], s47 offen offset:0 lds
    v_mfma_f32_32x32x16_bf16 v[140:155], v[56:59], v[44:47], v[140:155]
    v_mfma_f32_32x32x16_bf16 v[156:171], v[52:55], v[48:51], v[156:171]
    buffer_load_dwordx4 v9, s[16:19], s47 offen offset:1024 lds
    s_add_u32 s47, s47, 262144
    s_cmp_eq_u32 s47, s61
    s_cselect_b32 s47, s63, s47
    v_mfma_f32_32x32x16_bf16 v[172:187], v[56:59], v[48:51], v[172:187]
    ds_read_b64_tr_b16 v[52:53], v4 offset:52224
    ds_read_b64_tr_b16 v[54:55], v4 offset:53248
    ds_read_b128 v[36:39], v2 offset:34816
    ds_read_b64_tr_b16 v[56:57], v6 offset:52224
    ds_read_b64_tr_b16 v[58:59], v6 offset:53248
    ds_read_b128 v[40:43], v2 offset:36864
    ds_read_b128 v[44:47], v2 offset:38912
    ds_read_b128 v[48:51], v2 offset:40960
    s_waitcnt lgkmcnt(8)
    v_mfma_f32_32x32x16_bf16 v[60:75], v[28:31], v[12:15], v[60:75]
    v_mfma_f32_32x32x16_bf16 v[76:91], v[32:35], v[12:15], v[76:91]
    v_mfma_f32_32x32x16_bf16 v[92:107], v[28:31], v[16:19], v[92:107]
    v_mfma_f32_32x32x16_bf16 v[108:123], v[32:35], v[16:19], v[108:123]
    v_mfma_f32_32x32x16_bf16 v[124:139], v[28:31], v[20:23], v[124:139]
    v_mfma_f32_32x32x16_bf16 v[140:155], v[32:35], v[20:23], v[140:155]
    v_mfma_f32_32x32x16_bf16 v[156:171], v[28:31], v[24:27], v[156:171]
    v_mfma_f32_32x32x16_bf16 v[172:187], v[32:35], v[24:27], v[172:187]
    s_waitcnt vmcnt(8) lgkmcnt(0)
    s_barrier
    ds_read_b64_tr_b16 v[28:29], v5 offset:17408
    ds_read_b64_tr_b16 v[30:31], v5 offset:18432
    ds_read_b128 v[12:15], v3 offset:1024
    ds_read_b64_tr_b16 v[32:33], v7 offset:17408
    ds_read_b64_tr_b16 v[34:35], v7 offset:18432
    ds_read_b128 v[16:19], v3 offset:3072
    ds_read_b128 v[20:23], v3 offset:5120
    ds_read_b128 v[24:27], v3 offset:7168
    v_mfma_f32_32x32x16_bf16 v[60:75], v[52:55], v[36:39], v[60:75]
    s_add_u32 m0, s44, 33792
    s_nop 0
    buffer_load_dwordx4 v1, s[12:15], s46 offen offset:0 lds
    v_mfma_f32_32x32x16_bf16 v[76:91], v[56:59], v[36:39], v[76:91]
    v_mfma_f32_32x32x16_bf16 v[92:107], v[52:55], v[40:43], v[92:107]
    buffer_load_dwordx4 v1, s[12:15], s46 offen offset:1024 lds
    s_add_u32 s46, s46, 2048
    s_cmp_eq_u32 s46, s60
    s_cselect_b32 s46, s62, s46
    v_mfma_f32_32x32x16_bf16 v[108:123], v[56:59], v[40:43], v[108:123]
    v_mfma_f32_32x32x16_bf16 v[124:139], v[52:55], v[44:47], v[124:139]
    s_add_u32 m0, s45, 33792
    s_nop 0
    buffer_load_dwordx4 v8, s[16:19], s47 offen offset:0 lds
    v_mfma_f32_32x32x16_bf16 v[140:155], v[56:59], v[44:47], v[140:155]
    v_mfma_f32_32x32x16_bf16 v[156:171], v[52:55], v[48:51], v[156:171]
    buffer_load_dwordx4 v9, s[16:19], s47 offen offset:1024 lds
    s_add_u32 s47, s47, 262144
    s_cmp_eq_u32 s47, s61
    s_cselect_b32 s47, s63, s47
    v_mfma_f32_32x32x16_bf16 v[172:187], v[56:59], v[48:51], v[172:187]
    ds_read_b64_tr_b16 v[52:53], v5 offset:19456
    ds_read_b64_tr_b16 v[54:55], v5 offset:20480
    ds_read_b128 v[36:39], v3 offset:2048
    ds_read_b64_tr_b16 v[56:57], v7 offset:19456
    ds_read_b64_tr_b16 v[58:59], v7 offset:20480
    ds_read_b128 v[40:43], v3 offset:4096
    ds_read_b128 v[44:47], v3 offset:6144
    ds_read_b128 v[48:51], v3 offset:8192
    s_waitcnt lgkmcnt(8)
    v_mfma_f32_32x32x16_bf16 v[60:75], v[28:31], v[12:15], v[60:75]
    v_mfma_f32_32x32x16_bf16 v[76:91], v[32:35], v[12:15], v[76:91]
    v_mfma_f32_32x32x16_bf16 v[92:107], v[28:31], v[16:19], v[92:107]
    v_mfma_f32_32x32x16_bf16 v[108:123], v[32:35], v[16:19], v[108:123]
    v_mfma_f32_32x32x16_bf16 v[124:139], v[28:31], v[20:23], v[124:139]
    v_mfma_f32_32x32x16_bf16 v[140:155], v[32:35], v[20:23], v[140:155]
    v_mfma_f32_32x32x16_bf16 v[156:171], v[28:31], v[24:27], v[156:171]
    v_mfma_f32_32x32x16_bf16 v[172:187], v[32:35], v[24:27], v[172:187]
    s_waitcnt vmcnt(8) lgkmcnt(0)
    s_barrier
    ds_read_b64_tr_b16 v[28:29], v5 offset:50176
    ds_read_b64_tr_b16 v[30:31], v5 offset:51200
    ds_read_b128 v[12:15], v3 offset:33792
    ds_read_b64_tr_b16 v[32:33], v7 offset:50176
    ds_read_b64_tr_b16 v[34:35], v7 offset:51200
    ds_read_b128 v[16:19], v3 offset:35840
    ds_read_b128 v[20:23], v3 offset:37888
    ds_read_b128 v[24:27], v3 offset:39936
    v_mfma_f32_32x32x16_bf16 v[60:75], v[52:55], v[36:39], v[60:75]
    s_add_u32 m0, s44, 66560
    s_nop 0
    buffer_load_dwordx4 v1, s[12:15], s46 offen offset:0 lds
    v_mfma_f32_32x32x16_bf16 v[76:91], v[56:59], v[36:39], v[76:91]
    v_mfma_f32_32x32x16_bf16 v[92:107], v[52:55], v[40:43], v[92:107]
    buffer_load_dwordx4 v1, s[12:15], s46 offen offset:1024 lds
    s_add_u32 s46, s46, 2048
    s_cmp_eq_u32 s46, s60
    s_cselect_b32 s46, s62, s46
    v_mfma_f32_32x32x16_bf16 v[108:123], v[56:59], v[40:43], v[108:123]
    v_mfma_f32_32x32x16_bf16 v[124:139], v[52:55], v[44:47], v[124:139]
    s_add_u32 m0, s45, 66560
    s_nop 0
    buffer_load_dwordx4 v8, s[16:19], s47 offen offset:0 lds
    v_mfma_f32_32x32x16_bf16 v[140:155], v[56:59], v[44:47], v[140:155]
    v_mfma_f32_32x32x16_bf16 v[156:171], v[52:55], v[48:51], v[156:171]
    buffer_load_dwordx4 v9, s[16:19], s47 offen offset:1024 lds
    s_add_u32 s47, s47, 262144
    s_cmp_eq_u32 s47, s61
    s_cselect_b32 s47, s63, s47
    v_mfma_f32_32x32x16_bf16 v[172:187], v[56:59], v[48:51], v[172:187]
    ds_read_b64_tr_b16 v[52:53], v5 offset:52224
    ds_read_b64_tr_b16 v[54:55], v5 offset:53248
    ds_read_b128 v[36:39], v3 offset:34816
    ds_read_b64_tr_b16 v[56:57], v7 offset:52224
    ds_read_b64_tr_b16 v[58:59], v7 offset:53248
    ds_read_b128 v[40:43], v3 offset:36864
    ds_read_b128 v[44:47], v3 offset:38912
    ds_read_b128 v[48:51], v3 offset:40960
    s_waitcnt lgkmcnt(8)
    v_mfma_f32_32x32x16_bf16 v[60:75], v[28:31], v[12:15], v[60:75]
    v_mfma_f32_32x32x16_bf16 v[76:91], v[32:35], v[12:15], v[76:91]
    v_mfma_f32_32x32x16_bf16 v[92:107], v[28:31], v[16:19], v[92:107]
    v_mfma_f32_32x32x16_bf16 v[108:123], v[32:35], v[16:19], v[108:123]
    v_mfma_f32_32x32x16_bf16 v[124:139], v[28:31], v[20:23], v[124:139]
    v_mfma_f32_32x32x16_bf16 v[140:155], v[32:35], v[20:23], v[140:155]
    v_mfma_f32_32x32x16_bf16 v[156:171], v[28:31], v[24:27], v[156:171]
    v_mfma_f32_32x32x16_bf16 v[172:187], v[32:35], v[24:27], v[172:187]
    s_waitcnt vmcnt(8) lgkmcnt(0)
    s_barrier
    ds_read_b64_tr_b16 v[28:29], v4 offset:17408
    ds_read_b64_tr_b16 v[30:31], v4 offset:18432
    ds_read_b128 v[12:15], v2 offset:1024
    ds_read_b64_tr_b16 v[32:33], v6 offset:17408
    ds_read_b64_tr_b16 v[34:35], v6 offset:18432
    ds_read_b128 v[16:19], v2 offset:3072
    ds_read_b128 v[20:23], v2 offset:5120
    ds_read_b128 v[24:27], v2 offset:7168
    v_mfma_f32_32x32x16_bf16 v[60:75], v[52:55], v[36:39], v[60:75]
    s_add_u32 m0, s44, 99328
    s_nop 0
    buffer_load_dwordx4 v1, s[12:15], s46 offen offset:0 lds
    v_mfma_f32_32x32x16_bf16 v[76:91], v[56:59], v[36:39], v[76:91]
    v_mfma_f32_32x32x16_bf16 v[92:107], v[52:55], v[40:43], v[92:107]
    buffer_load_dwordx4 v1, s[12:15], s46 offen offset:1024 lds
    s_add_u32 s46, s46, 2048
    s_cmp_eq_u32 s46, s60
    s_cselect_b32 s46, s62, s46
    v_mfma_f32_32x32x16_bf16 v[108:123], v[56:59], v[40:43], v[108:123]
    v_mfma_f32_32x32x16_bf16 v[124:139], v[52:55], v[44:47], v[124:139]
    s_add_u32 m0, s45, 99328
    s_nop 0
    buffer_load_dwordx4 v8, s[16:19], s47 offen offset:0 lds
    v_mfma_f32_32x32x16_bf16 v[140:155], v[56:59], v[44:47], v[140:155]
    v_mfma_f32_32x32x16_bf16 v[156:171], v[52:55], v[48:51], v[156:171]
    buffer_load_dwordx4 v9, s[16:19], s47 offen offset:1024 lds
    s_add_u32 s47, s47, 262144
    s_cmp_eq_u32 s47, s61
    s_cselect_b32 s47, s63, s47
    v_mfma_f32_32x32x16_bf16 v[172:187], v[56:59], v[48:51], v[172:187]
    ds_read_b64_tr_b16 v[52:53], v4 offset:19456
    ds_read_b64_tr_b16 v[54:55], v4 offset:20480
    ds_read_b128 v[36:39], v2 offset:2048
    ds_read_b64_tr_b16 v[56:57], v6 offset:19456
    ds_read_b64_tr_b16 v[58:59], v6 offset:20480
    ds_read_b128 v[40:43], v2 offset:4096
    ds_read_b128 v[44:47], v2 offset:6144
    ds_read_b128 v[48:51], v2 offset:8192
    s_waitcnt lgkmcnt(8)
    v_mfma_f32_32x32x16_bf16 v[60:75], v[28:31], v[12:15], v[60:75]
    v_mfma_f32_32x32x16_bf16 v[76:91], v[32:35], v[12:15], v[76:91]
    v_mfma_f32_32x32x16_bf16 v[92:107], v[28:31], v[16:19], v[92:107]
    v_mfma_f32_32x32x16_bf16 v[108:123], v[32:35], v[16:19], v[108:123]
    v_mfma_f32_32x32x16_bf16 v[124:139], v[28:31], v[20:23], v[124:139]
    v_mfma_f32_32x32x16_bf16 v[140:155], v[32:35], v[20:23], v[140:155]
    v_mfma_f32_32x32x16_bf16 v[156:171], v[28:31], v[24:27], v[156:171]
    v_mfma_f32_32x32x16_bf16 v[172:187], v[32:35], v[24:27], v[172:187]
    s_waitcnt vmcnt(8) lgkmcnt(0)
    s_barrier
    ds_read_b64_tr_b16 v[28:29], v4 offset:50176
    ds_read_b64_tr_b16 v[30:31], v4 offset:51200
    ds_read_b128 v[12:15], v2 offset:33792
    ds_read_b64_tr_b16 v[32:33], v6 offset:50176
    ds_read_b64_tr_b16 v[34:35], v6 offset:51200
    ds_read_b128 v[16:19], v2 offset:35840
    ds_read_b128 v[20:23], v2 offset:37888
    ds_read_b128 v[24:27], v2 offset:39936
    v_mfma_f32_32x32x16_bf16 v[60:75], v[52:55], v[36:39], v[60:75]
    s_add_u32 m0, s44, 1024
    s_nop 0
    buffer_load_dwordx4 v1, s[12:15], s46 offen offset:0 lds
    v_mfma_f32_32x32x16_bf16 v[76:91], v[56:59], v[36:39], v[76:91]
    v_mfma_f32_32x32x16_bf16 v[92:107], v[52:55], v[40:43], v[92:107]
    buffer_load_dwordx4 v1, s[12:15], s46 offen offset:1024 lds
    s_add_u32 s46, s46, 2048
    s_cmp_eq_u32 s46, s60
    s_cselect_b32 s46, s62, s46
    v_mfma_f32_32x32x16_bf16 v[108:123], v[56:59], v[40:43], v[108:123]
    v_mfma_f32_32x32x16_bf16 v[124:139], v[52:55], v[44:47], v[124:139]
    s_add_u32 m0, s45, 1024
    s_nop 0
    buffer_load_dwordx4 v8, s[16:19], s47 offen offset:0 lds
    v_mfma_f32_32x32x16_bf16 v[140:155], v[56:59], v[44:47], v[140:155]
    v_mfma_f32_32x32x16_bf16 v[156:171], v[52:55], v[48:51], v[156:171]
    buffer_load_dwordx4 v9, s[16:19], s47 offen offset:1024 lds
    s_add_u32 s47, s47, 262144
    s_cmp_eq_u32 s47, s61
    s_cselect_b32 s47, s63, s47
    v_mfma_f32_32x32x16_bf16 v[172:187], v[56:59], v[48:51], v[172:187]
    ds_read_b64_tr_b16 v[52:53], v4 offset:52224
    ds_read_b64_tr_b16 v[54:55], v4 offset:53248
    ds_read_b128 v[36:39], v2 offset:34816
    ds_read_b64_tr_b16 v[56:57], v6 offset:52224
    ds_read_b64_tr_b16 v[58:59], v6 offset:53248
    ds_read_b128 v[40:43], v2 offset:36864
    ds_read_b128 v[44:47], v2 offset:38912
    ds_read_b128 v[48:51], v2 offset:40960
    s_waitcnt lgkmcnt(8)
    v_mfma_f32_32x32x16_bf16 v[60:75], v[28:31], v[12:15], v[60:75]
    v_mfma_f32_32x32x16_bf16 v[76:91], v[32:35], v[12:15], v[76:91]
    v_mfma_f32_32x32x16_bf16 v[92:107], v[28:31], v[16:19], v[92:107]
    v_mfma_f32_32x32x16_bf16 v[108:123], v[32:35], v[16:19], v[108:123]
    v_mfma_f32_32x32x16_bf16 v[124:139], v[28:31], v[20:23], v[124:139]
    v_mfma_f32_32x32x16_bf16 v[140:155], v[32:35], v[20:23], v[140:155]
    v_mfma_f32_32x32x16_bf16 v[156:171], v[28:31], v[24:27], v[156:171]
    v_mfma_f32_32x32x16_bf16 v[172:187], v[32:35], v[24:27], v[172:187]
    s_waitcnt vmcnt(8) lgkmcnt(0)
    s_barrier
    ds_read_b64_tr_b16 v[28:29], v5 offset:17408
    ds_read_b64_tr_b16 v[30:31], v5 offset:18432
    ds_read_b128 v[12:15], v3 offset:1024
    ds_read_b64_tr_b16 v[32:33], v7 offset:17408
    ds_read_b64_tr_b16 v[34:35], v7 offset:18432
    ds_read_b128 v[16:19], v3 offset:3072
    ds_read_b128 v[20:23], v3 offset:5120
    ds_read_b128 v[24:27], v3 offset:7168
    v_mfma_f32_32x32x16_bf16 v[60:75], v[52:55], v[36:39], v[60:75]
    s_add_u32 m0, s44, 33792
    s_nop 0
    buffer_load_dwordx4 v1, s[12:15], s46 offen offset:0 lds
    v_mfma_f32_32x32x16_bf16 v[76:91], v[56:59], v[36:39], v[76:91]
    v_mfma_f32_32x32x16_bf16 v[92:107], v[52:55], v[40:43], v[92:107]
    buffer_load_dwordx4 v1, s[12:15], s46 offen offset:1024 lds
    s_add_u32 s46, s46, 2048
    s_cmp_eq_u32 s46, s60
    s_cselect_b32 s46, s62, s46
    v_mfma_f32_32x32x16_bf16 v[108:123], v[56:59], v[40:43], v[108:123]
    v_mfma_f32_32x32x16_bf16 v[124:139], v[52:55], v[44:47], v[124:139]
    s_add_u32 m0, s45, 33792
    s_nop 0
    buffer_load_dwordx4 v8, s[16:19], s47 offen offset:0 lds
    v_mfma_f32_32x32x16_bf16 v[140:155], v[56:59], v[44:47], v[140:155]
    v_mfma_f32_32x32x16_bf16 v[156:171], v[52:55], v[48:51], v[156:171]
    buffer_load_dwordx4 v9, s[16:19], s47 offen offset:1024 lds
    s_add_u32 s47, s47, 262144
    s_cmp_eq_u32 s47, s61
    s_cselect_b32 s47, s63, s47
    v_mfma_f32_32x32x16_bf16 v[172:187], v[56:59], v[48:51], v[172:187]
    ds_read_b64_tr_b16 v[52:53], v5 offset:19456
    ds_read_b64_tr_b16 v[54:55], v5 offset:20480
    ds_read_b128 v[36:39], v3 offset:2048
    ds_read_b64_tr_b16 v[56:57], v7 offset:19456
    ds_read_b64_tr_b16 v[58:59], v7 offset:20480
    ds_read_b128 v[40:43], v3 offset:4096
    ds_read_b128 v[44:47], v3 offset:6144
    ds_read_b128 v[48:51], v3 offset:8192
    s_waitcnt lgkmcnt(8)
    v_mfma_f32_32x32x16_bf16 v[60:75], v[28:31], v[12:15], v[60:75]
    v_mfma_f32_32x32x16_bf16 v[76:91], v[32:35], v[12:15], v[76:91]
    v_mfma_f32_32x32x16_bf16 v[92:107], v[28:31], v[16:19], v[92:107]
    v_mfma_f32_32x32x16_bf16 v[108:123], v[32:35], v[16:19], v[108:123]
    v_mfma_f32_32x32x16_bf16 v[124:139], v[28:31], v[20:23], v[124:139]
    v_mfma_f32_32x32x16_bf16 v[140:155], v[32:35], v[20:23], v[140:155]
    v_mfma_f32_32x32x16_bf16 v[156:171], v[28:31], v[24:27], v[156:171]
    v_mfma_f32_32x32x16_bf16 v[172:187], v[32:35], v[24:27], v[172:187]
    s_waitcnt vmcnt(8) lgkmcnt(0)
    s_barrier
    ds_read_b64_tr_b16 v[28:29], v5 offset:50176
    ds_read_b64_tr_b16 v[30:31], v5 offset:51200
    ds_read_b128 v[12:15], v3 offset:33792
    ds_read_b64_tr_b16 v[32:33], v7 offset:50176
    ds_read_b64_tr_b16 v[34:35], v7 offset:51200
    ds_read_b128 v[16:19], v3 offset:35840
    ds_read_b128 v[20:23], v3 offset:37888
    ds_read_b128 v[24:27], v3 offset:39936
    v_mfma_f32_32x32x16_bf16 v[60:75], v[52:55], v[36:39], v[60:75]
    s_add_u32 m0, s44, 66560
    s_nop 0
    buffer_load_dwordx4 v1, s[12:15], s46 offen offset:0 lds
    v_mfma_f32_32x32x16_bf16 v[76:91], v[56:59], v[36:39], v[76:91]
    v_mfma_f32_32x32x16_bf16 v[92:107], v[52:55], v[40:43], v[92:107]
    buffer_load_dwordx4 v1, s[12:15], s46 offen offset:1024 lds
    s_add_u32 s46, s46, 2048
    s_cmp_eq_u32 s46, s60
    s_cselect_b32 s46, s62, s46
    v_mfma_f32_32x32x16_bf16 v[108:123], v[56:59], v[40:43], v[108:123]
    v_mfma_f32_32x32x16_bf16 v[124:139], v[52:55], v[44:47], v[124:139]
    s_add_u32 m0, s45, 66560
    s_nop 0
    buffer_load_dwordx4 v8, s[16:19], s47 offen offset:0 lds
    v_mfma_f32_32x32x16_bf16 v[140:155], v[56:59], v[44:47], v[140:155]
    v_mfma_f32_32x32x16_bf16 v[156:171], v[52:55], v[48:51], v[156:171]
    buffer_load_dwordx4 v9, s[16:19], s47 offen offset:1024 lds
    s_add_u32 s47, s47, 262144
    s_cmp_eq_u32 s47, s61
    s_cselect_b32 s47, s63, s47
    v_mfma_f32_32x32x16_bf16 v[172:187], v[56:59], v[48:51], v[172:187]
    ds_read_b64_tr_b16 v[52:53], v5 offset:52224
    ds_read_b64_tr_b16 v[54:55], v5 offset:53248
    ds_read_b128 v[36:39], v3 offset:34816
    ds_read_b64_tr_b16 v[56:57], v7 offset:52224
    ds_read_b64_tr_b16 v[58:59], v7 offset:53248
    ds_read_b128 v[40:43], v3 offset:36864
    ds_read_b128 v[44:47], v3 offset:38912
    ds_read_b128 v[48:51], v3 offset:40960
    s_waitcnt lgkmcnt(8)
    v_mfma_f32_32x32x16_bf16 v[60:75], v[28:31], v[12:15], v[60:75]
    v_mfma_f32_32x32x16_bf16 v[76:91], v[32:35], v[12:15], v[76:91]
    v_mfma_f32_32x32x16_bf16 v[92:107], v[28:31], v[16:19], v[92:107]
    v_mfma_f32_32x32x16_bf16 v[108:123], v[32:35], v[16:19], v[108:123]
    v_mfma_f32_32x32x16_bf16 v[124:139], v[28:31], v[20:23], v[124:139]
    v_mfma_f32_32x32x16_bf16 v[140:155], v[32:35], v[20:23], v[140:155]
    v_mfma_f32_32x32x16_bf16 v[156:171], v[28:31], v[24:27], v[156:171]
    v_mfma_f32_32x32x16_bf16 v[172:187], v[32:35], v[24:27], v[172:187]
    s_waitcnt vmcnt(8) lgkmcnt(0)
    s_barrier
    ds_read_b64_tr_b16 v[28:29], v4 offset:17408
    ds_read_b64_tr_b16 v[30:31], v4 offset:18432
    ds_read_b128 v[12:15], v2 offset:1024
    ds_read_b64_tr_b16 v[32:33], v6 offset:17408
    ds_read_b64_tr_b16 v[34:35], v6 offset:18432
    ds_read_b128 v[16:19], v2 offset:3072
    ds_read_b128 v[20:23], v2 offset:5120
    ds_read_b128 v[24:27], v2 offset:7168
    v_mfma_f32_32x32x16_bf16 v[60:75], v[52:55], v[36:39], v[60:75]
    s_add_u32 m0, s44, 99328
    s_nop 0
    buffer_load_dwordx4 v1, s[12:15], s46 offen offset:0 lds
    v_mfma_f32_32x32x16_bf16 v[76:91], v[56:59], v[36:39], v[76:91]
    buffer_load_dwordx4 v1, s[12:15], s46 offen offset:1024 lds
    s_add_u32 s46, s46, 2048
    s_cmp_eq_u32 s46, s60
    s_cselect_b32 s46, s62, s46
    v_mfma_f32_32x32x16_bf16 v[92:107], v[52:55], v[40:43], v[92:107]
    s_add_u32 m0, s45, 99328
    s_nop 0
    buffer_load_dwordx4 v8, s[16:19], s47 offen offset:0 lds
    v_mfma_f32_32x32x16_bf16 v[108:123], v[56:59], v[40:43], v[108:123]
    v_mfma_f32_32x32x16_bf16 v[124:139], v[52:55], v[44:47], v[124:139]
    buffer_load_dwordx4 v9, s[16:19], s47 offen offset:1024 lds
    s_add_u32 s47, s47, 262144
    s_cmp_eq_u32 s47, s61
    s_cselect_b32 s47, s63, s47
    v_mfma_f32_32x32x16_bf16 v[140:155], v[56:59], v[44:47], v[140:155]
    buffer_load_dwordx4 v[200:203], v1, s[56:59], s66 offen offset:0
    v_mfma_f32_32x32x16_bf16 v[156:171], v[52:55], v[48:51], v[156:171]
    buffer_load_dwordx4 v[200:203], v1, s[56:59], s66 offen offset:1024
    v_mfma_f32_32x32x16_bf16 v[172:187], v[56:59], v[48:51], v[172:187]
    ds_read_b64_tr_b16 v[52:53], v4 offset:19456
    ds_read_b64_tr_b16 v[54:55], v4 offset:20480
    ds_read_b128 v[36:39], v2 offset:2048
    ds_read_b64_tr_b16 v[56:57], v6 offset:19456
    ds_read_b64_tr_b16 v[58:59], v6 offset:20480
    ds_read_b128 v[40:43], v2 offset:4096
    ds_read_b128 v[44:47], v2 offset:6144
    ds_read_b128 v[48:51], v2 offset:8192
    s_waitcnt lgkmcnt(8)
    v_mfma_f32_32x32x16_bf16 v[60:75], v[28:31], v[12:15], v[60:75]
    v_mfma_f32_32x32x16_bf16 v[76:91], v[32:35], v[12:15], v[76:91]
    v_mfma_f32_32x32x16_bf16 v[92:107], v[28:31], v[16:19], v[92:107]
    v_mfma_f32_32x32x16_bf16 v[108:123], v[32:35], v[16:19], v[108:123]
    v_mfma_f32_32x32x16_bf16 v[124:139], v[28:31], v[20:23], v[124:139]
    v_mfma_f32_32x32x16_bf16 v[140:155], v[32:35], v[20:23], v[140:155]
    v_mfma_f32_32x32x16_bf16 v[156:171], v[28:31], v[24:27], v[156:171]
    v_mfma_f32_32x32x16_bf16 v[172:187], v[32:35], v[24:27], v[172:187]
    s_waitcnt vmcnt(10) lgkmcnt(0)
    s_barrier
    ds_read_b64_tr_b16 v[28:29], v4 offset:50176
    ds_read_b64_tr_b16 v[30:31], v4 offset:51200
    ds_read_b128 v[12:15], v2 offset:33792
    ds_read_b64_tr_b16 v[32:33], v6 offset:50176
    ds_read_b64_tr_b16 v[34:35], v6 offset:51200
    ds_read_b128 v[16:19], v2 offset:35840
    ds_read_b128 v[20:23], v2 offset:37888
    ds_read_b128 v[24:27], v2 offset:39936
    v_mfma_f32_32x32x16_bf16 v[60:75], v[52:55], v[36:39], v[60:75]
    buffer_load_dwordx2 v[196:197], v192, s[20:23], s38 offen
    v_mfma_f32_32x32x16_bf16 v[76:91], v[56:59], v[36:39], v[76:91]
    buffer_load_dwordx2 v[198:199], v192, s[20:23], s38 offen offset:16
    v_mfma_f32_32x32x16_bf16 v[92:107], v[52:55], v[40:43], v[92:107]
    buffer_load_dwordx4 v[204:207], v193, s[24:27], 0 offen offset:0
    v_mfma_f32_32x32x16_bf16 v[108:123], v[56:59], v[40:43], v[108:123]
    v_mfma_f32_32x32x16_bf16 v[124:139], v[52:55], v[44:47], v[124:139]
    buffer_load_dwordx4 v[208:211], v193, s[24:27], 0 offen offset:32
    v_mfma_f32_32x32x16_bf16 v[140:155], v[56:59], v[44:47], v[140:155]
    buffer_load_dwordx4 v[212:215], v193, s[24:27], 0 offen offset:2048
    v_mfma_f32_32x32x16_bf16 v[156:171], v[52:55], v[48:51], v[156:171]
    buffer_load_dwordx4 v[216:219], v193, s[24:27], 0 offen offset:2080
    v_mfma_f32_32x32x16_bf16 v[172:187], v[56:59], v[48:51], v[172:187]
    ds_read_b64_tr_b16 v[52:53], v4 offset:52224
    ds_read_b64_tr_b16 v[54:55], v4 offset:53248
    ds_read_b128 v[36:39], v2 offset:34816
    ds_read_b64_tr_b16 v[56:57], v6 offset:52224
    ds_read_b64_tr_b16 v[58:59], v6 offset:53248
    ds_read_b128 v[40:43], v2 offset:36864
    ds_read_b128 v[44:47], v2 offset:38912
    ds_read_b128 v[48:51], v2 offset:40960
    s_waitcnt lgkmcnt(8)
    v_mfma_f32_32x32x16_bf16 v[60:75], v[28:31], v[12:15], v[60:75]
    v_mfma_f32_32x32x16_bf16 v[76:91], v[32:35], v[12:15], v[76:91]
    v_mfma_f32_32x32x16_bf16 v[92:107], v[28:31], v[16:19], v[92:107]
    v_mfma_f32_32x32x16_bf16 v[108:123], v[32:35], v[16:19], v[108:123]
    v_mfma_f32_32x32x16_bf16 v[124:139], v[28:31], v[20:23], v[124:139]
    v_mfma_f32_32x32x16_bf16 v[140:155], v[32:35], v[20:23], v[140:155]
    v_mfma_f32_32x32x16_bf16 v[156:171], v[28:31], v[24:27], v[156:171]
    v_mfma_f32_32x32x16_bf16 v[172:187], v[32:35], v[24:27], v[172:187]
    s_waitcnt vmcnt(12) lgkmcnt(0)
    s_barrier
    ds_read_b64_tr_b16 v[28:29], v5 offset:17408
    ds_read_b64_tr_b16 v[30:31], v5 offset:18432
    ds_read_b128 v[12:15], v3 offset:1024
    ds_read_b64_tr_b16 v[32:33], v7 offset:17408
    ds_read_b64_tr_b16 v[34:35], v7 offset:18432
    ds_read_b128 v[16:19], v3 offset:3072
    ds_read_b128 v[20:23], v3 offset:5120
    ds_read_b128 v[24:27], v3 offset:7168
    v_mfma_f32_32x32x16_bf16 v[60:75], v[52:55], v[36:39], v[60:75]
    v_mfma_f32_32x32x16_bf16 v[76:91], v[56:59], v[36:39], v[76:91]
    v_mfma_f32_32x32x16_bf16 v[92:107], v[52:55], v[40:43], v[92:107]
    v_mfma_f32_32x32x16_bf16 v[108:123], v[56:59], v[40:43], v[108:123]
    v_mfma_f32_32x32x16_bf16 v[124:139], v[52:55], v[44:47], v[124:139]
    v_mfma_f32_32x32x16_bf16 v[140:155], v[56:59], v[44:47], v[140:155]
    v_mfma_f32_32x32x16_bf16 v[156:171], v[52:55], v[48:51], v[156:171]
    v_mfma_f32_32x32x16_bf16 v[172:187], v[56:59], v[48:51], v[172:187]
    ds_read_b64_tr_b16 v[52:53], v5 offset:19456
    ds_read_b64_tr_b16 v[54:55], v5 offset:20480
    ds_read_b128 v[36:39], v3 offset:2048
    ds_read_b64_tr_b16 v[56:57], v7 offset:19456
    ds_read_b64_tr_b16 v[58:59], v7 offset:20480
    ds_read_b128 v[40:43], v3 offset:4096
    ds_read_b128 v[44:47], v3 offset:6144
    ds_read_b128 v[48:51], v3 offset:8192
    s_waitcnt lgkmcnt(8)
    v_mfma_f32_32x32x16_bf16 v[60:75], v[28:31], v[12:15], v[60:75]
    v_mfma_f32_32x32x16_bf16 v[76:91], v[32:35], v[12:15], v[76:91]
    v_mfma_f32_32x32x16_bf16 v[92:107], v[28:31], v[16:19], v[92:107]
    v_mfma_f32_32x32x16_bf16 v[108:123], v[32:35], v[16:19], v[108:123]
    v_mfma_f32_32x32x16_bf16 v[124:139], v[28:31], v[20:23], v[124:139]
    v_mfma_f32_32x32x16_bf16 v[140:155], v[32:35], v[20:23], v[140:155]
    v_mfma_f32_32x32x16_bf16 v[156:171], v[28:31], v[24:27], v[156:171]
    v_mfma_f32_32x32x16_bf16 v[172:187], v[32:35], v[24:27], v[172:187]
    s_waitcnt vmcnt(8) lgkmcnt(0)
    s_barrier
    ds_read_b64_tr_b16 v[28:29], v5 offset:50176
    ds_read_b64_tr_b16 v[30:31], v5 offset:51200
    ds_read_b128 v[12:15], v3 offset:33792
    ds_read_b64_tr_b16 v[32:33], v7 offset:50176
    ds_read_b64_tr_b16 v[34:35], v7 offset:51200
    ds_read_b128 v[16:19], v3 offset:35840
    ds_read_b128 v[20:23], v3 offset:37888
    ds_read_b128 v[24:27], v3 offset:39936
    v_mfma_f32_32x32x16_bf16 v[60:75], v[52:55], v[36:39], v[60:75]
    v_mfma_f32_32x32x16_bf16 v[76:91], v[56:59], v[36:39], v[76:91]
    v_mfma_f32_32x32x16_bf16 v[92:107], v[52:55], v[40:43], v[92:107]
    v_mfma_f32_32x32x16_bf16 v[108:123], v[56:59], v[40:43], v[108:123]
    v_mfma_f32_32x32x16_bf16 v[124:139], v[52:55], v[44:47], v[124:139]
    v_mfma_f32_32x32x16_bf16 v[140:155], v[56:59], v[44:47], v[140:155]
    v_mfma_f32_32x32x16_bf16 v[156:171], v[52:55], v[48:51], v[156:171]
    v_mfma_f32_32x32x16_bf16 v[172:187], v[56:59], v[48:51], v[172:187]
    ds_read_b64_tr_b16 v[52:53], v5 offset:52224
    ds_read_b64_tr_b16 v[54:55], v5 offset:53248
    ds_read_b128 v[36:39], v3 offset:34816
    ds_read_b64_tr_b16 v[56:57], v7 offset:52224
    ds_read_b64_tr_b16 v[58:59], v7 offset:53248
    ds_read_b128 v[40:43], v3 offset:36864
    ds_read_b128 v[44:47], v3 offset:38912
    ds_read_b128 v[48:51], v3 offset:40960
    s_waitcnt lgkmcnt(8)
    v_mfma_f32_32x32x16_bf16 v[60:75], v[28:31], v[12:15], v[60:75]
    v_mfma_f32_32x32x16_bf16 v[76:91], v[32:35], v[12:15], v[76:91]
    v_mfma_f32_32x32x16_bf16 v[92:107], v[28:31], v[16:19], v[92:107]
    v_mfma_f32_32x32x16_bf16 v[108:123], v[32:35], v[16:19], v[108:123]
    v_mfma_f32_32x32x16_bf16 v[124:139], v[28:31], v[20:23], v[124:139]
    v_mfma_f32_32x32x16_bf16 v[140:155], v[32:35], v[20:23], v[140:155]
    v_mfma_f32_32x32x16_bf16 v[156:171], v[28:31], v[24:27], v[156:171]
    v_mfma_f32_32x32x16_bf16 v[172:187], v[32:35], v[24:27], v[172:187]
    s_waitcnt lgkmcnt(0)
    v_mfma_f32_32x32x16_bf16 v[60:75], v[52:55], v[36:39], v[60:75]
    v_mfma_f32_32x32x16_bf16 v[76:91], v[56:59], v[36:39], v[76:91]
    v_mfma_f32_32x32x16_bf16 v[92:107], v[52:55], v[40:43], v[92:107]
    v_mfma_f32_32x32x16_bf16 v[108:123], v[56:59], v[40:43], v[108:123]
    v_mfma_f32_32x32x16_bf16 v[124:139], v[52:55], v[44:47], v[124:139]
    v_mfma_f32_32x32x16_bf16 v[140:155], v[56:59], v[44:47], v[140:155]
    v_mfma_f32_32x32x16_bf16 v[156:171], v[52:55], v[48:51], v[156:171]
    v_mfma_f32_32x32x16_bf16 v[172:187], v[56:59], v[48:51], v[172:187]
    s_nop 7
    s_nop 7
    s_waitcnt vmcnt(0)
    v_cvt_pk_bf16_f32 v12, v60, v61
    v_cvt_pk_bf16_f32 v13, v62, v63
    v_cvt_pk_bf16_f32 v14, v64, v65
    v_cvt_pk_bf16_f32 v15, v66, v67
    v_cvt_pk_bf16_f32 v16, v68, v69
    v_cvt_pk_bf16_f32 v17, v70, v71
    v_cvt_pk_bf16_f32 v18, v72, v73
    v_cvt_pk_bf16_f32 v19, v74, v75
    buffer_store_dwordx4 v[12:15], v1, s[52:55], s36 offen offset:0 sc0 sc1
    buffer_store_dwordx4 v[16:19], v1, s[52:55], s36 offen offset:1024 sc0 sc1
    v_cvt_pk_bf16_f32 v20, v76, v77
    v_cvt_pk_bf16_f32 v21, v78, v79
    v_cvt_pk_bf16_f32 v22, v80, v81
    v_cvt_pk_bf16_f32 v23, v82, v83
    v_cvt_pk_bf16_f32 v24, v84, v85
    v_cvt_pk_bf16_f32 v25, v86, v87
    v_cvt_pk_bf16_f32 v26, v88, v89
    v_cvt_pk_bf16_f32 v27, v90, v91
    buffer_store_dwordx4 v[20:23], v1, s[52:55], s36 offen offset:2048 sc0 sc1
    buffer_store_dwordx4 v[24:27], v1, s[52:55], s36 offen offset:3072 sc0 sc1
    s_add_u32 s36, s36, 8192
    v_cvt_pk_bf16_f32 v28, v92, v93
    v_cvt_pk_bf16_f32 v29, v94, v95
    v_cvt_pk_bf16_f32 v30, v96, v97
    v_cvt_pk_bf16_f32 v31, v98, v99
    v_cvt_pk_bf16_f32 v32, v100, v101
    v_cvt_pk_bf16_f32 v33, v102, v103
    v_cvt_pk_bf16_f32 v34, v104, v105
    v_cvt_pk_bf16_f32 v35, v106, v107
    buffer_store_dwordx4 v[28:31], v1, s[52:55], s36 offen offset:0 sc0 sc1
    buffer_store_dwordx4 v[32:35], v1, s[52:55], s36 offen offset:1024 sc0 sc1
    v_cvt_pk_bf16_f32 v36, v108, v109
    v_cvt_pk_bf16_f32 v37, v110, v111
    v_cvt_pk_bf16_f32 v38, v112, v113
    v_cvt_pk_bf16_f32 v39, v114, v115
    v_cvt_pk_bf16_f32 v40, v116, v117
    v_cvt_pk_bf16_f32 v41, v118, v119
    v_cvt_pk_bf16_f32 v42, v120, v121
    v_cvt_pk_bf16_f32 v43, v122, v123
    buffer_store_dwordx4 v[36:39], v1, s[52:55], s36 offen offset:2048 sc0 sc1
    buffer_store_dwordx4 v[40:43], v1, s[52:55], s36 offen offset:3072 sc0 sc1
    s_add_u32 s36, s36, 8192
    v_cvt_pk_bf16_f32 v12, v124, v125
    v_cvt_pk_bf16_f32 v13, v126, v127
    v_cvt_pk_bf16_f32 v14, v128, v129
    v_cvt_pk_bf16_f32 v15, v130, v131
    v_cvt_pk_bf16_f32 v16, v132, v133
    v_cvt_pk_bf16_f32 v17, v134, v135
    v_cvt_pk_bf16_f32 v18, v136, v137
    v_cvt_pk_bf16_f32 v19, v138, v139
    buffer_store_dwordx4 v[12:15], v1, s[52:55], s36 offen offset:0 sc0 sc1
    buffer_store_dwordx4 v[16:19], v1, s[52:55], s36 offen offset:1024 sc0 sc1
    v_cvt_pk_bf16_f32 v20, v140, v141
    v_cvt_pk_bf16_f32 v21, v142, v143
    v_cvt_pk_bf16_f32 v22, v144, v145
    v_cvt_pk_bf16_f32 v23, v146, v147
    v_cvt_pk_bf16_f32 v24, v148, v149
    v_cvt_pk_bf16_f32 v25, v150, v151
    v_cvt_pk_bf16_f32 v26, v152, v153
    v_cvt_pk_bf16_f32 v27, v154, v155
    buffer_store_dwordx4 v[20:23], v1, s[52:55], s36 offen offset:2048 sc0 sc1
    buffer_store_dwordx4 v[24:27], v1, s[52:55], s36 offen offset:3072 sc0 sc1
    s_add_u32 s36, s36, 8192
    v_cvt_pk_bf16_f32 v28, v156, v157
    v_cvt_pk_bf16_f32 v29, v158, v159
    v_cvt_pk_bf16_f32 v30, v160, v161
    v_cvt_pk_bf16_f32 v31, v162, v163
    v_cvt_pk_bf16_f32 v32, v164, v165
    v_cvt_pk_bf16_f32 v33, v166, v167
    v_cvt_pk_bf16_f32 v34, v168, v169
    v_cvt_pk_bf16_f32 v35, v170, v171
    buffer_store_dwordx4 v[28:31], v1, s[52:55], s36 offen offset:0 sc0 sc1
    buffer_store_dwordx4 v[32:35], v1, s[52:55], s36 offen offset:1024 sc0 sc1
    v_cvt_pk_bf16_f32 v36, v172, v173
    v_cvt_pk_bf16_f32 v37, v174, v175
    v_cvt_pk_bf16_f32 v38, v176, v177
    v_cvt_pk_bf16_f32 v39, v178, v179
    v_cvt_pk_bf16_f32 v40, v180, v181
    v_cvt_pk_bf16_f32 v41, v182, v183
    v_cvt_pk_bf16_f32 v42, v184, v185
    v_cvt_pk_bf16_f32 v43, v186, v187
    buffer_store_dwordx4 v[36:39], v1, s[52:55], s36 offen offset:2048 sc0 sc1
    buffer_store_dwordx4 v[40:43], v1, s[52:55], s36 offen offset:3072 sc0 sc1
    s_add_u32 s36, s36, 8192
    s_branch kv_ln
kv_v:
    s_lshl_b32 s37, s37, 13
    s_add_u32 s36, s36, s37
    s_add_u32 s52, s6, 33554432
    s_addc_u32 s53, s7, 0
    s_mov_b32 s54, 16777216
    s_mov_b32 s55, 0x00020000
    s_waitcnt vmcnt(12)
    s_barrier
    ds_read_b64_tr_b16 v[28:29], v4 offset:17408
    ds_read_b64_tr_b16 v[30:31], v4 offset:18432
    ds_read_b128 v[12:15], v2 offset:1024
    ds_read_b64_tr_b16 v[32:33], v6 offset:17408
    ds_read_b64_tr_b16 v[34:35], v6 offset:18432
    ds_read_b128 v[16:19], v2 offset:3072
    ds_read_b128 v[20:23], v2 offset:5120
    ds_read_b128 v[24:27], v2 offset:7168
    ds_read_b64_tr_b16 v[52:53], v4 offset:19456
    ds_read_b64_tr_b16 v[54:55], v4 offset:20480
    ds_read_b128 v[36:39], v2 offset:2048
    ds_read_b64_tr_b16 v[56:57], v6 offset:19456
    ds_read_b64_tr_b16 v[58:59], v6 offset:20480
    ds_read_b128 v[40:43], v2 offset:4096
    ds_read_b128 v[44:47], v2 offset:6144
    ds_read_b128 v[48:51], v2 offset:8192
    s_waitcnt lgkmcnt(8)
    v_mfma_f32_32x32x16_bf16 v[60:75], v[12:15], v[28:31], 0
    v_mfma_f32_32x32x16_bf16 v[76:91], v[12:15], v[32:35], 0
    v_mfma_f32_32x32x16_bf16 v[92:107], v[16:19], v[28:31], 0
    v_mfma_f32_32x32x16_bf16 v[108:123], v[16:19], v[32:35], 0
    v_mfma_f32_32x32x16_bf16 v[124:139], v[20:23], v[28:31], 0
    v_mfma_f32_32x32x16_bf16 v[140:155], v[20:23], v[32:35], 0
    v_mfma_f32_32x32x16_bf16 v[156:171], v[24:27], v[28:31], 0
    v_mfma_f32_32x32x16_bf16 v[172:187], v[24:27], v[32:35], 0
    s_waitcnt vmcnt(8) lgkmcnt(0)
    s_barrier
    ds_read_b64_tr_b16 v[28:29], v4 offset:50176
    ds_read_b64_tr_b16 v[30:31], v4 offset:51200
    ds_read_b128 v[12:15], v2 offset:33792
    ds_read_b64_tr_b16 v[32:33], v6 offset:50176
    ds_read_b64_tr_b16 v[34:35], v6 offset:51200
    ds_read_b128 v[16:19], v2 offset:35840
    ds_read_b128 v[20:23], v2 offset:37888
    ds_read_b128 v[24:27], v2 offset:39936
    v_mfma_f32_32x32x16_bf16 v[60:75], v[36:39], v[52:55], v[60:75]
    s_add_u32 m0, s44, 1024
    s_nop 0
    buffer_load_dwordx4 v1, s[12:15], s46 offen offset:0 lds
    v_mfma_f32_32x32x16_bf16 v[76:91], v[36:39], v[56:59], v[76:91]
    v_mfma_f32_32x32x16_bf16 v[92:107], v[40:43], v[52:55], v[92:107]
    buffer_load_dwordx4 v1, s[12:15], s46 offen offset:1024 lds
    s_add_u32 s46, s46, 2048
    s_cmp_eq_u32 s46, s60
    s_cselect_b32 s46, s62, s46
    v_mfma_f32_32x32x16_bf16 v[108:123], v[40:43], v[56:59], v[108:123]
    v_mfma_f32_32x32x16_bf16 v[124:139], v[44:47], v[52:55], v[124:139]
    s_add_u32 m0, s45, 1024
    s_nop 0
    buffer_load_dwordx4 v8, s[16:19], s47 offen offset:0 lds
    v_mfma_f32_32x32x16_bf16 v[140:155], v[44:47], v[56:59], v[140:155]
    v_mfma_f32_32x32x16_bf16 v[156:171], v[48:51], v[52:55], v[156:171]
    buffer_load_dwordx4 v9, s[16:19], s47 offen offset:1024 lds
    s_add_u32 s47, s47, 262144
    s_cmp_eq_u32 s47, s61
    s_cselect_b32 s47, s63, s47
    v_mfma_f32_32x32x16_bf16 v[172:187], v[48:51], v[56:59], v[172:187]
    ds_read_b64_tr_b16 v[52:53], v4 offset:52224
    ds_read_b64_tr_b16 v[54:55], v4 offset:53248
    ds_read_b128 v[36:39], v2 offset:34816
    ds_read_b64_tr_b16 v[56:57], v6 offset:52224
    ds_read_b64_tr_b16 v[58:59], v6 offset:53248
    ds_read_b128 v[40:43], v2 offset:36864
    ds_read_b128 v[44:47], v2 offset:38912
    ds_read_b128 v[48:51], v2 offset:40960
    s_waitcnt lgkmcnt(8)
    v_mfma_f32_32x32x16_bf16 v[60:75], v[12:15], v[28:31], v[60:75]
    v_mfma_f32_32x32x16_bf16 v[76:91], v[12:15], v[32:35], v[76:91]
    v_mfma_f32_32x32x16_bf16 v[92:107], v[16:19], v[28:31], v[92:107]
    v_mfma_f32_32x32x16_bf16 v[108:123], v[16:19], v[32:35], v[108:123]
    v_mfma_f32_32x32x16_bf16 v[124:139], v[20:23], v[28:31], v[124:139]
    v_mfma_f32_32x32x16_bf16 v[140:155], v[20:23], v[32:35], v[140:155]
    v_mfma_f32_32x32x16_bf16 v[156:171], v[24:27], v[28:31], v[156:171]
    v_mfma_f32_32x32x16_bf16 v[172:187], v[24:27], v[32:35], v[172:187]
    s_waitcnt vmcnt(8) lgkmcnt(0)
    s_barrier
    ds_read_b64_tr_b16 v[28:29], v5 offset:17408
    ds_read_b64_tr_b16 v[30:31], v5 offset:18432
    ds_read_b128 v[12:15], v3 offset:1024
    ds_read_b64_tr_b16 v[32:33], v7 offset:17408
    ds_read_b64_tr_b16 v[34:35], v7 offset:18432
    ds_read_b128 v[16:19], v3 offset:3072
    ds_read_b128 v[20:23], v3 offset:5120
    ds_read_b128 v[24:27], v3 offset:7168
    v_mfma_f32_32x32x16_bf16 v[60:75], v[36:39], v[52:55], v[60:75]
    s_add_u32 m0, s44, 33792
    s_nop 0
    buffer_load_dwordx4 v1, s[12:15], s46 offen offset:0 lds
    v_mfma_f32_32x32x16_bf16 v[76:91], v[36:39], v[56:59], v[76:91]
    v_mfma_f32_32x32x16_bf16 v[92:107], v[40:43], v[52:55], v[92:107]
    buffer_load_dwordx4 v1, s[12:15], s46 offen offset:1024 lds
    s_add_u32 s46, s46, 2048
    s_cmp_eq_u32 s46, s60
    s_cselect_b32 s46, s62, s46
    v_mfma_f32_32x32x16_bf16 v[108:123], v[40:43], v[56:59], v[108:123]
    v_mfma_f32_32x32x16_bf16 v[124:139], v[44:47], v[52:55], v[124:139]
    s_add_u32 m0, s45, 33792
    s_nop 0
    buffer_load_dwordx4 v8, s[16:19], s47 offen offset:0 lds
    v_mfma_f32_32x32x16_bf16 v[140:155], v[44:47], v[56:59], v[140:155]
    v_mfma_f32_32x32x16_bf16 v[156:171], v[48:51], v[52:55], v[156:171]
    buffer_load_dwordx4 v9, s[16:19], s47 offen offset:1024 lds
    s_add_u32 s47, s47, 262144
    s_cmp_eq_u32 s47, s61
    s_cselect_b32 s47, s63, s47
    v_mfma_f32_32x32x16_bf16 v[172:187], v[48:51], v[56:59], v[172:187]
    ds_read_b64_tr_b16 v[52:53], v5 offset:19456
    ds_read_b64_tr_b16 v[54:55], v5 offset:20480
    ds_read_b128 v[36:39], v3 offset:2048
    ds_read_b64_tr_b16 v[56:57], v7 offset:19456
    ds_read_b64_tr_b16 v[58:59], v7 offset:20480
    ds_read_b128 v[40:43], v3 offset:4096
    ds_read_b128 v[44:47], v3 offset:6144
    ds_read_b128 v[48:51], v3 offset:8192
    s_waitcnt lgkmcnt(8)
    v_mfma_f32_32x32x16_bf16 v[60:75], v[12:15], v[28:31], v[60:75]
    v_mfma_f32_32x32x16_bf16 v[76:91], v[12:15], v[32:35], v[76:91]
    v_mfma_f32_32x32x16_bf16 v[92:107], v[16:19], v[28:31], v[92:107]
    v_mfma_f32_32x32x16_bf16 v[108:123], v[16:19], v[32:35], v[108:123]
    v_mfma_f32_32x32x16_bf16 v[124:139], v[20:23], v[28:31], v[124:139]
    v_mfma_f32_32x32x16_bf16 v[140:155], v[20:23], v[32:35], v[140:155]
    v_mfma_f32_32x32x16_bf16 v[156:171], v[24:27], v[28:31], v[156:171]
    v_mfma_f32_32x32x16_bf16 v[172:187], v[24:27], v[32:35], v[172:187]
    s_waitcnt vmcnt(8) lgkmcnt(0)
    s_barrier
    ds_read_b64_tr_b16 v[28:29], v5 offset:50176
    ds_read_b64_tr_b16 v[30:31], v5 offset:51200
    ds_read_b128 v[12:15], v3 offset:33792
    ds_read_b64_tr_b16 v[32:33], v7 offset:50176
    ds_read_b64_tr_b16 v[34:35], v7 offset:51200
    ds_read_b128 v[16:19], v3 offset:35840
    ds_read_b128 v[20:23], v3 offset:37888
    ds_read_b128 v[24:27], v3 offset:39936
    v_mfma_f32_32x32x16_bf16 v[60:75], v[36:39], v[52:55], v[60:75]
    s_add_u32 m0, s44, 66560
    s_nop 0
    buffer_load_dwordx4 v1, s[12:15], s46 offen offset:0 lds
    v_mfma_f32_32x32x16_bf16 v[76:91], v[36:39], v[56:59], v[76:91]
    v_mfma_f32_32x32x16_bf16 v[92:107], v[40:43], v[52:55], v[92:107]
    buffer_load_dwordx4 v1, s[12:15], s46 offen offset:1024 lds
    s_add_u32 s46, s46, 2048
    s_cmp_eq_u32 s46, s60
    s_cselect_b32 s46, s62, s46
    v_mfma_f32_32x32x16_bf16 v[108:123], v[40:43], v[56:59], v[108:123]
    v_mfma_f32_32x32x16_bf16 v[124:139], v[44:47], v[52:55], v[124:139]
    s_add_u32 m0, s45, 66560
    s_nop 0
    buffer_load_dwordx4 v8, s[16:19], s47 offen offset:0 lds
    v_mfma_f32_32x32x16_bf16 v[140:155], v[44:47], v[56:59], v[140:155]
    v_mfma_f32_32x32x16_bf16 v[156:171], v[48:51], v[52:55], v[156:171]
    buffer_load_dwordx4 v9, s[16:19], s47 offen offset:1024 lds
    s_add_u32 s47, s47, 262144
    s_cmp_eq_u32 s47, s61
    s_cselect_b32 s47, s63, s47
    v_mfma_f32_32x32x16_bf16 v[172:187], v[48:51], v[56:59], v[172:187]
    ds_read_b64_tr_b16 v[52:53], v5 offset:52224
    ds_read_b64_tr_b16 v[54:55], v5 offset:53248
    ds_read_b128 v[36:39], v3 offset:34816
    ds_read_b64_tr_b16 v[56:57], v7 offset:52224
    ds_read_b64_tr_b16 v[58:59], v7 offset:53248
    ds_read_b128 v[40:43], v3 offset:36864
    ds_read_b128 v[44:47], v3 offset:38912
    ds_read_b128 v[48:51], v3 offset:40960
    s_waitcnt lgkmcnt(8)
    v_mfma_f32_32x32x16_bf16 v[60:75], v[12:15], v[28:31], v[60:75]
    v_mfma_f32_32x32x16_bf16 v[76:91], v[12:15], v[32:35], v[76:91]
    v_mfma_f32_32x32x16_bf16 v[92:107], v[16:19], v[28:31], v[92:107]
    v_mfma_f32_32x32x16_bf16 v[108:123], v[16:19], v[32:35], v[108:123]
    v_mfma_f32_32x32x16_bf16 v[124:139], v[20:23], v[28:31], v[124:139]
    v_mfma_f32_32x32x16_bf16 v[140:155], v[20:23], v[32:35], v[140:155]
    v_mfma_f32_32x32x16_bf16 v[156:171], v[24:27], v[28:31], v[156:171]
    v_mfma_f32_32x32x16_bf16 v[172:187], v[24:27], v[32:35], v[172:187]
    s_waitcnt vmcnt(8) lgkmcnt(0)
    s_barrier
    ds_read_b64_tr_b16 v[28:29], v4 offset:17408
    ds_read_b64_tr_b16 v[30:31], v4 offset:18432
    ds_read_b128 v[12:15], v2 offset:1024
    ds_read_b64_tr_b16 v[32:33], v6 offset:17408
    ds_read_b64_tr_b16 v[34:35], v6 offset:18432
    ds_read_b128 v[16:19], v2 offset:3072
    ds_read_b128 v[20:23], v2 offset:5120
    ds_read_b128 v[24:27], v2 offset:7168
    v_mfma_f32_32x32x16_bf16 v[60:75], v[36:39], v[52:55], v[60:75]
    s_add_u32 m0, s44, 99328
    s_nop 0
    buffer_load_dwordx4 v1, s[12:15], s46 offen offset:0 lds
    v_mfma_f32_32x32x16_bf16 v[76:91], v[36:39], v[56:59], v[76:91]
    v_mfma_f32_32x32x16_bf16 v[92:107], v[40:43], v[52:55], v[92:107]
    buffer_load_dwordx4 v1, s[12:15], s46 offen offset:1024 lds
    s_add_u32 s46, s46, 2048
    s_cmp_eq_u32 s46, s60
    s_cselect_b32 s46, s62, s46
    v_mfma_f32_32x32x16_bf16 v[108:123], v[40:43], v[56:59], v[108:123]
    v_mfma_f32_32x32x16_bf16 v[124:139], v[44:47], v[52:55], v[124:139]
    s_add_u32 m0, s45, 99328
    s_nop 0
    buffer_load_dwordx4 v8, s[16:19], s47 offen offset:0 lds
    v_mfma_f32_32x32x16_bf16 v[140:155], v[44:47], v[56:59], v[140:155]
    v_mfma_f32_32x32x16_bf16 v[156:171], v[48:51], v[52:55], v[156:171]
    buffer_load_dwordx4 v9, s[16:19], s47 offen offset:1024 lds
    s_add_u32 s47, s47, 262144
    s_cmp_eq_u32 s47, s61
    s_cselect_b32 s47, s63, s47
    v_mfma_f32_32x32x16_bf16 v[172:187], v[48:51], v[56:59], v[172:187]
    ds_read_b64_tr_b16 v[52:53], v4 offset:19456
    ds_read_b64_tr_b16 v[54:55], v4 offset:20480
    ds_read_b128 v[36:39], v2 offset:2048
    ds_read_b64_tr_b16 v[56:57], v6 offset:19456
    ds_read_b64_tr_b16 v[58:59], v6 offset:20480
    ds_read_b128 v[40:43], v2 offset:4096
    ds_read_b128 v[44:47], v2 offset:6144
    ds_read_b128 v[48:51], v2 offset:8192
    s_waitcnt lgkmcnt(8)
    v_mfma_f32_32x32x16_bf16 v[60:75], v[12:15], v[28:31], v[60:75]
    v_mfma_f32_32x32x16_bf16 v[76:91], v[12:15], v[32:35], v[76:91]
    v_mfma_f32_32x32x16_bf16 v[92:107], v[16:19], v[28:31], v[92:107]
    v_mfma_f32_32x32x16_bf16 v[108:123], v[16:19], v[32:35], v[108:123]
    v_mfma_f32_32x32x16_bf16 v[124:139], v[20:23], v[28:31], v[124:139]
    v_mfma_f32_32x32x16_bf16 v[140:155], v[20:23], v[32:35], v[140:155]
    v_mfma_f32_32x32x16_bf16 v[156:171], v[24:27], v[28:31], v[156:171]
    v_mfma_f32_32x32x16_bf16 v[172:187], v[24:27], v[32:35], v[172:187]
    s_waitcnt vmcnt(8) lgkmcnt(0)
    s_barrier
    ds_read_b64_tr_b16 v[28:29], v4 offset:50176
    ds_read_b64_tr_b16 v[30:31], v4 offset:51200
    ds_read_b128 v[12:15], v2 offset:33792
    ds_read_b64_tr_b16 v[32:33], v6 offset:50176
    ds_read_b64_tr_b16 v[34:35], v6 offset:51200
    ds_read_b128 v[16:19], v2 offset:35840
    ds_read_b128 v[20:23], v2 offset:37888
    ds_read_b128 v[24:27], v2 offset:39936
    v_mfma_f32_32x32x16_bf16 v[60:75], v[36:39], v[52:55], v[60:75]
    s_add_u32 m0, s44, 1024
    s_nop 0
    buffer_load_dwordx4 v1, s[12:15], s46 offen offset:0 lds
    v_mfma_f32_32x32x16_bf16 v[76:91], v[36:39], v[56:59], v[76:91]
    v_mfma_f32_32x32x16_bf16 v[92:107], v[40:43], v[52:55], v[92:107]
    buffer_load_dwordx4 v1, s[12:15], s46 offen offset:1024 lds
    s_add_u32 s46, s46, 2048
    s_cmp_eq_u32 s46, s60
    s_cselect_b32 s46, s62, s46
    v_mfma_f32_32x32x16_bf16 v[108:123], v[40:43], v[56:59], v[108:123]
    v_mfma_f32_32x32x16_bf16 v[124:139], v[44:47], v[52:55], v[124:139]
    s_add_u32 m0, s45, 1024
    s_nop 0
    buffer_load_dwordx4 v8, s[16:19], s47 offen offset:0 lds
    v_mfma_f32_32x32x16_bf16 v[140:155], v[44:47], v[56:59], v[140:155]
    v_mfma_f32_32x32x16_bf16 v[156:171], v[48:51], v[52:55], v[156:171]
    buffer_load_dwordx4 v9, s[16:19], s47 offen offset:1024 lds
    s_add_u32 s47, s47, 262144
    s_cmp_eq_u32 s47, s61
    s_cselect_b32 s47, s63, s47
    v_mfma_f32_32x32x16_bf16 v[172:187], v[48:51], v[56:59], v[172:187]
    ds_read_b64_tr_b16 v[52:53], v4 offset:52224
    ds_read_b64_tr_b16 v[54:55], v4 offset:53248
    ds_read_b128 v[36:39], v2 offset:34816
    ds_read_b64_tr_b16 v[56:57], v6 offset:52224
    ds_read_b64_tr_b16 v[58:59], v6 offset:53248
    ds_read_b128 v[40:43], v2 offset:36864
    ds_read_b128 v[44:47], v2 offset:38912
    ds_read_b128 v[48:51], v2 offset:40960
    s_waitcnt lgkmcnt(8)
    v_mfma_f32_32x32x16_bf16 v[60:75], v[12:15], v[28:31], v[60:75]
    v_mfma_f32_32x32x16_bf16 v[76:91], v[12:15], v[32:35], v[76:91]
    v_mfma_f32_32x32x16_bf16 v[92:107], v[16:19], v[28:31], v[92:107]
    v_mfma_f32_32x32x16_bf16 v[108:123], v[16:19], v[32:35], v[108:123]
    v_mfma_f32_32x32x16_bf16 v[124:139], v[20:23], v[28:31], v[124:139]
    v_mfma_f32_32x32x16_bf16 v[140:155], v[20:23], v[32:35], v[140:155]
    v_mfma_f32_32x32x16_bf16 v[156:171], v[24:27], v[28:31], v[156:171]
    v_mfma_f32_32x32x16_bf16 v[172:187], v[24:27], v[32:35], v[172:187]
    s_waitcnt vmcnt(8) lgkmcnt(0)
    s_barrier
    ds_read_b64_tr_b16 v[28:29], v5 offset:17408
    ds_read_b64_tr_b16 v[30:31], v5 offset:18432
    ds_read_b128 v[12:15], v3 offset:1024
    ds_read_b64_tr_b16 v[32:33], v7 offset:17408
    ds_read_b64_tr_b16 v[34:35], v7 offset:18432
    ds_read_b128 v[16:19], v3 offset:3072
    ds_read_b128 v[20:23], v3 offset:5120
    ds_read_b128 v[24:27], v3 offset:7168
    v_mfma_f32_32x32x16_bf16 v[60:75], v[36:39], v[52:55], v[60:75]
    s_add_u32 m0, s44, 33792
    s_nop 0
    buffer_load_dwordx4 v1, s[12:15], s46 offen offset:0 lds
    v_mfma_f32_32x32x16_bf16 v[76:91], v[36:39], v[56:59], v[76:91]
    v_mfma_f32_32x32x16_bf16 v[92:107], v[40:43], v[52:55], v[92:107]
    buffer_load_dwordx4 v1, s[12:15], s46 offen offset:1024 lds
    s_add_u32 s46, s46, 2048
    s_cmp_eq_u32 s46, s60
    s_cselect_b32 s46, s62, s46
    v_mfma_f32_32x32x16_bf16 v[108:123], v[40:43], v[56:59], v[108:123]
    v_mfma_f32_32x32x16_bf16 v[124:139], v[44:47], v[52:55], v[124:139]
    s_add_u32 m0, s45, 33792
    s_nop 0
    buffer_load_dwordx4 v8, s[16:19], s47 offen offset:0 lds
    v_mfma_f32_32x32x16_bf16 v[140:155], v[44:47], v[56:59], v[140:155]
    v_mfma_f32_32x32x16_bf16 v[156:171], v[48:51], v[52:55], v[156:171]
    buffer_load_dwordx4 v9, s[16:19], s47 offen offset:1024 lds
    s_add_u32 s47, s47, 262144
    s_cmp_eq_u32 s47, s61
    s_cselect_b32 s47, s63, s47
    v_mfma_f32_32x32x16_bf16 v[172:187], v[48:51], v[56:59], v[172:187]
    ds_read_b64_tr_b16 v[52:53], v5 offset:19456
    ds_read_b64_tr_b16 v[54:55], v5 offset:20480
    ds_read_b128 v[36:39], v3 offset:2048
    ds_read_b64_tr_b16 v[56:57], v7 offset:19456
    ds_read_b64_tr_b16 v[58:59], v7 offset:20480
    ds_read_b128 v[40:43], v3 offset:4096
    ds_read_b128 v[44:47], v3 offset:6144
    ds_read_b128 v[48:51], v3 offset:8192
    s_waitcnt lgkmcnt(8)
    v_mfma_f32_32x32x16_bf16 v[60:75], v[12:15], v[28:31], v[60:75]
    v_mfma_f32_32x32x16_bf16 v[76:91], v[12:15], v[32:35], v[76:91]
    v_mfma_f32_32x32x16_bf16 v[92:107], v[16:19], v[28:31], v[92:107]
    v_mfma_f32_32x32x16_bf16 v[108:123], v[16:19], v[32:35], v[108:123]
    v_mfma_f32_32x32x16_bf16 v[124:139], v[20:23], v[28:31], v[124:139]
    v_mfma_f32_32x32x16_bf16 v[140:155], v[20:23], v[32:35], v[140:155]
    v_mfma_f32_32x32x16_bf16 v[156:171], v[24:27], v[28:31], v[156:171]
    v_mfma_f32_32x32x16_bf16 v[172:187], v[24:27], v[32:35], v[172:187]
    s_waitcnt vmcnt(8) lgkmcnt(0)
    s_barrier
    ds_read_b64_tr_b16 v[28:29], v5 offset:50176
    ds_read_b64_tr_b16 v[30:31], v5 offset:51200
    ds_read_b128 v[12:15], v3 offset:33792
    ds_read_b64_tr_b16 v[32:33], v7 offset:50176
    ds_read_b64_tr_b16 v[34:35], v7 offset:51200
    ds_read_b128 v[16:19], v3 offset:35840
    ds_read_b128 v[20:23], v3 offset:37888
    ds_read_b128 v[24:27], v3 offset:39936
    v_mfma_f32_32x32x16_bf16 v[60:75], v[36:39], v[52:55], v[60:75]
    s_add_u32 m0, s44, 66560
    s_nop 0
    buffer_load_dwordx4 v1, s[12:15], s46 offen offset:0 lds
    v_mfma_f32_32x32x16_bf16 v[76:91], v[36:39], v[56:59], v[76:91]
    v_mfma_f32_32x32x16_bf16 v[92:107], v[40:43], v[52:55], v[92:107]
    buffer_load_dwordx4 v1, s[12:15], s46 offen offset:1024 lds
    s_add_u32 s46, s46, 2048
    s_cmp_eq_u32 s46, s60
    s_cselect_b32 s46, s62, s46
    v_mfma_f32_32x32x16_bf16 v[108:123], v[40:43], v[56:59], v[108:123]
    v_mfma_f32_32x32x16_bf16 v[124:139], v[44:47], v[52:55], v[124:139]
    s_add_u32 m0, s45, 66560
    s_nop 0
    buffer_load_dwordx4 v8, s[16:19], s47 offen offset:0 lds
    v_mfma_f32_32x32x16_bf16 v[140:155], v[44:47], v[56:59], v[140:155]
    v_mfma_f32_32x32x16_bf16 v[156:171], v[48:51], v[52:55], v[156:171]
    buffer_load_dwordx4 v9, s[16:19], s47 offen offset:1024 lds
    s_add_u32 s47, s47, 262144
    s_cmp_eq_u32 s47, s61
    s_cselect_b32 s47, s63, s47
    v_mfma_f32_32x32x16_bf16 v[172:187], v[48:51], v[56:59], v[172:187]
    ds_read_b64_tr_b16 v[52:53], v5 offset:52224
    ds_read_b64_tr_b16 v[54:55], v5 offset:53248
    ds_read_b128 v[36:39], v3 offset:34816
    ds_read_b64_tr_b16 v[56:57], v7 offset:52224
    ds_read_b64_tr_b16 v[58:59], v7 offset:53248
    ds_read_b128 v[40:43], v3 offset:36864
    ds_read_b128 v[44:47], v3 offset:38912
    ds_read_b128 v[48:51], v3 offset:40960
    s_waitcnt lgkmcnt(8)
    v_mfma_f32_32x32x16_bf16 v[60:75], v[12:15], v[28:31], v[60:75]
    v_mfma_f32_32x32x16_bf16 v[76:91], v[12:15], v[32:35], v[76:91]
    v_mfma_f32_32x32x16_bf16 v[92:107], v[16:19], v[28:31], v[92:107]
    v_mfma_f32_32x32x16_bf16 v[108:123], v[16:19], v[32:35], v[108:123]
    v_mfma_f32_32x32x16_bf16 v[124:139], v[20:23], v[28:31], v[124:139]
    v_mfma_f32_32x32x16_bf16 v[140:155], v[20:23], v[32:35], v[140:155]
    v_mfma_f32_32x32x16_bf16 v[156:171], v[24:27], v[28:31], v[156:171]
    v_mfma_f32_32x32x16_bf16 v[172:187], v[24:27], v[32:35], v[172:187]
    s_waitcnt vmcnt(8) lgkmcnt(0)
    s_barrier
    ds_read_b64_tr_b16 v[28:29], v4 offset:17408
    ds_read_b64_tr_b16 v[30:31], v4 offset:18432
    ds_read_b128 v[12:15], v2 offset:1024
    ds_read_b64_tr_b16 v[32:33], v6 offset:17408
    ds_read_b64_tr_b16 v[34:35], v6 offset:18432
    ds_read_b128 v[16:19], v2 offset:3072
    ds_read_b128 v[20:23], v2 offset:5120
    ds_read_b128 v[24:27], v2 offset:7168
    v_mfma_f32_32x32x16_bf16 v[60:75], v[36:39], v[52:55], v[60:75]
    s_add_u32 m0, s44, 99328
    s_nop 0
    buffer_load_dwordx4 v1, s[12:15], s46 offen offset:0 lds
    v_mfma_f32_32x32x16_bf16 v[76:91], v[36:39], v[56:59], v[76:91]
    v_mfma_f32_32x32x16_bf16 v[92:107], v[40:43], v[52:55], v[92:107]
    buffer_load_dwordx4 v1, s[12:15], s46 offen offset:1024 lds
    s_add_u32 s46, s46, 2048
    s_cmp_eq_u32 s46, s60
    s_cselect_b32 s46, s62, s46
    v_mfma_f32_32x32x16_bf16 v[108:123], v[40:43], v[56:59], v[108:123]
    v_mfma_f32_32x32x16_bf16 v[124:139], v[44:47], v[52:55], v[124:139]
    s_add_u32 m0, s45, 99328
    s_nop 0
    buffer_load_dwordx4 v8, s[16:19], s47 offen offset:0 lds
    v_mfma_f32_32x32x16_bf16 v[140:155], v[44:47], v[56:59], v[140:155]
    v_mfma_f32_32x32x16_bf16 v[156:171], v[48:51], v[52:55], v[156:171]
    buffer_load_dwordx4 v9, s[16:19], s47 offen offset:1024 lds
    s_add_u32 s47, s47, 262144
    s_cmp_eq_u32 s47, s61
    s_cselect_b32 s47, s63, s47
    v_mfma_f32_32x32x16_bf16 v[172:187], v[48:51], v[56:59], v[172:187]
    ds_read_b64_tr_b16 v[52:53], v4 offset:19456
    ds_read_b64_tr_b16 v[54:55], v4 offset:20480
    ds_read_b128 v[36:39], v2 offset:2048
    ds_read_b64_tr_b16 v[56:57], v6 offset:19456
    ds_read_b64_tr_b16 v[58:59], v6 offset:20480
    ds_read_b128 v[40:43], v2 offset:4096
    ds_read_b128 v[44:47], v2 offset:6144
    ds_read_b128 v[48:51], v2 offset:8192
    s_waitcnt lgkmcnt(8)
    v_mfma_f32_32x32x16_bf16 v[60:75], v[12:15], v[28:31], v[60:75]
    v_mfma_f32_32x32x16_bf16 v[76:91], v[12:15], v[32:35], v[76:91]
    v_mfma_f32_32x32x16_bf16 v[92:107], v[16:19], v[28:31], v[92:107]
    v_mfma_f32_32x32x16_bf16 v[108:123], v[16:19], v[32:35], v[108:123]
    v_mfma_f32_32x32x16_bf16 v[124:139], v[20:23], v[28:31], v[124:139]
    v_mfma_f32_32x32x16_bf16 v[140:155], v[20:23], v[32:35], v[140:155]
    v_mfma_f32_32x32x16_bf16 v[156:171], v[24:27], v[28:31], v[156:171]
    v_mfma_f32_32x32x16_bf16 v[172:187], v[24:27], v[32:35], v[172:187]
    s_waitcnt vmcnt(8) lgkmcnt(0)
    s_barrier
    ds_read_b64_tr_b16 v[28:29], v4 offset:50176
    ds_read_b64_tr_b16 v[30:31], v4 offset:51200
    ds_read_b128 v[12:15], v2 offset:33792
    ds_read_b64_tr_b16 v[32:33], v6 offset:50176
    ds_read_b64_tr_b16 v[34:35], v6 offset:51200
    ds_read_b128 v[16:19], v2 offset:35840
    ds_read_b128 v[20:23], v2 offset:37888
    ds_read_b128 v[24:27], v2 offset:39936
    v_mfma_f32_32x32x16_bf16 v[60:75], v[36:39], v[52:55], v[60:75]
    s_add_u32 m0, s44, 1024
    s_nop 0
    buffer_load_dwordx4 v1, s[12:15], s46 offen offset:0 lds
    v_mfma_f32_32x32x16_bf16 v[76:91], v[36:39], v[56:59], v[76:91]
    v_mfma_f32_32x32x16_bf16 v[92:107], v[40:43], v[52:55], v[92:107]
    buffer_load_dwordx4 v1, s[12:15], s46 offen offset:1024 lds
    s_add_u32 s46, s46, 2048
    s_cmp_eq_u32 s46, s60
    s_cselect_b32 s46, s62, s46
    v_mfma_f32_32x32x16_bf16 v[108:123], v[40:43], v[56:59], v[108:123]
    v_mfma_f32_32x32x16_bf16 v[124:139], v[44:47], v[52:55], v[124:139]
    s_add_u32 m0, s45, 1024
    s_nop 0
    buffer_load_dwordx4 v8, s[16:19], s47 offen offset:0 lds
    v_mfma_f32_32x32x16_bf16 v[140:155], v[44:47], v[56:59], v[140:155]
    v_mfma_f32_32x32x16_bf16 v[156:171], v[48:51], v[52:55], v[156:171]
    buffer_load_dwordx4 v9, s[16:19], s47 offen offset:1024 lds
    s_add_u32 s47, s47, 262144
    s_cmp_eq_u32 s47, s61
    s_cselect_b32 s47, s63, s47
    v_mfma_f32_32x32x16_bf16 v[172:187], v[48:51], v[56:59], v[172:187]
    ds_read_b64_tr_b16 v[52:53], v4 offset:52224
    ds_read_b64_tr_b16 v[54:55], v4 offset:53248
    ds_read_b128 v[36:39], v2 offset:34816
    ds_read_b64_tr_b16 v[56:57], v6 offset:52224
    ds_read_b64_tr_b16 v[58:59], v6 offset:53248
    ds_read_b128 v[40:43], v2 offset:36864
    ds_read_b128 v[44:47], v2 offset:38912
    ds_read_b128 v[48:51], v2 offset:40960
    s_waitcnt lgkmcnt(8)
    v_mfma_f32_32x32x16_bf16 v[60:75], v[12:15], v[28:31], v[60:75]
    v_mfma_f32_32x32x16_bf16 v[76:91], v[12:15], v[32:35], v[76:91]
    v_mfma_f32_32x32x16_bf16 v[92:107], v[16:19], v[28:31], v[92:107]
    v_mfma_f32_32x32x16_bf16 v[108:123], v[16:19], v[32:35], v[108:123]
    v_mfma_f32_32x32x16_bf16 v[124:139], v[20:23], v[28:31], v[124:139]
    v_mfma_f32_32x32x16_bf16 v[140:155], v[20:23], v[32:35], v[140:155]
    v_mfma_f32_32x32x16_bf16 v[156:171], v[24:27], v[28:31], v[156:171]
    v_mfma_f32_32x32x16_bf16 v[172:187], v[24:27], v[32:35], v[172:187]
    s_waitcnt vmcnt(8) lgkmcnt(0)
    s_barrier
    ds_read_b64_tr_b16 v[28:29], v5 offset:17408
    ds_read_b64_tr_b16 v[30:31], v5 offset:18432
    ds_read_b128 v[12:15], v3 offset:1024
    ds_read_b64_tr_b16 v[32:33], v7 offset:17408
    ds_read_b64_tr_b16 v[34:35], v7 offset:18432
    ds_read_b128 v[16:19], v3 offset:3072
    ds_read_b128 v[20:23], v3 offset:5120
    ds_read_b128 v[24:27], v3 offset:7168
    v_mfma_f32_32x32x16_bf16 v[60:75], v[36:39], v[52:55], v[60:75]
    s_add_u32 m0, s44, 33792
    s_nop 0
    buffer_load_dwordx4 v1, s[12:15], s46 offen offset:0 lds
    v_mfma_f32_32x32x16_bf16 v[76:91], v[36:39], v[56:59], v[76:91]
    v_mfma_f32_32x32x16_bf16 v[92:107], v[40:43], v[52:55], v[92:107]
    buffer_load_dwordx4 v1, s[12:15], s46 offen offset:1024 lds
    s_add_u32 s46, s46, 2048
    s_cmp_eq_u32 s46, s60
    s_cselect_b32 s46, s62, s46
    v_mfma_f32_32x32x16_bf16 v[108:123], v[40:43], v[56:59], v[108:123]
    v_mfma_f32_32x32x16_bf16 v[124:139], v[44:47], v[52:55], v[124:139]
    s_add_u32 m0, s45, 33792
    s_nop 0
    buffer_load_dwordx4 v8, s[16:19], s47 offen offset:0 lds
    v_mfma_f32_32x32x16_bf16 v[140:155], v[44:47], v[56:59], v[140:155]
    v_mfma_f32_32x32x16_bf16 v[156:171], v[48:51], v[52:55], v[156:171]
    buffer_load_dwordx4 v9, s[16:19], s47 offen offset:1024 lds
    s_add_u32 s47, s47, 262144
    s_cmp_eq_u32 s47, s61
    s_cselect_b32 s47, s63, s47
    v_mfma_f32_32x32x16_bf16 v[172:187], v[48:51], v[56:59], v[172:187]
    ds_read_b64_tr_b16 v[52:53], v5 offset:19456
    ds_read_b64_tr_b16 v[54:55], v5 offset:20480
    ds_read_b128 v[36:39], v3 offset:2048
    ds_read_b64_tr_b16 v[56:57], v7 offset:19456
    ds_read_b64_tr_b16 v[58:59], v7 offset:20480
    ds_read_b128 v[40:43], v3 offset:4096
    ds_read_b128 v[44:47], v3 offset:6144
    ds_read_b128 v[48:51], v3 offset:8192
    s_waitcnt lgkmcnt(8)
    v_mfma_f32_32x32x16_bf16 v[60:75], v[12:15], v[28:31], v[60:75]
    v_mfma_f32_32x32x16_bf16 v[76:91], v[12:15], v[32:35], v[76:91]
    v_mfma_f32_32x32x16_bf16 v[92:107], v[16:19], v[28:31], v[92:107]
    v_mfma_f32_32x32x16_bf16 v[108:123], v[16:19], v[32:35], v[108:123]
    v_mfma_f32_32x32x16_bf16 v[124:139], v[20:23], v[28:31], v[124:139]
    v_mfma_f32_32x32x16_bf16 v[140:155], v[20:23], v[32:35], v[140:155]
    v_mfma_f32_32x32x16_bf16 v[156:171], v[24:27], v[28:31], v[156:171]
    v_mfma_f32_32x32x16_bf16 v[172:187], v[24:27], v[32:35], v[172:187]
    s_waitcnt vmcnt(8) lgkmcnt(0)
    s_barrier
    ds_read_b64_tr_b16 v[28:29], v5 offset:50176
    ds_read_b64_tr_b16 v[30:31], v5 offset:51200
    ds_read_b128 v[12:15], v3 offset:33792
    ds_read_b64_tr_b16 v[32:33], v7 offset:50176
    ds_read_b64_tr_b16 v[34:35], v7 offset:51200
    ds_read_b128 v[16:19], v3 offset:35840
    ds_read_b128 v[20:23], v3 offset:37888
    ds_read_b128 v[24:27], v3 offset:39936
    v_mfma_f32_32x32x16_bf16 v[60:75], v[36:39], v[52:55], v[60:75]
    s_add_u32 m0, s44, 66560
    s_nop 0
    buffer_load_dwordx4 v1, s[12:15], s46 offen offset:0 lds
    v_mfma_f32_32x32x16_bf16 v[76:91], v[36:39], v[56:59], v[76:91]
    v_mfma_f32_32x32x16_bf16 v[92:107], v[40:43], v[52:55], v[92:107]
    buffer_load_dwordx4 v1, s[12:15], s46 offen offset:1024 lds
    s_add_u32 s46, s46, 2048
    s_cmp_eq_u32 s46, s60
    s_cselect_b32 s46, s62, s46
    v_mfma_f32_32x32x16_bf16 v[108:123], v[40:43], v[56:59], v[108:123]
    v_mfma_f32_32x32x16_bf16 v[124:139], v[44:47], v[52:55], v[124:139]
    s_add_u32 m0, s45, 66560
    s_nop 0
    buffer_load_dwordx4 v8, s[16:19], s47 offen offset:0 lds
    v_mfma_f32_32x32x16_bf16 v[140:155], v[44:47], v[56:59], v[140:155]
    v_mfma_f32_32x32x16_bf16 v[156:171], v[48:51], v[52:55], v[156:171]
    buffer_load_dwordx4 v9, s[16:19], s47 offen offset:1024 lds
    s_add_u32 s47, s47, 262144
    s_cmp_eq_u32 s47, s61
    s_cselect_b32 s47, s63, s47
    v_mfma_f32_32x32x16_bf16 v[172:187], v[48:51], v[56:59], v[172:187]
    ds_read_b64_tr_b16 v[52:53], v5 offset:52224
    ds_read_b64_tr_b16 v[54:55], v5 offset:53248
    ds_read_b128 v[36:39], v3 offset:34816
    ds_read_b64_tr_b16 v[56:57], v7 offset:52224
    ds_read_b64_tr_b16 v[58:59], v7 offset:53248
    ds_read_b128 v[40:43], v3 offset:36864
    ds_read_b128 v[44:47], v3 offset:38912
    ds_read_b128 v[48:51], v3 offset:40960
    s_waitcnt lgkmcnt(8)
    v_mfma_f32_32x32x16_bf16 v[60:75], v[12:15], v[28:31], v[60:75]
    v_mfma_f32_32x32x16_bf16 v[76:91], v[12:15], v[32:35], v[76:91]
    v_mfma_f32_32x32x16_bf16 v[92:107], v[16:19], v[28:31], v[92:107]
    v_mfma_f32_32x32x16_bf16 v[108:123], v[16:19], v[32:35], v[108:123]
    v_mfma_f32_32x32x16_bf16 v[124:139], v[20:23], v[28:31], v[124:139]
    v_mfma_f32_32x32x16_bf16 v[140:155], v[20:23], v[32:35], v[140:155]
    v_mfma_f32_32x32x16_bf16 v[156:171], v[24:27], v[28:31], v[156:171]
    v_mfma_f32_32x32x16_bf16 v[172:187], v[24:27], v[32:35], v[172:187]
    s_waitcnt vmcnt(8) lgkmcnt(0)
    s_barrier
    ds_read_b64_tr_b16 v[28:29], v4 offset:17408
    ds_read_b64_tr_b16 v[30:31], v4 offset:18432
    ds_read_b128 v[12:15], v2 offset:1024
    ds_read_b64_tr_b16 v[32:33], v6 offset:17408
    ds_read_b64_tr_b16 v[34:35], v6 offset:18432
    ds_read_b128 v[16:19], v2 offset:3072
    ds_read_b128 v[20:23], v2 offset:5120
    ds_read_b128 v[24:27], v2 offset:7168
    v_mfma_f32_32x32x16_bf16 v[60:75], v[36:39], v[52:55], v[60:75]
    s_add_u32 m0, s44, 99328
    s_nop 0
    buffer_load_dwordx4 v1, s[12:15], s46 offen offset:0 lds
    v_mfma_f32_32x32x16_bf16 v[76:91], v[36:39], v[56:59], v[76:91]
    buffer_load_dwordx4 v1, s[12:15], s46 offen offset:1024 lds
    s_add_u32 s46, s46, 2048
    s_cmp_eq_u32 s46, s60
    s_cselect_b32 s46, s62, s46
    v_mfma_f32_32x32x16_bf16 v[92:107], v[40:43], v[52:55], v[92:107]
    s_add_u32 m0, s45, 99328
    s_nop 0
    buffer_load_dwordx4 v8, s[16:19], s47 offen offset:0 lds
    v_mfma_f32_32x32x16_bf16 v[108:123], v[40:43], v[56:59], v[108:123]
    v_mfma_f32_32x32x16_bf16 v[124:139], v[44:47], v[52:55], v[124:139]
    buffer_load_dwordx4 v9, s[16:19], s47 offen offset:1024 lds
    s_add_u32 s47, s47, 262144
    s_cmp_eq_u32 s47, s61
    s_cselect_b32 s47, s63, s47
    v_mfma_f32_32x32x16_bf16 v[140:155], v[44:47], v[56:59], v[140:155]
    buffer_load_dwordx4 v[200:203], v1, s[56:59], s66 offen offset:0
    v_mfma_f32_32x32x16_bf16 v[156:171], v[48:51], v[52:55], v[156:171]
    buffer_load_dwordx4 v[200:203], v1, s[56:59], s66 offen offset:1024
    v_mfma_f32_32x32x16_bf16 v[172:187], v[48:51], v[56:59], v[172:187]
    ds_read_b64_tr_b16 v[52:53], v4 offset:19456
    ds_read_b64_tr_b16 v[54:55], v4 offset:20480
    ds_read_b128 v[36:39], v2 offset:2048
    ds_read_b64_tr_b16 v[56:57], v6 offset:19456
    ds_read_b64_tr_b16 v[58:59], v6 offset:20480
    ds_read_b128 v[40:43], v2 offset:4096
    ds_read_b128 v[44:47], v2 offset:6144
    ds_read_b128 v[48:51], v2 offset:8192
    s_waitcnt lgkmcnt(8)
    v_mfma_f32_32x32x16_bf16 v[60:75], v[12:15], v[28:31], v[60:75]
    v_mfma_f32_32x32x16_bf16 v[76:91], v[12:15], v[32:35], v[76:91]
    v_mfma_f32_32x32x16_bf16 v[92:107], v[16:19], v[28:31], v[92:107]
    v_mfma_f32_32x32x16_bf16 v[108:123], v[16:19], v[32:35], v[108:123]
    v_mfma_f32_32x32x16_bf16 v[124:139], v[20:23], v[28:31], v[124:139]
    v_mfma_f32_32x32x16_bf16 v[140:155], v[20:23], v[32:35], v[140:155]
    v_mfma_f32_32x32x16_bf16 v[156:171], v[24:27], v[28:31], v[156:171]
    v_mfma_f32_32x32x16_bf16 v[172:187], v[24:27], v[32:35], v[172:187]
    s_waitcnt vmcnt(10) lgkmcnt(0)
    s_barrier
    ds_read_b64_tr_b16 v[28:29], v4 offset:50176
    ds_read_b64_tr_b16 v[30:31], v4 offset:51200
    ds_read_b128 v[12:15], v2 offset:33792
    ds_read_b64_tr_b16 v[32:33], v6 offset:50176
    ds_read_b64_tr_b16 v[34:35], v6 offset:51200
    ds_read_b128 v[16:19], v2 offset:35840
    ds_read_b128 v[20:23], v2 offset:37888
    ds_read_b128 v[24:27], v2 offset:39936
    v_mfma_f32_32x32x16_bf16 v[60:75], v[36:39], v[52:55], v[60:75]
    buffer_load_dwordx2 v[196:197], v192, s[20:23], s38 offen
    v_mfma_f32_32x32x16_bf16 v[76:91], v[36:39], v[56:59], v[76:91]
    buffer_load_dwordx2 v[198:199], v192, s[20:23], s38 offen offset:16
    v_mfma_f32_32x32x16_bf16 v[92:107], v[40:43], v[52:55], v[92:107]
    buffer_load_dwordx4 v[204:207], v193, s[24:27], 0 offen offset:0
    v_mfma_f32_32x32x16_bf16 v[108:123], v[40:43], v[56:59], v[108:123]
    v_mfma_f32_32x32x16_bf16 v[124:139], v[44:47], v[52:55], v[124:139]
    buffer_load_dwordx4 v[208:211], v193, s[24:27], 0 offen offset:32
    v_mfma_f32_32x32x16_bf16 v[140:155], v[44:47], v[56:59], v[140:155]
    buffer_load_dwordx4 v[212:215], v193, s[24:27], 0 offen offset:2048
    v_mfma_f32_32x32x16_bf16 v[156:171], v[48:51], v[52:55], v[156:171]
    buffer_load_dwordx4 v[216:219], v193, s[24:27], 0 offen offset:2080
    v_mfma_f32_32x32x16_bf16 v[172:187], v[48:51], v[56:59], v[172:187]
    ds_read_b64_tr_b16 v[52:53], v4 offset:52224
    ds_read_b64_tr_b16 v[54:55], v4 offset:53248
    ds_read_b128 v[36:39], v2 offset:34816
    ds_read_b64_tr_b16 v[56:57], v6 offset:52224
    ds_read_b64_tr_b16 v[58:59], v6 offset:53248
    ds_read_b128 v[40:43], v2 offset:36864
    ds_read_b128 v[44:47], v2 offset:38912
    ds_read_b128 v[48:51], v2 offset:40960
    s_waitcnt lgkmcnt(8)
    v_mfma_f32_32x32x16_bf16 v[60:75], v[12:15], v[28:31], v[60:75]
    v_mfma_f32_32x32x16_bf16 v[76:91], v[12:15], v[32:35], v[76:91]
    v_mfma_f32_32x32x16_bf16 v[92:107], v[16:19], v[28:31], v[92:107]
    v_mfma_f32_32x32x16_bf16 v[108:123], v[16:19], v[32:35], v[108:123]
    v_mfma_f32_32x32x16_bf16 v[124:139], v[20:23], v[28:31], v[124:139]
    v_mfma_f32_32x32x16_bf16 v[140:155], v[20:23], v[32:35], v[140:155]
    v_mfma_f32_32x32x16_bf16 v[156:171], v[24:27], v[28:31], v[156:171]
    v_mfma_f32_32x32x16_bf16 v[172:187], v[24:27], v[32:35], v[172:187]
    s_waitcnt vmcnt(12) lgkmcnt(0)
    s_barrier
    ds_read_b64_tr_b16 v[28:29], v5 offset:17408
    ds_read_b64_tr_b16 v[30:31], v5 offset:18432
    ds_read_b128 v[12:15], v3 offset:1024
    ds_read_b64_tr_b16 v[32:33], v7 offset:17408
    ds_read_b64_tr_b16 v[34:35], v7 offset:18432
    ds_read_b128 v[16:19], v3 offset:3072
    ds_read_b128 v[20:23], v3 offset:5120
    ds_read_b128 v[24:27], v3 offset:7168
    v_mfma_f32_32x32x16_bf16 v[60:75], v[36:39], v[52:55], v[60:75]
    v_mfma_f32_32x32x16_bf16 v[76:91], v[36:39], v[56:59], v[76:91]
    v_mfma_f32_32x32x16_bf16 v[92:107], v[40:43], v[52:55], v[92:107]
    v_mfma_f32_32x32x16_bf16 v[108:123], v[40:43], v[56:59], v[108:123]
    v_mfma_f32_32x32x16_bf16 v[124:139], v[44:47], v[52:55], v[124:139]
    v_mfma_f32_32x32x16_bf16 v[140:155], v[44:47], v[56:59], v[140:155]
    v_mfma_f32_32x32x16_bf16 v[156:171], v[48:51], v[52:55], v[156:171]
    v_mfma_f32_32x32x16_bf16 v[172:187], v[48:51], v[56:59], v[172:187]
    ds_read_b64_tr_b16 v[52:53], v5 offset:19456
    ds_read_b64_tr_b16 v[54:55], v5 offset:20480
    ds_read_b128 v[36:39], v3 offset:2048
    ds_read_b64_tr_b16 v[56:57], v7 offset:19456
    ds_read_b64_tr_b16 v[58:59], v7 offset:20480
    ds_read_b128 v[40:43], v3 offset:4096
    ds_read_b128 v[44:47], v3 offset:6144
    ds_read_b128 v[48:51], v3 offset:8192
    s_waitcnt lgkmcnt(8)
    v_mfma_f32_32x32x16_bf16 v[60:75], v[12:15], v[28:31], v[60:75]
    v_mfma_f32_32x32x16_bf16 v[76:91], v[12:15], v[32:35], v[76:91]
    v_mfma_f32_32x32x16_bf16 v[92:107], v[16:19], v[28:31], v[92:107]
    v_mfma_f32_32x32x16_bf16 v[108:123], v[16:19], v[32:35], v[108:123]
    v_mfma_f32_32x32x16_bf16 v[124:139], v[20:23], v[28:31], v[124:139]
    v_mfma_f32_32x32x16_bf16 v[140:155], v[20:23], v[32:35], v[140:155]
    v_mfma_f32_32x32x16_bf16 v[156:171], v[24:27], v[28:31], v[156:171]
    v_mfma_f32_32x32x16_bf16 v[172:187], v[24:27], v[32:35], v[172:187]
    s_waitcnt vmcnt(8) lgkmcnt(0)
    s_barrier
    ds_read_b64_tr_b16 v[28:29], v5 offset:50176
    ds_read_b64_tr_b16 v[30:31], v5 offset:51200
    ds_read_b128 v[12:15], v3 offset:33792
    ds_read_b64_tr_b16 v[32:33], v7 offset:50176
    ds_read_b64_tr_b16 v[34:35], v7 offset:51200
    ds_read_b128 v[16:19], v3 offset:35840
    ds_read_b128 v[20:23], v3 offset:37888
    ds_read_b128 v[24:27], v3 offset:39936
    v_mfma_f32_32x32x16_bf16 v[60:75], v[36:39], v[52:55], v[60:75]
    v_mfma_f32_32x32x16_bf16 v[76:91], v[36:39], v[56:59], v[76:91]
    v_mfma_f32_32x32x16_bf16 v[92:107], v[40:43], v[52:55], v[92:107]
    v_mfma_f32_32x32x16_bf16 v[108:123], v[40:43], v[56:59], v[108:123]
    v_mfma_f32_32x32x16_bf16 v[124:139], v[44:47], v[52:55], v[124:139]
    v_mfma_f32_32x32x16_bf16 v[140:155], v[44:47], v[56:59], v[140:155]
    v_mfma_f32_32x32x16_bf16 v[156:171], v[48:51], v[52:55], v[156:171]
    v_mfma_f32_32x32x16_bf16 v[172:187], v[48:51], v[56:59], v[172:187]
    ds_read_b64_tr_b16 v[52:53], v5 offset:52224
    ds_read_b64_tr_b16 v[54:55], v5 offset:53248
    ds_read_b128 v[36:39], v3 offset:34816
    ds_read_b64_tr_b16 v[56:57], v7 offset:52224
    ds_read_b64_tr_b16 v[58:59], v7 offset:53248
    ds_read_b128 v[40:43], v3 offset:36864
    ds_read_b128 v[44:47], v3 offset:38912
    ds_read_b128 v[48:51], v3 offset:40960
    s_waitcnt lgkmcnt(8)
    v_mfma_f32_32x32x16_bf16 v[60:75], v[12:15], v[28:31], v[60:75]
    v_mfma_f32_32x32x16_bf16 v[76:91], v[12:15], v[32:35], v[76:91]
    v_mfma_f32_32x32x16_bf16 v[92:107], v[16:19], v[28:31], v[92:107]
    v_mfma_f32_32x32x16_bf16 v[108:123], v[16:19], v[32:35], v[108:123]
    v_mfma_f32_32x32x16_bf16 v[124:139], v[20:23], v[28:31], v[124:139]
    v_mfma_f32_32x32x16_bf16 v[140:155], v[20:23], v[32:35], v[140:155]
    v_mfma_f32_32x32x16_bf16 v[156:171], v[24:27], v[28:31], v[156:171]
    v_mfma_f32_32x32x16_bf16 v[172:187], v[24:27], v[32:35], v[172:187]
    s_waitcnt lgkmcnt(0)
    v_mfma_f32_32x32x16_bf16 v[60:75], v[36:39], v[52:55], v[60:75]
    v_mfma_f32_32x32x16_bf16 v[76:91], v[36:39], v[56:59], v[76:91]
    v_mfma_f32_32x32x16_bf16 v[92:107], v[40:43], v[52:55], v[92:107]
    v_mfma_f32_32x32x16_bf16 v[108:123], v[40:43], v[56:59], v[108:123]
    v_mfma_f32_32x32x16_bf16 v[124:139], v[44:47], v[52:55], v[124:139]
    v_mfma_f32_32x32x16_bf16 v[140:155], v[44:47], v[56:59], v[140:155]
    v_mfma_f32_32x32x16_bf16 v[156:171], v[48:51], v[52:55], v[156:171]
    v_mfma_f32_32x32x16_bf16 v[172:187], v[48:51], v[56:59], v[172:187]
    s_nop 7
    s_nop 7
    s_waitcnt vmcnt(0)
    v_cvt_pk_bf16_f32 v12, v60, v61
    v_cvt_pk_bf16_f32 v13, v62, v63
    v_cvt_pk_bf16_f32 v14, v64, v65
    v_cvt_pk_bf16_f32 v15, v66, v67
    v_cvt_pk_bf16_f32 v16, v68, v69
    v_cvt_pk_bf16_f32 v17, v70, v71
    v_cvt_pk_bf16_f32 v18, v72, v73
    v_cvt_pk_bf16_f32 v19, v74, v75
    buffer_store_dwordx4 v[12:15], v1, s[52:55], s36 offen offset:0 sc0 sc1
    buffer_store_dwordx4 v[16:19], v1, s[52:55], s36 offen offset:1024 sc0 sc1
    v_cvt_pk_bf16_f32 v20, v92, v93
    v_cvt_pk_bf16_f32 v21, v94, v95
    v_cvt_pk_bf16_f32 v22, v96, v97
    v_cvt_pk_bf16_f32 v23, v98, v99
    v_cvt_pk_bf16_f32 v24, v100, v101
    v_cvt_pk_bf16_f32 v25, v102, v103
    v_cvt_pk_bf16_f32 v26, v104, v105
    v_cvt_pk_bf16_f32 v27, v106, v107
    buffer_store_dwordx4 v[20:23], v1, s[52:55], s36 offen offset:2048 sc0 sc1
    buffer_store_dwordx4 v[24:27], v1, s[52:55], s36 offen offset:3072 sc0 sc1
    s_add_u32 s36, s36, 4096
    v_cvt_pk_bf16_f32 v28, v76, v77
    v_cvt_pk_bf16_f32 v29, v78, v79
    v_cvt_pk_bf16_f32 v30, v80, v81
    v_cvt_pk_bf16_f32 v31, v82, v83
    v_cvt_pk_bf16_f32 v32, v84, v85
    v_cvt_pk_bf16_f32 v33, v86, v87
    v_cvt_pk_bf16_f32 v34, v88, v89
    v_cvt_pk_bf16_f32 v35, v90, v91
    buffer_store_dwordx4 v[28:31], v1, s[52:55], s36 offen offset:0 sc0 sc1
    buffer_store_dwordx4 v[32:35], v1, s[52:55], s36 offen offset:1024 sc0 sc1
    v_cvt_pk_bf16_f32 v36, v108, v109
    v_cvt_pk_bf16_f32 v37, v110, v111
    v_cvt_pk_bf16_f32 v38, v112, v113
    v_cvt_pk_bf16_f32 v39, v114, v115
    v_cvt_pk_bf16_f32 v40, v116, v117
    v_cvt_pk_bf16_f32 v41, v118, v119
    v_cvt_pk_bf16_f32 v42, v120, v121
    v_cvt_pk_bf16_f32 v43, v122, v123
    buffer_store_dwordx4 v[36:39], v1, s[52:55], s36 offen offset:2048 sc0 sc1
    buffer_store_dwordx4 v[40:43], v1, s[52:55], s36 offen offset:3072 sc0 sc1
    s_add_u32 s36, s36, 12288
    v_cvt_pk_bf16_f32 v12, v124, v125
    v_cvt_pk_bf16_f32 v13, v126, v127
    v_cvt_pk_bf16_f32 v14, v128, v129
    v_cvt_pk_bf16_f32 v15, v130, v131
    v_cvt_pk_bf16_f32 v16, v132, v133
    v_cvt_pk_bf16_f32 v17, v134, v135
    v_cvt_pk_bf16_f32 v18, v136, v137
    v_cvt_pk_bf16_f32 v19, v138, v139
    buffer_store_dwordx4 v[12:15], v1, s[52:55], s36 offen offset:0 sc0 sc1
    buffer_store_dwordx4 v[16:19], v1, s[52:55], s36 offen offset:1024 sc0 sc1
    v_cvt_pk_bf16_f32 v20, v156, v157
    v_cvt_pk_bf16_f32 v21, v158, v159
    v_cvt_pk_bf16_f32 v22, v160, v161
    v_cvt_pk_bf16_f32 v23, v162, v163
    v_cvt_pk_bf16_f32 v24, v164, v165
    v_cvt_pk_bf16_f32 v25, v166, v167
    v_cvt_pk_bf16_f32 v26, v168, v169
    v_cvt_pk_bf16_f32 v27, v170, v171
    buffer_store_dwordx4 v[20:23], v1, s[52:55], s36 offen offset:2048 sc0 sc1
    buffer_store_dwordx4 v[24:27], v1, s[52:55], s36 offen offset:3072 sc0 sc1
    s_add_u32 s36, s36, 4096
    v_cvt_pk_bf16_f32 v28, v140, v141
    v_cvt_pk_bf16_f32 v29, v142, v143
    v_cvt_pk_bf16_f32 v30, v144, v145
    v_cvt_pk_bf16_f32 v31, v146, v147
    v_cvt_pk_bf16_f32 v32, v148, v149
    v_cvt_pk_bf16_f32 v33, v150, v151
    v_cvt_pk_bf16_f32 v34, v152, v153
    v_cvt_pk_bf16_f32 v35, v154, v155
    buffer_store_dwordx4 v[28:31], v1, s[52:55], s36 offen offset:0 sc0 sc1
    buffer_store_dwordx4 v[32:35], v1, s[52:55], s36 offen offset:1024 sc0 sc1
    v_cvt_pk_bf16_f32 v36, v172, v173
    v_cvt_pk_bf16_f32 v37, v174, v175
    v_cvt_pk_bf16_f32 v38, v176, v177
    v_cvt_pk_bf16_f32 v39, v178, v179
    v_cvt_pk_bf16_f32 v40, v180, v181
    v_cvt_pk_bf16_f32 v41, v182, v183
    v_cvt_pk_bf16_f32 v42, v184, v185
    v_cvt_pk_bf16_f32 v43, v186, v187
    buffer_store_dwordx4 v[36:39], v1, s[52:55], s36 offen offset:2048 sc0 sc1
    buffer_store_dwordx4 v[40:43], v1, s[52:55], s36 offen offset:3072 sc0 sc1
    s_add_u32 s36, s36, 12288
kv_ln:
    v_and_b32 v221, 0xffff0000, v196
    v_lshlrev_b32 v220, 16, v196
    v_and_b32 v223, 0xffff0000, v197
    v_lshlrev_b32 v222, 16, v197
    v_and_b32 v225, 0xffff0000, v198
    v_lshlrev_b32 v224, 16, v198
    v_and_b32 v227, 0xffff0000, v199
    v_lshlrev_b32 v226, 16, v199
    v_add_f32 v228, v220, v221
    v_mul_f32 v229, v220, v220
    v_fmac_f32 v229, v221, v221
    v_add_f32 v228, v228, v222
    v_fmac_f32 v229, v222, v222
    v_add_f32 v228, v228, v223
    v_fmac_f32 v229, v223, v223
    v_add_f32 v228, v228, v224
    v_fmac_f32 v229, v224, v224
    v_add_f32 v228, v228, v225
    v_fmac_f32 v229, v225, v225
    v_add_f32 v228, v228, v226
    v_fmac_f32 v229, v226, v226
    v_add_f32 v228, v228, v227
    v_fmac_f32 v229, v227, v227
    s_nop 1
    v_add_f32_dpp v228, v228, v228 row_ror:8 row_mask:0xf bank_mask:0xf
    v_add_f32_dpp v229, v229, v229 row_ror:8 row_mask:0xf bank_mask:0xf
    v_mov_b32 v230, v228
    v_mov_b32 v231, v229
    s_nop 1
    v_permlane16_swap_b32 v230, v228
    v_permlane16_swap_b32 v231, v229
    s_nop 1
    v_add_f32 v228, v228, v230
    v_add_f32 v229, v229, v231
    v_mov_b32 v230, v228
    v_mov_b32 v231, v229
    s_nop 1
    v_permlane32_swap_b32 v230, v228
    v_permlane32_swap_b32 v231, v229
    s_nop 1
    v_add_f32 v228, v228, v230
    v_add_f32 v229, v229, v231
    v_and_b32 v230, 7, v0
    v_mul_u32_u24 v230, 64, v230
    v_lshrrev_b32 v231, 6, v0
    v_lshl_add_u32 v231, v231, 3, v230
    ds_write_b64 v231, v[228:229] offset:0
    s_waitcnt lgkmcnt(0)
    s_barrier
    ds_read_b128 v[232:235], v230 offset:0
    ds_read_b128 v[236:239], v230 offset:16
    ds_read_b128 v[240:243], v230 offset:32
    ds_read_b128 v[244:247], v230 offset:48
    s_waitcnt lgkmcnt(0)
    v_add_f32 v228, v232, v234
    v_add_f32 v229, v233, v235
    v_add_f32 v228, v228, v236
    v_add_f32 v229, v229, v237
    v_add_f32 v228, v228, v238
    v_add_f32 v229, v229, v239
    v_add_f32 v228, v228, v240
    v_add_f32 v229, v229, v241
    v_add_f32 v228, v228, v242
    v_add_f32 v229, v229, v243
    v_add_f32 v228, v228, v244
    v_add_f32 v229, v229, v245
    v_add_f32 v228, v228, v246
    v_add_f32 v229, v229, v247
    v_mul_f32 v228, 0x3b000000, v228
    v_mul_f32 v229, 0x3b000000, v229
    v_fma_f32 v229, -v228, v228, v229
    v_max_f32 v229, 0, v229
    v_add_f32 v229, 0x3727c5ac, v229
    v_rsq_f32 v229, v229
    v_sub_f32 v220, v220, v228
    v_mul_f32 v212, v212, v229
    v_fma_f32 v220, v220, v212, v204
    v_sub_f32 v221, v221, v228
    v_mul_f32 v213, v213, v229
    v_fma_f32 v221, v221, v213, v205
    v_sub_f32 v222, v222, v228
    v_mul_f32 v214, v214, v229
    v_fma_f32 v222, v222, v214, v206
    v_sub_f32 v223, v223, v228
    v_mul_f32 v215, v215, v229
    v_fma_f32 v223, v223, v215, v207
    v_sub_f32 v224, v224, v228
    v_mul_f32 v216, v216, v229
    v_fma_f32 v224, v224, v216, v208
    v_sub_f32 v225, v225, v228
    v_mul_f32 v217, v217, v229
    v_fma_f32 v225, v225, v217, v209
    v_sub_f32 v226, v226, v228
    v_mul_f32 v218, v218, v229
    v_fma_f32 v226, v226, v218, v210
    v_sub_f32 v227, v227, v228
    v_mul_f32 v219, v219, v229
    v_fma_f32 v227, v227, v219, v211
    v_cvt_pk_bf16_f32 v196, v220, v221
    v_cvt_pk_bf16_f32 v197, v222, v223
    v_cvt_pk_bf16_f32 v198, v224, v225
    v_cvt_pk_bf16_f32 v199, v226, v227
    buffer_store_dwordx4 v[196:199], v191, s[28:31], s39 offen sc0 sc1
kv_end:
    s_endpgm
.text
.globl attn_kernel
.p2align 8
.type attn_kernel,@function
attn_kernel:
    s_load_dwordx2 s[8:9], s[0:1], 16
    s_load_dwordx2 s[6:7], s[0:1], 112
    s_load_dwordx2 s[90:91], s[0:1], 40
    s_load_dwordx4 s[92:95], s[0:1], 56
    s_load_dwordx2 s[10:11], s[0:1], 72
    s_cmp_ge_u32 s2, 256
    s_cbranch_scc1 at_end
    s_and_b32 s33, s2, 7
    s_lshl_b32 s33, s33, 2
    s_bfe_u32 s34, s2, 0x20003
    s_add_u32 s33, s33, s34
    s_lshr_b32 s34, s2, 5
    s_sub_u32 s35, 15, s34
    v_and_b32 v1, 63, v0
    v_lshrrev_b32 v2, 6, v0
    s_nop 0
    v_readfirstlane_b32 s40, v2
    v_lshrrev_b32 v8, 3, v1
    v_and_b32 v9, 7, v1
    v_bfe_u32 v10, v1, 4, 1
    v_lshrrev_b32 v11, 2, v9
    v_xor_b32 v10, v10, v11
    v_and_b32 v9, 3, v9
    v_mul_u32_u24 v8, 8192, v8
    v_lshl_add_u32 v8, v10, 6, v8
    v_lshl_add_u32 v8, v9, 4, v8
    s_lshr_b32 s41, s40, 1
    s_and_b32 s42, s40, 1
    v_lshrrev_b32 v4, 5, v1
    v_lshlrev_b32 v4, 9, v4
    v_bfe_u32 v5, v1, 2, 2
    v_lshl_add_u32 v4, v5, 7, v4
    v_bfe_u32 v5, v1, 4, 1
    v_lshl_add_u32 v4, v5, 5, v4
    v_and_b32 v5, 3, v1
    v_lshl_add_u32 v4, v5, 3, v4
    v_bfe_u32 v5, v1, 3, 1
    v_lshl_add_u32 v4, v5, 6, v4
    v_lshlrev_b32 v1, 4, v1
    s_mul_i32 s43, s41, 4096
    s_add_u32 s43, s43, 65536
    v_add_u32 v2, s43, v1
    v_add_u32 v3, 0x10000, v2
    v_add_u32 v4, 65536, v4
    s_mul_i32 s43, s42, 4096
    v_add_u32 v4, s43, v4
    v_xor_b32 v6, 64, v4
    v_add_u32 v5, 0x10000, v4
    v_add_u32 v7, 0x10000, v6
    s_mul_i32 s44, s40, 2048
    s_mul_i32 s45, s40, 1024
    s_add_u32 s45, s45, 81920
    s_add_u32 s44, s44, 65536
    s_waitcnt lgkmcnt(0)
    s_mov_b32 s16, s8
    s_mov_b32 s17, s9
    s_mov_b32 s18, 4194304
    s_mov_b32 s19, 0x00020000
    s_add_u32 s12, s6, 3145728
    s_addc_u32 s13, s7, 0
    s_mov_b32 s14, 2097152
    s_mov_b32 s15, 0x00020000
    s_cmp_eq_u32 s42, 0
    s_cselect_b32 s46, s35, s34
    s_lshl_b32 s46, s46, 2
    s_add_u32 s46, s46, s41
    s_lshl_b32 s46, s46, 15
    s_lshl_b32 s47, s33, 8
    s_lshr_b32 s36, s40, 2
    s_lshl_b32 s36, s36, 7
    s_add_u32 s47, s47, s36
    s_and_b32 s36, s40, 3
    s_lshl_b32 s36, s36, 16
    s_add_u32 s47, s47, s36
    s_mov_b32 s64, 0
    s_mov_b32 s62, s46
    s_mov_b32 s63, s47
    s_add_u32 s60, s46, 32768
    s_add_u32 s61, s47, 4194304
    s_mul_i32 s65, s64, 2048
    s_add_u32 s46, s46, s65
    s_mul_i32 s65, s64, 262144
    s_add_u32 s47, s47, s65
    s_add_u32 m0, s44, 0
    s_nop 0
    buffer_load_dwordx4 v1, s[12:15], s46 offen offset:0 lds
    buffer_load_dwordx4 v1, s[12:15], s46 offen offset:1024 lds
    s_add_u32 s46, s46, 2048
    s_cmp_eq_u32 s46, s60
    s_cselect_b32 s46, s62, s46
    s_add_u32 m0, s45, 0
    s_nop 0
    buffer_load_dwordx4 v8, s[16:19], s47 offen offset:0 lds
    s_add_u32 s47, s47, 262144
    s_cmp_eq_u32 s47, s61
    s_cselect_b32 s47, s63, s47
    s_add_u32 m0, s44, 24576
    s_nop 0
    buffer_load_dwordx4 v1, s[12:15], s46 offen offset:0 lds
    buffer_load_dwordx4 v1, s[12:15], s46 offen offset:1024 lds
    s_add_u32 s46, s46, 2048
    s_cmp_eq_u32 s46, s60
    s_cselect_b32 s46, s62, s46
    s_add_u32 m0, s45, 24576
    s_nop 0
    buffer_load_dwordx4 v8, s[16:19], s47 offen offset:0 lds
    s_add_u32 s47, s47, 262144
    s_cmp_eq_u32 s47, s61
    s_cselect_b32 s47, s63, s47
    s_add_u32 m0, s44, 49152
    s_nop 0
    buffer_load_dwordx4 v1, s[12:15], s46 offen offset:0 lds
    buffer_load_dwordx4 v1, s[12:15], s46 offen offset:1024 lds
    s_add_u32 s46, s46, 2048
    s_cmp_eq_u32 s46, s60
    s_cselect_b32 s46, s62, s46
    s_add_u32 m0, s45, 49152
    s_nop 0
    buffer_load_dwordx4 v8, s[16:19], s47 offen offset:0 lds
    s_add_u32 s47, s47, 262144
    s_cmp_eq_u32 s47, s61
    s_cselect_b32 s47, s63, s47
    s_add_u32 m0, s44, 73728
    s_nop 0
    buffer_load_dwordx4 v1, s[12:15], s46 offen offset:0 lds
    buffer_load_dwordx4 v1, s[12:15], s46 offen offset:1024 lds
    s_add_u32 s46, s46, 2048
    s_cmp_eq_u32 s46, s60
    s_cselect_b32 s46, s62, s46
    s_add_u32 m0, s45, 73728
    s_nop 0
    buffer_load_dwordx4 v8, s[16:19], s47 offen offset:0 lds
    s_add_u32 s47, s47, 262144
    s_cmp_eq_u32 s47, s61
    s_cselect_b32 s47, s63, s47
    s_add_u32 s24, s6, 16777216
    s_addc_u32 s25, s7, 0
    s_mov_b32 s26, 16777216
    s_mov_b32 s27, 0x00020000
    s_add_u32 s28, s6, 33554432
    s_addc_u32 s29, s7, 0
    s_mov_b32 s30, 16777216
    s_mov_b32 s31, 0x00020000
    s_add_u32 s20, s6, 50331648
    s_addc_u32 s21, s7, 0
    s_mov_b32 s22, 16777216
    s_mov_b32 s23, 0x00020000
    s_lshl_b32 s36, s40, 12
    s_add_u32 s36, s36, 0x18000
    v_add_u32 v110, s36, v1
    s_and_b32 s41, s40, 3
    s_lshr_b32 s42, s40, 2
    s_lshl_b32 s57, s40, 12
    s_lshl_b32 s49, s33, 19
    s_add_u32 s49, s49, s57
    s_mov_b32 s58, s49
    s_mov_b32 s59, s49
    s_add_u32 s48, s35, 1
    s_lshl_b32 s48, s48, 15
    s_add_u32 s48, s48, s49
    s_lshl_b32 s36, s41, 18
    s_lshl_b32 s37, s33, 13
    s_add_u32 s36, s36, s37
    s_lshl_b32 s37, s42, 12
    s_add_u32 s36, s36, s37
    s_lshl_b32 s52, s35, 20
    s_add_u32 s52, s52, s36
    s_lshl_b32 s53, s34, 20
    s_add_u32 s53, s53, s36
    s_mov_b32 s54, 0
    s_mov_b32 s55, s35
    s_sub_u32 s56, s35, 1
    s_mov_b32 s50, 0x41f00000
    v_mov_b32 v176, 0
    v_mov_b32 v177, 0
    v_mov_b32 v178, 0
    v_mov_b32 v179, 0
    v_mov_b32 v180, 0
    v_mov_b32 v181, 0
    v_mov_b32 v182, 0
    v_mov_b32 v183, 0
    v_mov_b32 v184, 0
    v_mov_b32 v185, 0
    v_mov_b32 v186, 0
    v_mov_b32 v187, 0
    v_mov_b32 v188, 0
    v_mov_b32 v189, 0
    v_mov_b32 v190, 0
    v_mov_b32 v191, 0
    v_mov_b32 v192, 0
    v_mov_b32 v193, 0
    v_mov_b32 v194, 0
    v_mov_b32 v195, 0
    v_mov_b32 v196, 0
    v_mov_b32 v197, 0
    v_mov_b32 v198, 0
    v_mov_b32 v199, 0
    v_mov_b32 v200, 0
    v_mov_b32 v201, 0
    v_mov_b32 v202, 0
    v_mov_b32 v203, 0
    v_mov_b32 v204, 0
    v_mov_b32 v205, 0
    v_mov_b32 v206, 0
    v_mov_b32 v207, 0
    v_mov_b32 v208, 0
    v_mov_b32 v209, 0
    v_mov_b32 v210, 0
    v_mov_b32 v211, 0
    v_mov_b32 v212, 0
    v_mov_b32 v213, 0
    v_mov_b32 v214, 0
    v_mov_b32 v215, 0
    v_mov_b32 v216, 0
    v_mov_b32 v217, 0
    v_mov_b32 v218, 0
    v_mov_b32 v219, 0
    v_mov_b32 v220, 0
    v_mov_b32 v221, 0
    v_mov_b32 v222, 0
    v_mov_b32 v223, 0
    v_mov_b32 v224, 0
    v_mov_b32 v225, 0
    v_mov_b32 v226, 0
    v_mov_b32 v227, 0
    v_mov_b32 v228, 0
    v_mov_b32 v229, 0
    v_mov_b32 v230, 0
    v_mov_b32 v231, 0
    v_mov_b32 v232, 0
    v_mov_b32 v233, 0
    v_mov_b32 v234, 0
    v_mov_b32 v235, 0
    v_mov_b32 v236, 0
    v_mov_b32 v237, 0
    v_mov_b32 v238, 0
    v_mov_b32 v239, 0
    s_waitcnt vmcnt(9)
    s_barrier
    ds_read_b64_tr_b16 v[20:21], v4 offset:16384
    ds_read_b64_tr_b16 v[22:23], v4 offset:17408
    ds_read_b128 v[12:15], v2 offset:0
    ds_read_b64_tr_b16 v[24:25], v6 offset:16384
    ds_read_b64_tr_b16 v[26:27], v6 offset:17408
    ds_read_b128 v[16:19], v2 offset:2048
    ds_read_b64_tr_b16 v[36:37], v4 offset:18432
    ds_read_b64_tr_b16 v[38:39], v4 offset:19456
    ds_read_b128 v[28:31], v2 offset:1024
    ds_read_b64_tr_b16 v[40:41], v6 offset:18432
    ds_read_b64_tr_b16 v[42:43], v6 offset:19456
    ds_read_b128 v[32:35], v2 offset:3072
    s_waitcnt lgkmcnt(6)
    v_mfma_f32_32x32x16_bf16 v[44:59], v[20:23], v[12:15], 0
    v_mfma_f32_32x32x16_bf16 v[60:75], v[24:27], v[12:15], 0
    v_mfma_f32_32x32x16_bf16 v[76:91], v[20:23], v[16:19], 0
    v_mfma_f32_32x32x16_bf16 v[92:107], v[24:27], v[16:19], 0
    s_waitcnt vmcnt(6) lgkmcnt(0)
    s_barrier
    ds_read_b64_tr_b16 v[20:21], v4 offset:40960
    ds_read_b64_tr_b16 v[22:23], v4 offset:41984
    ds_read_b128 v[12:15], v2 offset:24576
    ds_read_b64_tr_b16 v[24:25], v6 offset:40960
    ds_read_b64_tr_b16 v[26:27], v6 offset:41984
    ds_read_b128 v[16:19], v2 offset:26624
    v_mfma_f32_32x32x16_bf16 v[44:59], v[36:39], v[28:31], v[44:59]
    s_add_u32 m0, s44, 0
    s_nop 0
    buffer_load_dwordx4 v1, s[12:15], s46 offen offset:0 lds
    v_mfma_f32_32x32x16_bf16 v[60:75], v[40:43], v[28:31], v[60:75]
    buffer_load_dwordx4 v1, s[12:15], s46 offen offset:1024 lds
    s_add_u32 s46, s46, 2048
    s_cmp_eq_u32 s46, s60
    s_cselect_b32 s46, s62, s46
    v_mfma_f32_32x32x16_bf16 v[76:91], v[36:39], v[32:35], v[76:91]
    s_add_u32 m0, s45, 0
    s_nop 0
    buffer_load_dwordx4 v8, s[16:19], s47 offen offset:0 lds
    s_add_u32 s47, s47, 262144
    s_cmp_eq_u32 s47, s61
    s_cselect_b32 s47, s63, s47
    v_mfma_f32_32x32x16_bf16 v[92:107], v[40:43], v[32:35], v[92:107]
    ds_read_b64_tr_b16 v[36:37], v4 offset:43008
    ds_read_b64_tr_b16 v[38:39], v4 offset:44032
    ds_read_b128 v[28:31], v2 offset:25600
    ds_read_b64_tr_b16 v[40:41], v6 offset:43008
    ds_read_b64_tr_b16 v[42:43], v6 offset:44032
    ds_read_b128 v[32:35], v2 offset:27648
    s_waitcnt lgkmcnt(6)
    v_mfma_f32_32x32x16_bf16 v[44:59], v[20:23], v[12:15], v[44:59]
    v_mfma_f32_32x32x16_bf16 v[60:75], v[24:27], v[12:15], v[60:75]
    v_mfma_f32_32x32x16_bf16 v[76:91], v[20:23], v[16:19], v[76:91]
    v_mfma_f32_32x32x16_bf16 v[92:107], v[24:27], v[16:19], v[92:107]
    s_waitcnt vmcnt(6) lgkmcnt(0)
    s_barrier
    ds_read_b64_tr_b16 v[20:21], v5 offset:0
    ds_read_b64_tr_b16 v[22:23], v5 offset:1024
    ds_read_b128 v[12:15], v2 offset:49152
    ds_read_b64_tr_b16 v[24:25], v7 offset:0
    ds_read_b64_tr_b16 v[26:27], v7 offset:1024
    ds_read_b128 v[16:19], v2 offset:51200
    v_mfma_f32_32x32x16_bf16 v[44:59], v[36:39], v[28:31], v[44:59]
    s_add_u32 m0, s44, 24576
    s_nop 0
    buffer_load_dwordx4 v1, s[12:15], s46 offen offset:0 lds
    v_mfma_f32_32x32x16_bf16 v[60:75], v[40:43], v[28:31], v[60:75]
    buffer_load_dwordx4 v1, s[12:15], s46 offen offset:1024 lds
    s_add_u32 s46, s46, 2048
    s_cmp_eq_u32 s46, s60
    s_cselect_b32 s46, s62, s46
    v_mfma_f32_32x32x16_bf16 v[76:91], v[36:39], v[32:35], v[76:91]
    s_add_u32 m0, s45, 24576
    s_nop 0
    buffer_load_dwordx4 v8, s[16:19], s47 offen offset:0 lds
    s_add_u32 s47, s47, 262144
    s_cmp_eq_u32 s47, s61
    s_cselect_b32 s47, s63, s47
    v_mfma_f32_32x32x16_bf16 v[92:107], v[40:43], v[32:35], v[92:107]
    ds_read_b64_tr_b16 v[36:37], v5 offset:2048
    ds_read_b64_tr_b16 v[38:39], v5 offset:3072
    ds_read_b128 v[28:31], v2 offset:50176
    ds_read_b64_tr_b16 v[40:41], v7 offset:2048
    ds_read_b64_tr_b16 v[42:43], v7 offset:3072
    ds_read_b128 v[32:35], v2 offset:52224
    s_waitcnt lgkmcnt(6)
    v_mfma_f32_32x32x16_bf16 v[44:59], v[20:23], v[12:15], v[44:59]
    v_mfma_f32_32x32x16_bf16 v[60:75], v[24:27], v[12:15], v[60:75]
    v_mfma_f32_32x32x16_bf16 v[76:91], v[20:23], v[16:19], v[76:91]
    v_mfma_f32_32x32x16_bf16 v[92:107], v[24:27], v[16:19], v[92:107]
    s_waitcnt vmcnt(6) lgkmcnt(0)
    s_barrier
    ds_read_b64_tr_b16 v[20:21], v5 offset:24576
    ds_read_b64_tr_b16 v[22:23], v5 offset:25600
    ds_read_b128 v[12:15], v3 offset:8192
    ds_read_b64_tr_b16 v[24:25], v7 offset:24576
    ds_read_b64_tr_b16 v[26:27], v7 offset:25600
    ds_read_b128 v[16:19], v3 offset:10240
    v_mfma_f32_32x32x16_bf16 v[44:59], v[36:39], v[28:31], v[44:59]
    s_add_u32 m0, s44, 49152
    s_nop 0
    buffer_load_dwordx4 v1, s[12:15], s46 offen offset:0 lds
    v_mfma_f32_32x32x16_bf16 v[60:75], v[40:43], v[28:31], v[60:75]
    buffer_load_dwordx4 v1, s[12:15], s46 offen offset:1024 lds
    s_add_u32 s46, s46, 2048
    s_cmp_eq_u32 s46, s60
    s_cselect_b32 s46, s62, s46
    v_mfma_f32_32x32x16_bf16 v[76:91], v[36:39], v[32:35], v[76:91]
    s_add_u32 m0, s45, 49152
    s_nop 0
    buffer_load_dwordx4 v8, s[16:19], s47 offen offset:0 lds
    s_add_u32 s47, s47, 262144
    s_cmp_eq_u32 s47, s61
    s_cselect_b32 s47, s63, s47
    v_mfma_f32_32x32x16_bf16 v[92:107], v[40:43], v[32:35], v[92:107]
    ds_read_b64_tr_b16 v[36:37], v5 offset:26624
    ds_read_b64_tr_b16 v[38:39], v5 offset:27648
    ds_read_b128 v[28:31], v3 offset:9216
    ds_read_b64_tr_b16 v[40:41], v7 offset:26624
    ds_read_b64_tr_b16 v[42:43], v7 offset:27648
    ds_read_b128 v[32:35], v3 offset:11264
    s_waitcnt lgkmcnt(6)
    v_mfma_f32_32x32x16_bf16 v[44:59], v[20:23], v[12:15], v[44:59]
    v_mfma_f32_32x32x16_bf16 v[60:75], v[24:27], v[12:15], v[60:75]
    v_mfma_f32_32x32x16_bf16 v[76:91], v[20:23], v[16:19], v[76:91]
    v_mfma_f32_32x32x16_bf16 v[92:107], v[24:27], v[16:19], v[92:107]
    s_waitcnt vmcnt(6) lgkmcnt(0)
    s_barrier
    ds_read_b64_tr_b16 v[20:21], v4 offset:16384
    ds_read_b64_tr_b16 v[22:23], v4 offset:17408
    ds_read_b128 v[12:15], v2 offset:0
    ds_read_b64_tr_b16 v[24:25], v6 offset:16384
    ds_read_b64_tr_b16 v[26:27], v6 offset:17408
    ds_read_b128 v[16:19], v2 offset:2048
    v_mfma_f32_32x32x16_bf16 v[44:59], v[36:39], v[28:31], v[44:59]
    s_add_u32 m0, s44, 73728
    s_nop 0
    buffer_load_dwordx4 v1, s[12:15], s46 offen offset:0 lds
    v_mfma_f32_32x32x16_bf16 v[60:75], v[40:43], v[28:31], v[60:75]
    buffer_load_dwordx4 v1, s[12:15], s46 offen offset:1024 lds
    s_add_u32 s46, s46, 2048
    s_cmp_eq_u32 s46, s60
    s_cselect_b32 s46, s62, s46
    v_mfma_f32_32x32x16_bf16 v[76:91], v[36:39], v[32:35], v[76:91]
    s_add_u32 m0, s45, 73728
    s_nop 0
    buffer_load_dwordx4 v8, s[16:19], s47 offen offset:0 lds
    s_add_u32 s47, s47, 262144
    s_cmp_eq_u32 s47, s61
    s_cselect_b32 s47, s63, s47
    v_mfma_f32_32x32x16_bf16 v[92:107], v[40:43], v[32:35], v[92:107]
    ds_read_b64_tr_b16 v[36:37], v4 offset:18432
    ds_read_b64_tr_b16 v[38:39], v4 offset:19456
    ds_read_b128 v[28:31], v2 offset:1024
    ds_read_b64_tr_b16 v[40:41], v6 offset:18432
    ds_read_b64_tr_b16 v[42:43], v6 offset:19456
    ds_read_b128 v[32:35], v2 offset:3072
    s_waitcnt lgkmcnt(6)
    v_mfma_f32_32x32x16_bf16 v[44:59], v[20:23], v[12:15], v[44:59]
    v_mfma_f32_32x32x16_bf16 v[60:75], v[24:27], v[12:15], v[60:75]
    v_mfma_f32_32x32x16_bf16 v[76:91], v[20:23], v[16:19], v[76:91]
    v_mfma_f32_32x32x16_bf16 v[92:107], v[24:27], v[16:19], v[92:107]
    s_waitcnt vmcnt(6) lgkmcnt(0)
    s_barrier
    ds_read_b64_tr_b16 v[20:21], v4 offset:40960
    ds_read_b64_tr_b16 v[22:23], v4 offset:41984
    ds_read_b128 v[12:15], v2 offset:24576
    ds_read_b64_tr_b16 v[24:25], v6 offset:40960
    ds_read_b64_tr_b16 v[26:27], v6 offset:41984
    ds_read_b128 v[16:19], v2 offset:26624
    v_mfma_f32_32x32x16_bf16 v[44:59], v[36:39], v[28:31], v[44:59]
    s_add_u32 m0, s44, 0
    s_nop 0
    buffer_load_dwordx4 v1, s[12:15], s46 offen offset:0 lds
    v_mfma_f32_32x32x16_bf16 v[60:75], v[40:43], v[28:31], v[60:75]
    buffer_load_dwordx4 v1, s[12:15], s46 offen offset:1024 lds
    s_add_u32 s46, s46, 2048
    s_cmp_eq_u32 s46, s60
    s_cselect_b32 s46, s62, s46
    v_mfma_f32_32x32x16_bf16 v[76:91], v[36:39], v[32:35], v[76:91]
    s_add_u32 m0, s45, 0
    s_nop 0
    buffer_load_dwordx4 v8, s[16:19], s47 offen offset:0 lds
    s_add_u32 s47, s47, 262144
    s_cmp_eq_u32 s47, s61
    s_cselect_b32 s47, s63, s47
    v_mfma_f32_32x32x16_bf16 v[92:107], v[40:43], v[32:35], v[92:107]
    ds_read_b64_tr_b16 v[36:37], v4 offset:43008
    ds_read_b64_tr_b16 v[38:39], v4 offset:44032
    ds_read_b128 v[28:31], v2 offset:25600
    ds_read_b64_tr_b16 v[40:41], v6 offset:43008
    ds_read_b64_tr_b16 v[42:43], v6 offset:44032
    ds_read_b128 v[32:35], v2 offset:27648
    s_waitcnt lgkmcnt(6)
    v_mfma_f32_32x32x16_bf16 v[44:59], v[20:23], v[12:15], v[44:59]
    v_mfma_f32_32x32x16_bf16 v[60:75], v[24:27], v[12:15], v[60:75]
    v_mfma_f32_32x32x16_bf16 v[76:91], v[20:23], v[16:19], v[76:91]
    v_mfma_f32_32x32x16_bf16 v[92:107], v[24:27], v[16:19], v[92:107]
    s_waitcnt vmcnt(6) lgkmcnt(0)
    s_barrier
    ds_read_b64_tr_b16 v[20:21], v5 offset:0
    ds_read_b64_tr_b16 v[22:23], v5 offset:1024
    ds_read_b128 v[12:15], v2 offset:49152
    ds_read_b64_tr_b16 v[24:25], v7 offset:0
    ds_read_b64_tr_b16 v[26:27], v7 offset:1024
    ds_read_b128 v[16:19], v2 offset:51200
    v_mfma_f32_32x32x16_bf16 v[44:59], v[36:39], v[28:31], v[44:59]
    s_add_u32 m0, s44, 24576
    s_nop 0
    buffer_load_dwordx4 v1, s[12:15], s46 offen offset:0 lds
    v_mfma_f32_32x32x16_bf16 v[60:75], v[40:43], v[28:31], v[60:75]
    buffer_load_dwordx4 v1, s[12:15], s46 offen offset:1024 lds
    s_add_u32 s46, s46, 2048
    s_cmp_eq_u32 s46, s60
    s_cselect_b32 s46, s62, s46
    v_mfma_f32_32x32x16_bf16 v[76:91], v[36:39], v[32:35], v[76:91]
    s_add_u32 m0, s45, 24576
    s_nop 0
    buffer_load_dwordx4 v8, s[16:19], s47 offen offset:0 lds
    s_add_u32 s47, s47, 262144
    s_cmp_eq_u32 s47, s61
    s_cselect_b32 s47, s63, s47
    v_mfma_f32_32x32x16_bf16 v[92:107], v[40:43], v[32:35], v[92:107]
    ds_read_b64_tr_b16 v[36:37], v5 offset:2048
    ds_read_b64_tr_b16 v[38:39], v5 offset:3072
    ds_read_b128 v[28:31], v2 offset:50176
    ds_read_b64_tr_b16 v[40:41], v7 offset:2048
    ds_read_b64_tr_b16 v[42:43], v7 offset:3072
    ds_read_b128 v[32:35], v2 offset:52224
    s_waitcnt lgkmcnt(6)
    v_mfma_f32_32x32x16_bf16 v[44:59], v[20:23], v[12:15], v[44:59]
    v_mfma_f32_32x32x16_bf16 v[60:75], v[24:27], v[12:15], v[60:75]
    v_mfma_f32_32x32x16_bf16 v[76:91], v[20:23], v[16:19], v[76:91]
    v_mfma_f32_32x32x16_bf16 v[92:107], v[24:27], v[16:19], v[92:107]
    s_waitcnt vmcnt(6) lgkmcnt(0)
    s_barrier
    ds_read_b64_tr_b16 v[20:21], v5 offset:24576
    ds_read_b64_tr_b16 v[22:23], v5 offset:25600
    ds_read_b128 v[12:15], v3 offset:8192
    ds_read_b64_tr_b16 v[24:25], v7 offset:24576
    ds_read_b64_tr_b16 v[26:27], v7 offset:25600
    ds_read_b128 v[16:19], v3 offset:10240
    v_mfma_f32_32x32x16_bf16 v[44:59], v[36:39], v[28:31], v[44:59]
    s_add_u32 m0, s44, 49152
    s_nop 0
    buffer_load_dwordx4 v1, s[12:15], s46 offen offset:0 lds
    v_mfma_f32_32x32x16_bf16 v[60:75], v[40:43], v[28:31], v[60:75]
    buffer_load_dwordx4 v1, s[12:15], s46 offen offset:1024 lds
    s_add_u32 s46, s46, 2048
    s_cmp_eq_u32 s46, s60
    s_cselect_b32 s46, s62, s46
    v_mfma_f32_32x32x16_bf16 v[76:91], v[36:39], v[32:35], v[76:91]
    s_add_u32 m0, s45, 49152
    s_nop 0
    buffer_load_dwordx4 v8, s[16:19], s47 offen offset:0 lds
    s_add_u32 s47, s47, 262144
    s_cmp_eq_u32 s47, s61
    s_cselect_b32 s47, s63, s47
    v_mfma_f32_32x32x16_bf16 v[92:107], v[40:43], v[32:35], v[92:107]
    ds_read_b64_tr_b16 v[36:37], v5 offset:26624
    ds_read_b64_tr_b16 v[38:39], v5 offset:27648
    ds_read_b128 v[28:31], v3 offset:9216
    ds_read_b64_tr_b16 v[40:41], v7 offset:26624
    ds_read_b64_tr_b16 v[42:43], v7 offset:27648
    ds_read_b128 v[32:35], v3 offset:11264
    s_waitcnt lgkmcnt(6)
    v_mfma_f32_32x32x16_bf16 v[44:59], v[20:23], v[12:15], v[44:59]
    v_mfma_f32_32x32x16_bf16 v[60:75], v[24:27], v[12:15], v[60:75]
    v_mfma_f32_32x32x16_bf16 v[76:91], v[20:23], v[16:19], v[76:91]
    v_mfma_f32_32x32x16_bf16 v[92:107], v[24:27], v[16:19], v[92:107]
    s_waitcnt vmcnt(6) lgkmcnt(0)
    s_barrier
    ds_read_b64_tr_b16 v[20:21], v4 offset:16384
    ds_read_b64_tr_b16 v[22:23], v4 offset:17408
    ds_read_b128 v[12:15], v2 offset:0
    ds_read_b64_tr_b16 v[24:25], v6 offset:16384
    ds_read_b64_tr_b16 v[26:27], v6 offset:17408
    ds_read_b128 v[16:19], v2 offset:2048
    v_mfma_f32_32x32x16_bf16 v[44:59], v[36:39], v[28:31], v[44:59]
    s_add_u32 m0, s44, 73728
    s_nop 0
    buffer_load_dwordx4 v1, s[12:15], s46 offen offset:0 lds
    v_mfma_f32_32x32x16_bf16 v[60:75], v[40:43], v[28:31], v[60:75]
    buffer_load_dwordx4 v1, s[12:15], s46 offen offset:1024 lds
    s_add_u32 s46, s46, 2048
    s_cmp_eq_u32 s46, s60
    s_cselect_b32 s46, s62, s46
    v_mfma_f32_32x32x16_bf16 v[76:91], v[36:39], v[32:35], v[76:91]
    s_add_u32 m0, s45, 73728
    s_nop 0
    buffer_load_dwordx4 v8, s[16:19], s47 offen offset:0 lds
    s_add_u32 s47, s47, 262144
    s_cmp_eq_u32 s47, s61
    s_cselect_b32 s47, s63, s47
    v_mfma_f32_32x32x16_bf16 v[92:107], v[40:43], v[32:35], v[92:107]
    ds_read_b64_tr_b16 v[36:37], v4 offset:18432
    ds_read_b64_tr_b16 v[38:39], v4 offset:19456
    ds_read_b128 v[28:31], v2 offset:1024
    ds_read_b64_tr_b16 v[40:41], v6 offset:18432
    ds_read_b64_tr_b16 v[42:43], v6 offset:19456
    ds_read_b128 v[32:35], v2 offset:3072
    s_waitcnt lgkmcnt(6)
    v_mfma_f32_32x32x16_bf16 v[44:59], v[20:23], v[12:15], v[44:59]
    v_mfma_f32_32x32x16_bf16 v[60:75], v[24:27], v[12:15], v[60:75]
    v_mfma_f32_32x32x16_bf16 v[76:91], v[20:23], v[16:19], v[76:91]
    v_mfma_f32_32x32x16_bf16 v[92:107], v[24:27], v[16:19], v[92:107]
    s_waitcnt vmcnt(6) lgkmcnt(0)
    s_barrier
    ds_read_b64_tr_b16 v[20:21], v4 offset:40960
    ds_read_b64_tr_b16 v[22:23], v4 offset:41984
    ds_read_b128 v[12:15], v2 offset:24576
    ds_read_b64_tr_b16 v[24:25], v6 offset:40960
    ds_read_b64_tr_b16 v[26:27], v6 offset:41984
    ds_read_b128 v[16:19], v2 offset:26624
    v_mfma_f32_32x32x16_bf16 v[44:59], v[36:39], v[28:31], v[44:59]
    s_add_u32 m0, s44, 0
    s_nop 0
    buffer_load_dwordx4 v1, s[12:15], s46 offen offset:0 lds
    v_mfma_f32_32x32x16_bf16 v[60:75], v[40:43], v[28:31], v[60:75]
    buffer_load_dwordx4 v1, s[12:15], s46 offen offset:1024 lds
    s_add_u32 s46, s46, 2048
    s_cmp_eq_u32 s46, s60
    s_cselect_b32 s46, s62, s46
    v_mfma_f32_32x32x16_bf16 v[76:91], v[36:39], v[32:35], v[76:91]
    s_add_u32 m0, s45, 0
    s_nop 0
    buffer_load_dwordx4 v8, s[16:19], s47 offen offset:0 lds
    s_add_u32 s47, s47, 262144
    s_cmp_eq_u32 s47, s61
    s_cselect_b32 s47, s63, s47
    v_mfma_f32_32x32x16_bf16 v[92:107], v[40:43], v[32:35], v[92:107]
    ds_read_b64_tr_b16 v[36:37], v4 offset:43008
    ds_read_b64_tr_b16 v[38:39], v4 offset:44032
    ds_read_b128 v[28:31], v2 offset:25600
    ds_read_b64_tr_b16 v[40:41], v6 offset:43008
    ds_read_b64_tr_b16 v[42:43], v6 offset:44032
    ds_read_b128 v[32:35], v2 offset:27648
    s_waitcnt lgkmcnt(6)
    v_mfma_f32_32x32x16_bf16 v[44:59], v[20:23], v[12:15], v[44:59]
    v_mfma_f32_32x32x16_bf16 v[60:75], v[24:27], v[12:15], v[60:75]
    v_mfma_f32_32x32x16_bf16 v[76:91], v[20:23], v[16:19], v[76:91]
    v_mfma_f32_32x32x16_bf16 v[92:107], v[24:27], v[16:19], v[92:107]
    s_waitcnt vmcnt(6) lgkmcnt(0)
    s_barrier
    ds_read_b64_tr_b16 v[20:21], v5 offset:0
    ds_read_b64_tr_b16 v[22:23], v5 offset:1024
    ds_read_b128 v[12:15], v2 offset:49152
    ds_read_b64_tr_b16 v[24:25], v7 offset:0
    ds_read_b64_tr_b16 v[26:27], v7 offset:1024
    ds_read_b128 v[16:19], v2 offset:51200
    v_mfma_f32_32x32x16_bf16 v[44:59], v[36:39], v[28:31], v[44:59]
    s_add_u32 m0, s44, 24576
    s_nop 0
    buffer_load_dwordx4 v1, s[12:15], s46 offen offset:0 lds
    v_mfma_f32_32x32x16_bf16 v[60:75], v[40:43], v[28:31], v[60:75]
    buffer_load_dwordx4 v1, s[12:15], s46 offen offset:1024 lds
    s_add_u32 s46, s46, 2048
    s_cmp_eq_u32 s46, s60
    s_cselect_b32 s46, s62, s46
    v_mfma_f32_32x32x16_bf16 v[76:91], v[36:39], v[32:35], v[76:91]
    s_add_u32 m0, s45, 24576
    s_nop 0
    buffer_load_dwordx4 v8, s[16:19], s47 offen offset:0 lds
    s_add_u32 s47, s47, 262144
    s_cmp_eq_u32 s47, s61
    s_cselect_b32 s47, s63, s47
    v_mfma_f32_32x32x16_bf16 v[92:107], v[40:43], v[32:35], v[92:107]
    ds_read_b64_tr_b16 v[36:37], v5 offset:2048
    ds_read_b64_tr_b16 v[38:39], v5 offset:3072
    ds_read_b128 v[28:31], v2 offset:50176
    ds_read_b64_tr_b16 v[40:41], v7 offset:2048
    ds_read_b64_tr_b16 v[42:43], v7 offset:3072
    ds_read_b128 v[32:35], v2 offset:52224
    s_waitcnt lgkmcnt(6)
    v_mfma_f32_32x32x16_bf16 v[44:59], v[20:23], v[12:15], v[44:59]
    v_mfma_f32_32x32x16_bf16 v[60:75], v[24:27], v[12:15], v[60:75]
    v_mfma_f32_32x32x16_bf16 v[76:91], v[20:23], v[16:19], v[76:91]
    v_mfma_f32_32x32x16_bf16 v[92:107], v[24:27], v[16:19], v[92:107]
    s_waitcnt vmcnt(6) lgkmcnt(0)
    s_barrier
    ds_read_b64_tr_b16 v[20:21], v5 offset:24576
    ds_read_b64_tr_b16 v[22:23], v5 offset:25600
    ds_read_b128 v[12:15], v3 offset:8192
    ds_read_b64_tr_b16 v[24:25], v7 offset:24576
    ds_read_b64_tr_b16 v[26:27], v7 offset:25600
    ds_read_b128 v[16:19], v3 offset:10240
    v_mfma_f32_32x32x16_bf16 v[44:59], v[36:39], v[28:31], v[44:59]
    s_add_u32 m0, s44, 49152
    s_nop 0
    buffer_load_dwordx4 v1, s[12:15], s46 offen offset:0 lds
    v_mfma_f32_32x32x16_bf16 v[60:75], v[40:43], v[28:31], v[60:75]
    buffer_load_dwordx4 v1, s[12:15], s46 offen offset:1024 lds
    s_add_u32 s46, s46, 2048
    s_cmp_eq_u32 s46, s60
    s_cselect_b32 s46, s62, s46
    v_mfma_f32_32x32x16_bf16 v[76:91], v[36:39], v[32:35], v[76:91]
    s_add_u32 m0, s45, 49152
    s_nop 0
    buffer_load_dwordx4 v8, s[16:19], s47 offen offset:0 lds
    s_add_u32 s47, s47, 262144
    s_cmp_eq_u32 s47, s61
    s_cselect_b32 s47, s63, s47
    v_mfma_f32_32x32x16_bf16 v[92:107], v[40:43], v[32:35], v[92:107]
    ds_read_b64_tr_b16 v[36:37], v5 offset:26624
    ds_read_b64_tr_b16 v[38:39], v5 offset:27648
    ds_read_b128 v[28:31], v3 offset:9216
    ds_read_b64_tr_b16 v[40:41], v7 offset:26624
    ds_read_b64_tr_b16 v[42:43], v7 offset:27648
    ds_read_b128 v[32:35], v3 offset:11264
    s_waitcnt lgkmcnt(6)
    v_mfma_f32_32x32x16_bf16 v[44:59], v[20:23], v[12:15], v[44:59]
    v_mfma_f32_32x32x16_bf16 v[60:75], v[24:27], v[12:15], v[60:75]
    v_mfma_f32_32x32x16_bf16 v[76:91], v[20:23], v[16:19], v[76:91]
    v_mfma_f32_32x32x16_bf16 v[92:107], v[24:27], v[16:19], v[92:107]
    s_waitcnt vmcnt(6) lgkmcnt(0)
    s_barrier
    ds_read_b64_tr_b16 v[20:21], v4 offset:16384
    ds_read_b64_tr_b16 v[22:23], v4 offset:17408
    ds_read_b128 v[12:15], v2 offset:0
    ds_read_b64_tr_b16 v[24:25], v6 offset:16384
    ds_read_b64_tr_b16 v[26:27], v6 offset:17408
    ds_read_b128 v[16:19], v2 offset:2048
    v_mfma_f32_32x32x16_bf16 v[44:59], v[36:39], v[28:31], v[44:59]
    s_add_u32 m0, s44, 73728
    s_nop 0
    buffer_load_dwordx4 v1, s[12:15], s46 offen offset:0 lds
    v_mfma_f32_32x32x16_bf16 v[60:75], v[40:43], v[28:31], v[60:75]
    buffer_load_dwordx4 v1, s[12:15], s46 offen offset:1024 lds
    s_add_u32 s46, s46, 2048
    s_cmp_eq_u32 s46, s60
    s_cselect_b32 s46, s62, s46
    v_mfma_f32_32x32x16_bf16 v[76:91], v[36:39], v[32:35], v[76:91]
    s_add_u32 m0, s45, 73728
    s_nop 0
    buffer_load_dwordx4 v8, s[16:19], s47 offen offset:0 lds
    s_add_u32 s47, s47, 262144
    s_cmp_eq_u32 s47, s61
    s_cselect_b32 s47, s63, s47
    v_mfma_f32_32x32x16_bf16 v[92:107], v[40:43], v[32:35], v[92:107]
    ds_read_b64_tr_b16 v[36:37], v4 offset:18432
    ds_read_b64_tr_b16 v[38:39], v4 offset:19456
    ds_read_b128 v[28:31], v2 offset:1024
    ds_read_b64_tr_b16 v[40:41], v6 offset:18432
    ds_read_b64_tr_b16 v[42:43], v6 offset:19456
    ds_read_b128 v[32:35], v2 offset:3072
    s_waitcnt lgkmcnt(6)
    v_mfma_f32_32x32x16_bf16 v[44:59], v[20:23], v[12:15], v[44:59]
    v_mfma_f32_32x32x16_bf16 v[60:75], v[24:27], v[12:15], v[60:75]
    v_mfma_f32_32x32x16_bf16 v[76:91], v[20:23], v[16:19], v[76:91]
    v_mfma_f32_32x32x16_bf16 v[92:107], v[24:27], v[16:19], v[92:107]
    s_waitcnt vmcnt(6) lgkmcnt(0)
    s_barrier
    ds_read_b64_tr_b16 v[20:21], v4 offset:40960
    ds_read_b64_tr_b16 v[22:23], v4 offset:41984
    ds_read_b128 v[12:15], v2 offset:24576
    ds_read_b64_tr_b16 v[24:25], v6 offset:40960
    ds_read_b64_tr_b16 v[26:27], v6 offset:41984
    ds_read_b128 v[16:19], v2 offset:26624
    v_mfma_f32_32x32x16_bf16 v[44:59], v[36:39], v[28:31], v[44:59]
    s_add_u32 m0, s57, 0
    s_nop 0
    buffer_load_dwordx4 v1, s[24:27], s58 offen offset:0 lds
    buffer_load_dwordx4 v1, s[24:27], s58 offen offset:1024 lds
    v_mfma_f32_32x32x16_bf16 v[60:75], v[40:43], v[28:31], v[60:75]
    buffer_load_dwordx4 v1, s[24:27], s58 offen offset:2048 lds
    buffer_load_dwordx4 v1, s[24:27], s58 offen offset:3072 lds
    s_add_u32 s58, s58, 0x8000
    s_cmp_eq_u32 s58, s48
    s_cselect_b32 s58, s49, s58
    v_mfma_f32_32x32x16_bf16 v[76:91], v[36:39], v[32:35], v[76:91]
    s_add_u32 m0, s57, 32768
    s_nop 0
    buffer_load_dwordx4 v1, s[24:27], s58 offen offset:0 lds
    buffer_load_dwordx4 v1, s[24:27], s58 offen offset:1024 lds
    v_mfma_f32_32x32x16_bf16 v[92:107], v[40:43], v[32:35], v[92:107]
    buffer_load_dwordx4 v1, s[24:27], s58 offen offset:2048 lds
    buffer_load_dwordx4 v1, s[24:27], s58 offen offset:3072 lds
    s_add_u32 s58, s58, 0x8000
    s_cmp_eq_u32 s58, s48
    s_cselect_b32 s58, s49, s58
    ds_read_b64_tr_b16 v[36:37], v4 offset:43008
    ds_read_b64_tr_b16 v[38:39], v4 offset:44032
    ds_read_b128 v[28:31], v2 offset:25600
    ds_read_b64_tr_b16 v[40:41], v6 offset:43008
    ds_read_b64_tr_b16 v[42:43], v6 offset:44032
    ds_read_b128 v[32:35], v2 offset:27648
    s_waitcnt lgkmcnt(6)
    v_mfma_f32_32x32x16_bf16 v[44:59], v[20:23], v[12:15], v[44:59]
    v_mfma_f32_32x32x16_bf16 v[60:75], v[24:27], v[12:15], v[60:75]
    v_mfma_f32_32x32x16_bf16 v[76:91], v[20:23], v[16:19], v[76:91]
    v_mfma_f32_32x32x16_bf16 v[92:107], v[24:27], v[16:19], v[92:107]
    s_waitcnt vmcnt(11) lgkmcnt(0)
    s_barrier
    ds_read_b64_tr_b16 v[20:21], v5 offset:0
    ds_read_b64_tr_b16 v[22:23], v5 offset:1024
    ds_read_b128 v[12:15], v2 offset:49152
    ds_read_b64_tr_b16 v[24:25], v7 offset:0
    ds_read_b64_tr_b16 v[26:27], v7 offset:1024
    ds_read_b128 v[16:19], v2 offset:51200
    v_mfma_f32_32x32x16_bf16 v[44:59], v[36:39], v[28:31], v[44:59]
    s_add_u32 m0, s57, 65536
    s_nop 0
    buffer_load_dwordx4 v1, s[28:31], s59 offen offset:0 lds
    v_mfma_f32_32x32x16_bf16 v[60:75], v[40:43], v[28:31], v[60:75]
    buffer_load_dwordx4 v1, s[28:31], s59 offen offset:1024 lds
    v_mfma_f32_32x32x16_bf16 v[76:91], v[36:39], v[32:35], v[76:91]
    buffer_load_dwordx4 v1, s[28:31], s59 offen offset:2048 lds
    v_mfma_f32_32x32x16_bf16 v[92:107], v[40:43], v[32:35], v[92:107]
    buffer_load_dwordx4 v1, s[28:31], s59 offen offset:3072 lds
    s_add_u32 s59, s59, 0x8000
    s_cmp_eq_u32 s59, s48
    s_cselect_b32 s59, s49, s59
    ds_read_b64_tr_b16 v[36:37], v5 offset:2048
    ds_read_b64_tr_b16 v[38:39], v5 offset:3072
    ds_read_b128 v[28:31], v2 offset:50176
    ds_read_b64_tr_b16 v[40:41], v7 offset:2048
    ds_read_b64_tr_b16 v[42:43], v7 offset:3072
    ds_read_b128 v[32:35], v2 offset:52224
    s_waitcnt lgkmcnt(6)
    v_mfma_f32_32x32x16_bf16 v[44:59], v[20:23], v[12:15], v[44:59]
    v_mfma_f32_32x32x16_bf16 v[60:75], v[24:27], v[12:15], v[60:75]
    v_mfma_f32_32x32x16_bf16 v[76:91], v[20:23], v[16:19], v[76:91]
    v_mfma_f32_32x32x16_bf16 v[92:107], v[24:27], v[16:19], v[92:107]
    s_waitcnt vmcnt(12) lgkmcnt(0)
    s_barrier
    ds_read_b64_tr_b16 v[20:21], v5 offset:24576
    ds_read_b64_tr_b16 v[22:23], v5 offset:25600
    ds_read_b128 v[12:15], v3 offset:8192
    ds_read_b64_tr_b16 v[24:25], v7 offset:24576
    ds_read_b64_tr_b16 v[26:27], v7 offset:25600
    ds_read_b128 v[16:19], v3 offset:10240
    v_mfma_f32_32x32x16_bf16 v[44:59], v[36:39], v[28:31], v[44:59]
    v_mfma_f32_32x32x16_bf16 v[60:75], v[40:43], v[28:31], v[60:75]
    v_mfma_f32_32x32x16_bf16 v[76:91], v[36:39], v[32:35], v[76:91]
    v_mfma_f32_32x32x16_bf16 v[92:107], v[40:43], v[32:35], v[92:107]
    ds_read_b64_tr_b16 v[36:37], v5 offset:26624
    ds_read_b64_tr_b16 v[38:39], v5 offset:27648
    ds_read_b128 v[28:31], v3 offset:9216
    ds_read_b64_tr_b16 v[40:41], v7 offset:26624
    ds_read_b64_tr_b16 v[42:43], v7 offset:27648
    ds_read_b128 v[32:35], v3 offset:11264
    s_waitcnt lgkmcnt(6)
    v_mfma_f32_32x32x16_bf16 v[44:59], v[20:23], v[12:15], v[44:59]
    v_mfma_f32_32x32x16_bf16 v[60:75], v[24:27], v[12:15], v[60:75]
    v_mfma_f32_32x32x16_bf16 v[76:91], v[20:23], v[16:19], v[76:91]
    v_mfma_f32_32x32x16_bf16 v[92:107], v[24:27], v[16:19], v[92:107]
    s_waitcnt lgkmcnt(0)
    v_mfma_f32_32x32x16_bf16 v[44:59], v[36:39], v[28:31], v[44:59]
    v_mfma_f32_32x32x16_bf16 v[60:75], v[40:43], v[28:31], v[60:75]
    v_mfma_f32_32x32x16_bf16 v[76:91], v[36:39], v[32:35], v[76:91]
    v_mfma_f32_32x32x16_bf16 v[92:107], v[40:43], v[32:35], v[92:107]
    s_nop 7
    s_nop 7
    s_barrier
    v_mul_f32 v44, 0x3e0293ee, v44
    v_mul_f32 v45, 0x3e0293ee, v45
    v_mul_f32 v46, 0x3e0293ee, v46
    v_mul_f32 v47, 0x3e0293ee, v47
    v_mul_f32 v48, 0x3e0293ee, v48
    v_mul_f32 v49, 0x3e0293ee, v49
    v_mul_f32 v50, 0x3e0293ee, v50
    v_mul_f32 v51, 0x3e0293ee, v51
    v_mul_f32 v52, 0x3e0293ee, v52
    v_mul_f32 v53, 0x3e0293ee, v53
    v_mul_f32 v54, 0x3e0293ee, v54
    v_mul_f32 v55, 0x3e0293ee, v55
    v_mul_f32 v56, 0x3e0293ee, v56
    v_mul_f32 v57, 0x3e0293ee, v57
    v_mul_f32 v58, 0x3e0293ee, v58
    v_mul_f32 v59, 0x3e0293ee, v59
    v_mul_f32 v60, 0x3e0293ee, v60
    v_mul_f32 v61, 0x3e0293ee, v61
    v_mul_f32 v62, 0x3e0293ee, v62
    v_mul_f32 v63, 0x3e0293ee, v63
    v_mul_f32 v64, 0x3e0293ee, v64
    v_mul_f32 v65, 0x3e0293ee, v65
    v_mul_f32 v66, 0x3e0293ee, v66
    v_mul_f32 v67, 0x3e0293ee, v67
    v_mul_f32 v68, 0x3e0293ee, v68
    v_mul_f32 v69, 0x3e0293ee, v69
    v_mul_f32 v70, 0x3e0293ee, v70
    v_mul_f32 v71, 0x3e0293ee, v71
    v_mul_f32 v72, 0x3e0293ee, v72
    v_mul_f32 v73, 0x3e0293ee, v73
    v_mul_f32 v74, 0x3e0293ee, v74
    v_mul_f32 v75, 0x3e0293ee, v75
    v_mul_f32 v76, 0x3e0293ee, v76
    v_mul_f32 v77, 0x3e0293ee, v77
    v_mul_f32 v78, 0x3e0293ee, v78
    v_mul_f32 v79, 0x3e0293ee, v79
    v_mul_f32 v80, 0x3e0293ee, v80
    v_mul_f32 v81, 0x3e0293ee, v81
    v_mul_f32 v82, 0x3e0293ee, v82
    v_mul_f32 v83, 0x3e0293ee, v83
    v_mul_f32 v84, 0x3e0293ee, v84
    v_mul_f32 v85, 0x3e0293ee, v85
    v_mul_f32 v86, 0x3e0293ee, v86
    v_mul_f32 v87, 0x3e0293ee, v87
    v_mul_f32 v88, 0x3e0293ee, v88
    v_mul_f32 v89, 0x3e0293ee, v89
    v_mul_f32 v90, 0x3e0293ee, v90
    v_mul_f32 v91, 0x3e0293ee, v91
    v_mul_f32 v92, 0x3e0293ee, v92
    v_mul_f32 v93, 0x3e0293ee, v93
    v_mul_f32 v94, 0x3e0293ee, v94
    v_mul_f32 v95, 0x3e0293ee, v95
    v_mul_f32 v96, 0x3e0293ee, v96
    v_mul_f32 v97, 0x3e0293ee, v97
    v_mul_f32 v98, 0x3e0293ee, v98
    v_mul_f32 v99, 0x3e0293ee, v99
    v_mul_f32 v100, 0x3e0293ee, v100
    v_mul_f32 v101, 0x3e0293ee, v101
    v_mul_f32 v102, 0x3e0293ee, v102
    v_mul_f32 v103, 0x3e0293ee, v103
    v_mul_f32 v104, 0x3e0293ee, v104
    v_mul_f32 v105, 0x3e0293ee, v105
    v_mul_f32 v106, 0x3e0293ee, v106
    v_mul_f32 v107, 0x3e0293ee, v107
    v_cvt_pk_bf16_f32 v144, v44, v45
    v_cvt_pk_bf16_f32 v145, v46, v47
    v_cvt_pk_bf16_f32 v146, v48, v49
    v_cvt_pk_bf16_f32 v147, v50, v51
    v_cvt_pk_bf16_f32 v148, v52, v53
    v_cvt_pk_bf16_f32 v149, v54, v55
    v_cvt_pk_bf16_f32 v150, v56, v57
    v_cvt_pk_bf16_f32 v151, v58, v59
    v_cvt_pk_bf16_f32 v152, v60, v61
    v_cvt_pk_bf16_f32 v153, v62, v63
    v_cvt_pk_bf16_f32 v154, v64, v65
    v_cvt_pk_bf16_f32 v155, v66, v67
    v_cvt_pk_bf16_f32 v156, v68, v69
    v_cvt_pk_bf16_f32 v157, v70, v71
    v_cvt_pk_bf16_f32 v158, v72, v73
    v_cvt_pk_bf16_f32 v159, v74, v75
    v_cvt_pk_bf16_f32 v160, v76, v77
    v_cvt_pk_bf16_f32 v161, v78, v79
    v_cvt_pk_bf16_f32 v162, v80, v81
    v_cvt_pk_bf16_f32 v163, v82, v83
    v_cvt_pk_bf16_f32 v164, v84, v85
    v_cvt_pk_bf16_f32 v165, v86, v87
    v_cvt_pk_bf16_f32 v166, v88, v89
    v_cvt_pk_bf16_f32 v167, v90, v91
    v_cvt_pk_bf16_f32 v168, v92, v93
    v_cvt_pk_bf16_f32 v169, v94, v95
    v_cvt_pk_bf16_f32 v170, v96, v97
    v_cvt_pk_bf16_f32 v171, v98, v99
    v_cvt_pk_bf16_f32 v172, v100, v101
    v_cvt_pk_bf16_f32 v173, v102, v103
    v_cvt_pk_bf16_f32 v174, v104, v105
    v_cvt_pk_bf16_f32 v175, v106, v107
    ds_write_b128 v110, v[144:147] offset:0
    ds_write_b128 v110, v[148:151] offset:1024
    ds_write_b128 v110, v[152:155] offset:2048
    ds_write_b128 v110, v[156:159] offset:3072
    ds_write_b128 v110, v[160:163] offset:32768
    ds_write_b128 v110, v[164:167] offset:33792
    ds_write_b128 v110, v[168:171] offset:34816
    ds_write_b128 v110, v[172:175] offset:35840
    v_lshrrev_b32 v5, 4, v1
    v_lshrrev_b32 v4, 5, v5
    v_and_b32 v5, 31, v5
    v_lshlrev_b32 v4, 2, v4
    v_sub_u32 v4, v5, v4
    s_lshl_b32 s36, s41, 5
    s_lshl_b32 s37, s42, 6
    s_sub_u32 s36, s36, s37
    v_add_u32 v4, s36, v4
    v_lshlrev_b32 v15, 3, v0
    v_add_u32 v15, 0x20000, v15
    s_lshl_b32 s36, s42, 14
    v_add_u32 v2, s36, v1
    v_add_u32 v3, 0x10000, v2
    s_lshl_b32 s36, s41, 13
    v_add_u32 v13, s36, v1
    v_add_u32 v14, 0x10000, v13
    v_add_u32 v12, 0x20000, v13
    s_waitcnt vmcnt(8) lgkmcnt(0)
    s_barrier
    ds_read_b128 v[48:51], v14 offset:32768
    ds_read_b128 v[52:55], v14 offset:33792
    ds_read_b128 v[56:59], v14 offset:34816
    ds_read_b128 v[60:63], v14 offset:35840
    ds_read_b128 v[64:67], v14 offset:36864
    ds_read_b128 v[68:71], v14 offset:37888
    ds_read_b128 v[72:75], v14 offset:38912
    ds_read_b128 v[76:79], v14 offset:39936
    v_mov_b32 v80, 0
    v_mov_b32 v81, 0
    v_mov_b32 v82, 0
    v_mov_b32 v83, 0
    v_mov_b32 v84, 0
    v_mov_b32 v85, 0
    v_mov_b32 v86, 0
    v_mov_b32 v87, 0
    v_mov_b32 v88, 0
    v_mov_b32 v89, 0
    v_mov_b32 v90, 0
    v_mov_b32 v91, 0
    v_mov_b32 v92, 0
    v_mov_b32 v93, 0
    v_mov_b32 v94, 0
    v_mov_b32 v95, 0
    v_mov_b32 v6, 0
    v_mov_b32 v7, 0
    s_waitcnt lgkmcnt(0)
    ds_read_b128 v[16:19], v2 offset:0
    ds_read_b128 v[20:23], v2 offset:8192
    ds_read_b128 v[24:27], v2 offset:1024
    ds_read_b128 v[28:31], v2 offset:9216
    ds_read_b128 v[32:35], v2 offset:2048
    ds_read_b128 v[36:39], v2 offset:10240
    ds_read_b128 v[40:43], v2 offset:3072
    ds_read_b128 v[44:47], v2 offset:11264
    s_waitcnt lgkmcnt(7)
    v_mfma_f32_32x32x16_bf16 v[112:127], v[16:19], v[48:51], 0
    s_waitcnt lgkmcnt(6)
    v_mfma_f32_32x32x16_bf16 v[128:143], v[20:23], v[48:51], 0
    s_waitcnt lgkmcnt(5)
    v_mfma_f32_32x32x16_bf16 v[112:127], v[24:27], v[52:55], v[112:127]
    s_waitcnt lgkmcnt(4)
    v_mfma_f32_32x32x16_bf16 v[128:143], v[28:31], v[52:55], v[128:143]
    s_waitcnt lgkmcnt(3)
    v_mfma_f32_32x32x16_bf16 v[112:127], v[32:35], v[56:59], v[112:127]
    s_waitcnt lgkmcnt(2)
    v_mfma_f32_32x32x16_bf16 v[128:143], v[36:39], v[56:59], v[128:143]
    s_waitcnt lgkmcnt(1)
    v_mfma_f32_32x32x16_bf16 v[112:127], v[40:43], v[60:63], v[112:127]
    s_waitcnt lgkmcnt(0)
    v_mfma_f32_32x32x16_bf16 v[128:143], v[44:47], v[60:63], v[128:143]
    ds_read_b128 v[16:19], v2 offset:4096
    ds_read_b128 v[20:23], v2 offset:12288
    ds_read_b128 v[24:27], v2 offset:5120
    ds_read_b128 v[28:31], v2 offset:13312
    ds_read_b128 v[32:35], v2 offset:6144
    ds_read_b128 v[36:39], v2 offset:14336
    ds_read_b128 v[40:43], v2 offset:7168
    ds_read_b128 v[44:47], v2 offset:15360
    s_waitcnt lgkmcnt(7)
    v_mfma_f32_32x32x16_bf16 v[112:127], v[16:19], v[64:67], v[112:127]
    s_waitcnt lgkmcnt(6)
    v_mfma_f32_32x32x16_bf16 v[128:143], v[20:23], v[64:67], v[128:143]
    s_waitcnt lgkmcnt(5)
    v_mfma_f32_32x32x16_bf16 v[112:127], v[24:27], v[68:71], v[112:127]
    s_waitcnt lgkmcnt(4)
    v_mfma_f32_32x32x16_bf16 v[128:143], v[28:31], v[68:71], v[128:143]
    s_waitcnt lgkmcnt(3)
    v_mfma_f32_32x32x16_bf16 v[112:127], v[32:35], v[72:75], v[112:127]
    s_waitcnt lgkmcnt(2)
    v_mfma_f32_32x32x16_bf16 v[128:143], v[36:39], v[72:75], v[128:143]
    s_waitcnt lgkmcnt(1)
    v_mfma_f32_32x32x16_bf16 v[112:127], v[40:43], v[76:79], v[112:127]
    s_waitcnt lgkmcnt(0)
    v_mfma_f32_32x32x16_bf16 v[128:143], v[44:47], v[76:79], v[128:143]
    s_waitcnt vmcnt(0)
    s_barrier
    ds_read_b128 v[16:19], v2 offset:32768
    ds_read_b128 v[20:23], v2 offset:40960
    ds_read_b128 v[24:27], v2 offset:33792
    ds_read_b128 v[28:31], v2 offset:41984
    ds_read_b128 v[32:35], v2 offset:34816
    ds_read_b128 v[36:39], v2 offset:43008
    s_nop 7
    v_max3_f32 v5, v112, v113, v114
    v_max3_f32 v5, v5, v115, v116
    v_max3_f32 v5, v5, v117, v118
    v_max3_f32 v5, v5, v119, v120
    v_max3_f32 v5, v5, v121, v122
    v_max3_f32 v5, v5, v123, v124
    v_max3_f32 v5, v5, v125, v126
    v_max3_f32 v5, v5, v127, v128
    v_max3_f32 v5, v5, v129, v130
    v_max3_f32 v5, v5, v131, v132
    v_max3_f32 v5, v5, v133, v134
    v_max3_f32 v5, v5, v135, v136
    v_max3_f32 v5, v5, v137, v138
    v_max3_f32 v5, v5, v139, v140
    v_max3_f32 v5, v5, v141, v142
    v_max_f32 v5, v5, v143
    s_branch at_fs1
at_it0:
    s_cmp_lg_u32 s54, s55
    s_cbranch_scc1 at_nq0
    s_cmp_eq_u32 s54, 16
    s_cbranch_scc1 at_last
    ds_read_b128 v[48:51], v12 offset:0
    ds_read_b128 v[52:55], v12 offset:1024
    ds_read_b128 v[56:59], v12 offset:2048
    ds_read_b128 v[60:63], v12 offset:3072
    ds_read_b128 v[64:67], v12 offset:4096
    ds_read_b128 v[68:71], v12 offset:5120
    ds_read_b128 v[72:75], v12 offset:6144
    ds_read_b128 v[76:79], v12 offset:7168
    v_mov_b32 v8, v80
    v_mov_b32 v80, 0
    v_mov_b32 v81, 0
    v_mov_b32 v82, 0
    v_mov_b32 v83, 0
    v_mov_b32 v84, 0
    v_mov_b32 v85, 0
    v_mov_b32 v86, 0
    v_mov_b32 v87, 0
    v_mov_b32 v88, 0
    v_mov_b32 v89, 0
    v_mov_b32 v90, 0
    v_mov_b32 v91, 0
    v_mov_b32 v92, 0
    v_mov_b32 v93, 0
    v_mov_b32 v94, 0
    v_mov_b32 v95, 0
    s_waitcnt lgkmcnt(0)
at_nq0:
    s_waitcnt lgkmcnt(5)
    v_mfma_f32_32x32x16_bf16 v[144:159], v[16:19], v[48:51], v[80:95]
    ds_read_b128 v[40:43], v2 offset:35840
    v_exp_f32 v112, v112
    v_exp_f32 v113, v113
    s_add_u32 m0, s57, 0
    s_nop 0
    buffer_load_dwordx4 v1, s[24:27], s58 offen offset:0 lds
    s_waitcnt lgkmcnt(5)
    v_mfma_f32_32x32x16_bf16 v[160:175], v[20:23], v[48:51], v[80:95]
    ds_read_b128 v[44:47], v2 offset:44032
    v_exp_f32 v114, v114
    v_cvt_pk_bf16_f32 v96, v112, v113
    v_add_f32 v6, v6, v112
    v_add_f32 v7, v7, v113
    s_waitcnt lgkmcnt(5)
    v_mfma_f32_32x32x16_bf16 v[144:159], v[24:27], v[52:55], v[144:159]
    ds_read_b128 v[16:19], v2 offset:36864
    v_exp_f32 v115, v115
    buffer_load_dwordx4 v1, s[24:27], s58 offen offset:1024 lds
    s_waitcnt lgkmcnt(5)
    v_mfma_f32_32x32x16_bf16 v[160:175], v[28:31], v[52:55], v[160:175]
    ds_read_b128 v[20:23], v2 offset:45056
    v_exp_f32 v116, v116
    v_exp_f32 v117, v117
    v_cvt_pk_bf16_f32 v97, v114, v115
    v_add_f32 v6, v6, v114
    v_add_f32 v7, v7, v115
    s_waitcnt lgkmcnt(5)
    v_mfma_f32_32x32x16_bf16 v[144:159], v[32:35], v[56:59], v[144:159]
    ds_read_b128 v[24:27], v2 offset:37888
    v_exp_f32 v118, v118
    v_cvt_pk_bf16_f32 v98, v116, v117
    v_add_f32 v6, v6, v116
    v_add_f32 v7, v7, v117
    buffer_load_dwordx4 v1, s[24:27], s58 offen offset:2048 lds
    s_waitcnt lgkmcnt(5)
    v_mfma_f32_32x32x16_bf16 v[160:175], v[36:39], v[56:59], v[160:175]
    ds_read_b128 v[28:31], v2 offset:46080
    v_exp_f32 v119, v119
    s_waitcnt lgkmcnt(5)
    v_mfma_f32_32x32x16_bf16 v[144:159], v[40:43], v[60:63], v[144:159]
    ds_read_b128 v[32:35], v2 offset:38912
    v_exp_f32 v120, v120
    v_cvt_pk_bf16_f32 v99, v118, v119
    v_add_f32 v6, v6, v118
    v_add_f32 v7, v7, v119
    buffer_load_dwordx4 v1, s[24:27], s58 offen offset:3072 lds
    s_add_u32 s58, s58, 0x8000
    s_cmp_eq_u32 s58, s48
    s_cselect_b32 s58, s49, s58
    s_waitcnt lgkmcnt(5)
    v_mfma_f32_32x32x16_bf16 v[160:175], v[44:47], v[60:63], v[160:175]
    ds_read_b128 v[36:39], v2 offset:47104
    v_exp_f32 v121, v121
    v_exp_f32 v122, v122
    s_waitcnt lgkmcnt(5)
    v_mfma_f32_32x32x16_bf16 v[144:159], v[16:19], v[64:67], v[144:159]
    ds_read_b128 v[40:43], v2 offset:39936
    v_exp_f32 v123, v123
    v_cvt_pk_bf16_f32 v100, v120, v121
    v_add_f32 v6, v6, v120
    v_add_f32 v7, v7, v121
    s_add_u32 m0, s57, 98304
    s_nop 0
    buffer_load_dwordx4 v1, s[28:31], s59 offen offset:0 lds
    s_waitcnt lgkmcnt(5)
    v_mfma_f32_32x32x16_bf16 v[160:175], v[20:23], v[64:67], v[160:175]
    ds_read_b128 v[44:47], v2 offset:48128
    v_exp_f32 v124, v124
    v_cvt_pk_bf16_f32 v101, v122, v123
    v_add_f32 v6, v6, v122
    v_add_f32 v7, v7, v123
    s_waitcnt lgkmcnt(5)
    v_mfma_f32_32x32x16_bf16 v[144:159], v[24:27], v[68:71], v[144:159]
    ds_read_b128 v[16:19], v3 offset:0
    v_exp_f32 v125, v125
    v_exp_f32 v126, v126
    buffer_load_dwordx4 v1, s[28:31], s59 offen offset:1024 lds
    s_waitcnt lgkmcnt(5)
    v_mfma_f32_32x32x16_bf16 v[160:175], v[28:31], v[68:71], v[160:175]
    ds_read_b128 v[20:23], v3 offset:4096
    v_exp_f32 v127, v127
    v_cvt_pk_bf16_f32 v102, v124, v125
    v_add_f32 v6, v6, v124
    v_add_f32 v7, v7, v125
    s_waitcnt lgkmcnt(5)
    v_mfma_f32_32x32x16_bf16 v[144:159], v[32:35], v[72:75], v[144:159]
    ds_read_b128 v[24:27], v3 offset:8192
    v_exp_f32 v128, v128
    v_cvt_pk_bf16_f32 v103, v126, v127
    v_add_f32 v6, v6, v126
    v_add_f32 v7, v7, v127
    buffer_load_dwordx4 v1, s[28:31], s59 offen offset:2048 lds
    s_waitcnt lgkmcnt(5)
    v_mfma_f32_32x32x16_bf16 v[160:175], v[36:39], v[72:75], v[160:175]
    ds_read_b128 v[28:31], v3 offset:12288
    v_exp_f32 v129, v129
    s_waitcnt lgkmcnt(5)
    v_mfma_f32_32x32x16_bf16 v[144:159], v[40:43], v[76:79], v[144:159]
    ds_read_b128 v[32:35], v3 offset:1024
    v_exp_f32 v130, v130
    v_exp_f32 v131, v131
    v_cvt_pk_bf16_f32 v104, v128, v129
    v_add_f32 v6, v6, v128
    v_add_f32 v7, v7, v129
    buffer_load_dwordx4 v1, s[28:31], s59 offen offset:3072 lds
    s_add_u32 s59, s59, 0x8000
    s_cmp_eq_u32 s59, s48
    s_cselect_b32 s59, s49, s59
    s_waitcnt lgkmcnt(5)
    v_mfma_f32_32x32x16_bf16 v[160:175], v[44:47], v[76:79], v[160:175]
    ds_read_b128 v[36:39], v3 offset:5120
    v_exp_f32 v132, v132
    v_cvt_pk_bf16_f32 v105, v130, v131
    v_add_f32 v6, v6, v130
    v_add_f32 v7, v7, v131
    s_cmp_eq_u32 s54, s56
    s_cbranch_scc1 at_mask0
at_mret0:
    s_waitcnt lgkmcnt(5)
    v_mfma_f32_32x32x16_bf16 v[176:191], v[16:19], v[96:99], v[176:191]
    ds_read_b128 v[40:43], v3 offset:9216
    v_exp_f32 v133, v133
    s_waitcnt lgkmcnt(5)
    v_mfma_f32_32x32x16_bf16 v[192:207], v[20:23], v[96:99], v[192:207]
    ds_read_b128 v[44:47], v3 offset:13312
    v_exp_f32 v134, v134
    v_exp_f32 v135, v135
    v_cvt_pk_bf16_f32 v106, v132, v133
    v_add_f32 v6, v6, v132
    v_add_f32 v7, v7, v133
    s_waitcnt lgkmcnt(5)
    v_mfma_f32_32x32x16_bf16 v[208:223], v[24:27], v[96:99], v[208:223]
    ds_read_b128 v[16:19], v3 offset:2048
    v_exp_f32 v136, v136
    v_cvt_pk_bf16_f32 v107, v134, v135
    v_add_f32 v6, v6, v134
    v_add_f32 v7, v7, v135
    s_waitcnt lgkmcnt(5)
    v_mfma_f32_32x32x16_bf16 v[224:239], v[28:31], v[96:99], v[224:239]
    ds_read_b128 v[20:23], v3 offset:6144
    v_exp_f32 v137, v137
    s_waitcnt lgkmcnt(5)
    v_mfma_f32_32x32x16_bf16 v[176:191], v[32:35], v[100:103], v[176:191]
    ds_read_b128 v[24:27], v3 offset:10240
    v_exp_f32 v138, v138
    v_cvt_pk_bf16_f32 v108, v136, v137
    v_add_f32 v6, v6, v136
    v_add_f32 v7, v7, v137
    s_waitcnt lgkmcnt(5)
    v_mfma_f32_32x32x16_bf16 v[192:207], v[36:39], v[100:103], v[192:207]
    ds_read_b128 v[28:31], v3 offset:14336
    v_exp_f32 v139, v139
    v_exp_f32 v140, v140
    s_waitcnt lgkmcnt(5)
    v_mfma_f32_32x32x16_bf16 v[208:223], v[40:43], v[100:103], v[208:223]
    ds_read_b128 v[32:35], v3 offset:3072
    v_exp_f32 v141, v141
    v_cvt_pk_bf16_f32 v109, v138, v139
    v_add_f32 v6, v6, v138
    v_add_f32 v7, v7, v139
    v_max3_f32 v5, v144, v145, v146
    v_max3_f32 v5, v5, v147, v148
    s_waitcnt lgkmcnt(5)
    v_mfma_f32_32x32x16_bf16 v[224:239], v[44:47], v[100:103], v[224:239]
    ds_read_b128 v[36:39], v3 offset:7168
    v_exp_f32 v142, v142
    v_cvt_pk_bf16_f32 v110, v140, v141
    v_add_f32 v6, v6, v140
    v_add_f32 v7, v7, v141
    v_max3_f32 v5, v5, v149, v150
    v_max3_f32 v5, v5, v151, v152
    s_waitcnt lgkmcnt(5)
    v_mfma_f32_32x32x16_bf16 v[176:191], v[16:19], v[104:107], v[176:191]
    ds_read_b128 v[40:43], v3 offset:11264
    v_exp_f32 v143, v143
    v_max3_f32 v5, v5, v153, v154
    s_waitcnt lgkmcnt(5)
    v_mfma_f32_32x32x16_bf16 v[192:207], v[20:23], v[104:107], v[192:207]
    ds_read_b128 v[44:47], v3 offset:15360
    v_cvt_pk_bf16_f32 v111, v142, v143
    v_add_f32 v6, v6, v142
    v_add_f32 v7, v7, v143
    v_max3_f32 v5, v5, v155, v156
    v_max3_f32 v5, v5, v157, v158
    s_waitcnt lgkmcnt(5)
    v_mfma_f32_32x32x16_bf16 v[208:223], v[24:27], v[104:107], v[208:223]
    v_max3_f32 v5, v5, v159, v160
    s_waitcnt lgkmcnt(4)
    v_mfma_f32_32x32x16_bf16 v[224:239], v[28:31], v[104:107], v[224:239]
    v_max3_f32 v5, v5, v161, v162
    v_max3_f32 v5, v5, v163, v164
    s_waitcnt vmcnt(0) lgkmcnt(0)
    s_barrier
    ds_read_b128 v[16:19], v2 offset:0
    ds_read_b128 v[20:23], v2 offset:8192
    ds_read_b128 v[24:27], v2 offset:1024
    ds_read_b128 v[28:31], v2 offset:9216
    v_mfma_f32_32x32x16_bf16 v[176:191], v[32:35], v[108:111], v[176:191]
    v_max3_f32 v5, v5, v165, v166
    v_max3_f32 v5, v5, v167, v168
    v_mfma_f32_32x32x16_bf16 v[192:207], v[36:39], v[108:111], v[192:207]
    ds_read_b128 v[32:35], v2 offset:2048
    v_max3_f32 v5, v5, v169, v170
    v_mfma_f32_32x32x16_bf16 v[208:223], v[40:43], v[108:111], v[208:223]
    ds_read_b128 v[36:39], v2 offset:10240
    v_max3_f32 v5, v5, v171, v172
    v_max3_f32 v5, v5, v173, v174
    v_mfma_f32_32x32x16_bf16 v[224:239], v[44:47], v[108:111], v[224:239]
    v_max_f32 v5, v5, v175
    s_cmp_eq_u32 s54, s55
    s_cbranch_scc1 at_fin0
    v_cmp_lt_f32 vcc, s50, v5
    s_add_u32 s54, s54, 1
    s_cmp_lg_u64 vcc, 0
    s_cbranch_scc1 at_rs0
at_it1:
    s_cmp_lg_u32 s54, s55
    s_cbranch_scc1 at_nq1
    ds_read_b128 v[48:51], v12 offset:0
    ds_read_b128 v[52:55], v12 offset:1024
    ds_read_b128 v[56:59], v12 offset:2048
    ds_read_b128 v[60:63], v12 offset:3072
    ds_read_b128 v[64:67], v12 offset:4096
    ds_read_b128 v[68:71], v12 offset:5120
    ds_read_b128 v[72:75], v12 offset:6144
    ds_read_b128 v[76:79], v12 offset:7168
    v_mov_b32 v8, v80
    v_mov_b32 v80, 0
    v_mov_b32 v81, 0
    v_mov_b32 v82, 0
    v_mov_b32 v83, 0
    v_mov_b32 v84, 0
    v_mov_b32 v85, 0
    v_mov_b32 v86, 0
    v_mov_b32 v87, 0
    v_mov_b32 v88, 0
    v_mov_b32 v89, 0
    v_mov_b32 v90, 0
    v_mov_b32 v91, 0
    v_mov_b32 v92, 0
    v_mov_b32 v93, 0
    v_mov_b32 v94, 0
    v_mov_b32 v95, 0
    s_waitcnt lgkmcnt(0)
at_nq1:
    s_waitcnt lgkmcnt(5)
    v_mfma_f32_32x32x16_bf16 v[112:127], v[16:19], v[48:51], v[80:95]
    ds_read_b128 v[40:43], v2 offset:3072
    v_exp_f32 v144, v144
    v_exp_f32 v145, v145
    s_add_u32 m0, s57, 32768
    s_nop 0
    buffer_load_dwordx4 v1, s[24:27], s58 offen offset:0 lds
    s_waitcnt lgkmcnt(5)
    v_mfma_f32_32x32x16_bf16 v[128:143], v[20:23], v[48:51], v[80:95]
    ds_read_b128 v[44:47], v2 offset:11264
    v_exp_f32 v146, v146
    v_cvt_pk_bf16_f32 v96, v144, v145
    v_add_f32 v6, v6, v144
    v_add_f32 v7, v7, v145
    s_waitcnt lgkmcnt(5)
    v_mfma_f32_32x32x16_bf16 v[112:127], v[24:27], v[52:55], v[112:127]
    ds_read_b128 v[16:19], v2 offset:4096
    v_exp_f32 v147, v147
    buffer_load_dwordx4 v1, s[24:27], s58 offen offset:1024 lds
    s_waitcnt lgkmcnt(5)
    v_mfma_f32_32x32x16_bf16 v[128:143], v[28:31], v[52:55], v[128:143]
    ds_read_b128 v[20:23], v2 offset:12288
    v_exp_f32 v148, v148
    v_exp_f32 v149, v149
    v_cvt_pk_bf16_f32 v97, v146, v147
    v_add_f32 v6, v6, v146
    v_add_f32 v7, v7, v147
    s_waitcnt lgkmcnt(5)
    v_mfma_f32_32x32x16_bf16 v[112:127], v[32:35], v[56:59], v[112:127]
    ds_read_b128 v[24:27], v2 offset:5120
    v_exp_f32 v150, v150
    v_cvt_pk_bf16_f32 v98, v148, v149
    v_add_f32 v6, v6, v148
    v_add_f32 v7, v7, v149
    buffer_load_dwordx4 v1, s[24:27], s58 offen offset:2048 lds
    s_waitcnt lgkmcnt(5)
    v_mfma_f32_32x32x16_bf16 v[128:143], v[36:39], v[56:59], v[128:143]
    ds_read_b128 v[28:31], v2 offset:13312
    v_exp_f32 v151, v151
    s_waitcnt lgkmcnt(5)
    v_mfma_f32_32x32x16_bf16 v[112:127], v[40:43], v[60:63], v[112:127]
    ds_read_b128 v[32:35], v2 offset:6144
    v_exp_f32 v152, v152
    v_cvt_pk_bf16_f32 v99, v150, v151
    v_add_f32 v6, v6, v150
    v_add_f32 v7, v7, v151
    buffer_load_dwordx4 v1, s[24:27], s58 offen offset:3072 lds
    s_add_u32 s58, s58, 0x8000
    s_cmp_eq_u32 s58, s48
    s_cselect_b32 s58, s49, s58
    s_waitcnt lgkmcnt(5)
    v_mfma_f32_32x32x16_bf16 v[128:143], v[44:47], v[60:63], v[128:143]
    ds_read_b128 v[36:39], v2 offset:14336
    v_exp_f32 v153, v153
    v_exp_f32 v154, v154
    s_waitcnt lgkmcnt(5)
    v_mfma_f32_32x32x16_bf16 v[112:127], v[16:19], v[64:67], v[112:127]
    ds_read_b128 v[40:43], v2 offset:7168
    v_exp_f32 v155, v155
    v_cvt_pk_bf16_f32 v100, v152, v153
    v_add_f32 v6, v6, v152
    v_add_f32 v7, v7, v153
    s_add_u32 m0, s57, 65536
    s_nop 0
    buffer_load_dwordx4 v1, s[28:31], s59 offen offset:0 lds
    s_waitcnt lgkmcnt(5)
    v_mfma_f32_32x32x16_bf16 v[128:143], v[20:23], v[64:67], v[128:143]
    ds_read_b128 v[44:47], v2 offset:15360
    v_exp_f32 v156, v156
    v_cvt_pk_bf16_f32 v101, v154, v155
    v_add_f32 v6, v6, v154
    v_add_f32 v7, v7, v155
    s_waitcnt lgkmcnt(5)
    v_mfma_f32_32x32x16_bf16 v[112:127], v[24:27], v[68:71], v[112:127]
    ds_read_b128 v[16:19], v3 offset:32768
    v_exp_f32 v157, v157
    v_exp_f32 v158, v158
    buffer_load_dwordx4 v1, s[28:31], s59 offen offset:1024 lds
    s_waitcnt lgkmcnt(5)
    v_mfma_f32_32x32x16_bf16 v[128:143], v[28:31], v[68:71], v[128:143]
    ds_read_b128 v[20:23], v3 offset:36864
    v_exp_f32 v159, v159
    v_cvt_pk_bf16_f32 v102, v156, v157
    v_add_f32 v6, v6, v156
    v_add_f32 v7, v7, v157
    s_waitcnt lgkmcnt(5)
    v_mfma_f32_32x32x16_bf16 v[112:127], v[32:35], v[72:75], v[112:127]
    ds_read_b128 v[24:27], v3 offset:40960
    v_exp_f32 v160, v160
    v_cvt_pk_bf16_f32 v103, v158, v159
    v_add_f32 v6, v6, v158
    v_add_f32 v7, v7, v159
    buffer_load_dwordx4 v1, s[28:31], s59 offen offset:2048 lds
    s_waitcnt lgkmcnt(5)
    v_mfma_f32_32x32x16_bf16 v[128:143], v[36:39], v[72:75], v[128:143]
    ds_read_b128 v[28:31], v3 offset:45056
    v_exp_f32 v161, v161
    s_waitcnt lgkmcnt(5)
    v_mfma_f32_32x32x16_bf16 v[112:127], v[40:43], v[76:79], v[112:127]
    ds_read_b128 v[32:35], v3 offset:33792
    v_exp_f32 v162, v162
    v_exp_f32 v163, v163
    v_cvt_pk_bf16_f32 v104, v160, v161
    v_add_f32 v6, v6, v160
    v_add_f32 v7, v7, v161
    buffer_load_dwordx4 v1, s[28:31], s59 offen offset:3072 lds
    s_add_u32 s59, s59, 0x8000
    s_cmp_eq_u32 s59, s48
    s_cselect_b32 s59, s49, s59
    s_waitcnt lgkmcnt(5)
    v_mfma_f32_32x32x16_bf16 v[128:143], v[44:47], v[76:79], v[128:143]
    ds_read_b128 v[36:39], v3 offset:37888
    v_exp_f32 v164, v164
    v_cvt_pk_bf16_f32 v105, v162, v163
    v_add_f32 v6, v6, v162
    v_add_f32 v7, v7, v163
    s_cmp_eq_u32 s54, s56
    s_cbranch_scc1 at_mask1
at_mret1:
    s_waitcnt lgkmcnt(5)
    v_mfma_f32_32x32x16_bf16 v[176:191], v[16:19], v[96:99], v[176:191]
    ds_read_b128 v[40:43], v3 offset:41984
    v_exp_f32 v165, v165
    s_waitcnt lgkmcnt(5)
    v_mfma_f32_32x32x16_bf16 v[192:207], v[20:23], v[96:99], v[192:207]
    ds_read_b128 v[44:47], v3 offset:46080
    v_exp_f32 v166, v166
    v_exp_f32 v167, v167
    v_cvt_pk_bf16_f32 v106, v164, v165
    v_add_f32 v6, v6, v164
    v_add_f32 v7, v7, v165
    s_waitcnt lgkmcnt(5)
    v_mfma_f32_32x32x16_bf16 v[208:223], v[24:27], v[96:99], v[208:223]
    ds_read_b128 v[16:19], v3 offset:34816
    v_exp_f32 v168, v168
    v_cvt_pk_bf16_f32 v107, v166, v167
    v_add_f32 v6, v6, v166
    v_add_f32 v7, v7, v167
    s_waitcnt lgkmcnt(5)
    v_mfma_f32_32x32x16_bf16 v[224:239], v[28:31], v[96:99], v[224:239]
    ds_read_b128 v[20:23], v3 offset:38912
    v_exp_f32 v169, v169
    s_waitcnt lgkmcnt(5)
    v_mfma_f32_32x32x16_bf16 v[176:191], v[32:35], v[100:103], v[176:191]
    ds_read_b128 v[24:27], v3 offset:43008
    v_exp_f32 v170, v170
    v_cvt_pk_bf16_f32 v108, v168, v169
    v_add_f32 v6, v6, v168
    v_add_f32 v7, v7, v169
    s_waitcnt lgkmcnt(5)
    v_mfma_f32_32x32x16_bf16 v[192:207], v[36:39], v[100:103], v[192:207]
    ds_read_b128 v[28:31], v3 offset:47104
    v_exp_f32 v171, v171
    v_exp_f32 v172, v172
    s_waitcnt lgkmcnt(5)
    v_mfma_f32_32x32x16_bf16 v[208:223], v[40:43], v[100:103], v[208:223]
    ds_read_b128 v[32:35], v3 offset:35840
    v_exp_f32 v173, v173
    v_cvt_pk_bf16_f32 v109, v170, v171
    v_add_f32 v6, v6, v170
    v_add_f32 v7, v7, v171
    v_max3_f32 v5, v112, v113, v114
    v_max3_f32 v5, v5, v115, v116
    s_waitcnt lgkmcnt(5)
    v_mfma_f32_32x32x16_bf16 v[224:239], v[44:47], v[100:103], v[224:239]
    ds_read_b128 v[36:39], v3 offset:39936
    v_exp_f32 v174, v174
    v_cvt_pk_bf16_f32 v110, v172, v173
    v_add_f32 v6, v6, v172
    v_add_f32 v7, v7, v173
    v_max3_f32 v5, v5, v117, v118
    v_max3_f32 v5, v5, v119, v120
    s_waitcnt lgkmcnt(5)
    v_mfma_f32_32x32x16_bf16 v[176:191], v[16:19], v[104:107], v[176:191]
    ds_read_b128 v[40:43], v3 offset:44032
    v_exp_f32 v175, v175
    v_max3_f32 v5, v5, v121, v122
    s_waitcnt lgkmcnt(5)
    v_mfma_f32_32x32x16_bf16 v[192:207], v[20:23], v[104:107], v[192:207]
    ds_read_b128 v[44:47], v3 offset:48128
    v_cvt_pk_bf16_f32 v111, v174, v175
    v_add_f32 v6, v6, v174
    v_add_f32 v7, v7, v175
    v_max3_f32 v5, v5, v123, v124
    v_max3_f32 v5, v5, v125, v126
    s_waitcnt lgkmcnt(5)
    v_mfma_f32_32x32x16_bf16 v[208:223], v[24:27], v[104:107], v[208:223]
    v_max3_f32 v5, v5, v127, v128
    s_waitcnt lgkmcnt(4)
    v_mfma_f32_32x32x16_bf16 v[224:239], v[28:31], v[104:107], v[224:239]
    v_max3_f32 v5, v5, v129, v130
    v_max3_f32 v5, v5, v131, v132
    s_waitcnt vmcnt(0) lgkmcnt(0)
    s_barrier
    ds_read_b128 v[16:19], v2 offset:32768
    ds_read_b128 v[20:23], v2 offset:40960
    ds_read_b128 v[24:27], v2 offset:33792
    ds_read_b128 v[28:31], v2 offset:41984
    v_mfma_f32_32x32x16_bf16 v[176:191], v[32:35], v[108:111], v[176:191]
    v_max3_f32 v5, v5, v133, v134
    v_max3_f32 v5, v5, v135, v136
    v_mfma_f32_32x32x16_bf16 v[192:207], v[36:39], v[108:111], v[192:207]
    ds_read_b128 v[32:35], v2 offset:34816
    v_max3_f32 v5, v5, v137, v138
    v_mfma_f32_32x32x16_bf16 v[208:223], v[40:43], v[108:111], v[208:223]
    ds_read_b128 v[36:39], v2 offset:43008
    v_max3_f32 v5, v5, v139, v140
    v_max3_f32 v5, v5, v141, v142
    v_mfma_f32_32x32x16_bf16 v[224:239], v[44:47], v[108:111], v[224:239]
    v_max_f32 v5, v5, v143
    s_cmp_eq_u32 s54, s55
    s_cbranch_scc1 at_fin1
    v_cmp_lt_f32 vcc, s50, v5
    s_add_u32 s54, s54, 1
    s_cmp_lg_u64 vcc, 0
    s_cbranch_scc1 at_rs1
    s_branch at_it0
at_rs0:
    v_mov_b32 v9, v5
    s_nop 7
    v_permlane32_swap_b32 v9, v5
    s_nop 1
    v_max3_f32 v5, v5, v9, 0
    v_mul_f32 v9, -1.0, v5
    v_exp_f32 v9, v9
    v_sub_f32 v80, v80, v5
    v_sub_f32 v81, v81, v5
    v_sub_f32 v82, v82, v5
    v_sub_f32 v83, v83, v5
    v_sub_f32 v84, v84, v5
    v_sub_f32 v85, v85, v5
    v_sub_f32 v86, v86, v5
    v_sub_f32 v87, v87, v5
    v_sub_f32 v88, v88, v5
    v_sub_f32 v89, v89, v5
    v_sub_f32 v90, v90, v5
    v_sub_f32 v91, v91, v5
    v_sub_f32 v92, v92, v5
    v_sub_f32 v93, v93, v5
    v_sub_f32 v94, v94, v5
    v_sub_f32 v95, v95, v5
    v_sub_f32 v144, v144, v5
    v_sub_f32 v145, v145, v5
    v_sub_f32 v146, v146, v5
    v_sub_f32 v147, v147, v5
    v_sub_f32 v148, v148, v5
    v_sub_f32 v149, v149, v5
    v_sub_f32 v150, v150, v5
    v_sub_f32 v151, v151, v5
    v_sub_f32 v152, v152, v5
    v_sub_f32 v153, v153, v5
    v_sub_f32 v154, v154, v5
    v_sub_f32 v155, v155, v5
    v_sub_f32 v156, v156, v5
    v_sub_f32 v157, v157, v5
    v_sub_f32 v158, v158, v5
    v_sub_f32 v159, v159, v5
    v_sub_f32 v160, v160, v5
    v_sub_f32 v161, v161, v5
    v_sub_f32 v162, v162, v5
    v_sub_f32 v163, v163, v5
    v_sub_f32 v164, v164, v5
    v_sub_f32 v165, v165, v5
    v_sub_f32 v166, v166, v5
    v_sub_f32 v167, v167, v5
    v_sub_f32 v168, v168, v5
    v_sub_f32 v169, v169, v5
    v_sub_f32 v170, v170, v5
    v_sub_f32 v171, v171, v5
    v_sub_f32 v172, v172, v5
    v_sub_f32 v173, v173, v5
    v_sub_f32 v174, v174, v5
    v_sub_f32 v175, v175, v5
    v_mul_f32 v176, v176, v9
    v_mul_f32 v177, v177, v9
    v_mul_f32 v178, v178, v9
    v_mul_f32 v179, v179, v9
    v_mul_f32 v180, v180, v9
    v_mul_f32 v181, v181, v9
    v_mul_f32 v182, v182, v9
    v_mul_f32 v183, v183, v9
    v_mul_f32 v184, v184, v9
    v_mul_f32 v185, v185, v9
    v_mul_f32 v186, v186, v9
    v_mul_f32 v187, v187, v9
    v_mul_f32 v188, v188, v9
    v_mul_f32 v189, v189, v9
    v_mul_f32 v190, v190, v9
    v_mul_f32 v191, v191, v9
    v_mul_f32 v192, v192, v9
    v_mul_f32 v193, v193, v9
    v_mul_f32 v194, v194, v9
    v_mul_f32 v195, v195, v9
    v_mul_f32 v196, v196, v9
    v_mul_f32 v197, v197, v9
    v_mul_f32 v198, v198, v9
    v_mul_f32 v199, v199, v9
    v_mul_f32 v200, v200, v9
    v_mul_f32 v201, v201, v9
    v_mul_f32 v202, v202, v9
    v_mul_f32 v203, v203, v9
    v_mul_f32 v204, v204, v9
    v_mul_f32 v205, v205, v9
    v_mul_f32 v206, v206, v9
    v_mul_f32 v207, v207, v9
    v_mul_f32 v208, v208, v9
    v_mul_f32 v209, v209, v9
    v_mul_f32 v210, v210, v9
    v_mul_f32 v211, v211, v9
    v_mul_f32 v212, v212, v9
    v_mul_f32 v213, v213, v9
    v_mul_f32 v214, v214, v9
    v_mul_f32 v215, v215, v9
    v_mul_f32 v216, v216, v9
    v_mul_f32 v217, v217, v9
    v_mul_f32 v218, v218, v9
    v_mul_f32 v219, v219, v9
    v_mul_f32 v220, v220, v9
    v_mul_f32 v221, v221, v9
    v_mul_f32 v222, v222, v9
    v_mul_f32 v223, v223, v9
    v_mul_f32 v224, v224, v9
    v_mul_f32 v225, v225, v9
    v_mul_f32 v226, v226, v9
    v_mul_f32 v227, v227, v9
    v_mul_f32 v228, v228, v9
    v_mul_f32 v229, v229, v9
    v_mul_f32 v230, v230, v9
    v_mul_f32 v231, v231, v9
    v_mul_f32 v232, v232, v9
    v_mul_f32 v233, v233, v9
    v_mul_f32 v234, v234, v9
    v_mul_f32 v235, v235, v9
    v_mul_f32 v236, v236, v9
    v_mul_f32 v237, v237, v9
    v_mul_f32 v238, v238, v9
    v_mul_f32 v239, v239, v9
    v_mul_f32 v6, v6, v9
    v_mul_f32 v7, v7, v9
    s_branch at_it1
at_fs0:
    v_mov_b32 v9, v5
    s_nop 7
    v_permlane32_swap_b32 v9, v5
    s_nop 1
    v_max_f32 v5, v5, v9
    v_sub_f32 v80, v80, v5
    v_sub_f32 v81, v81, v5
    v_sub_f32 v82, v82, v5
    v_sub_f32 v83, v83, v5
    v_sub_f32 v84, v84, v5
    v_sub_f32 v85, v85, v5
    v_sub_f32 v86, v86, v5
    v_sub_f32 v87, v87, v5
    v_sub_f32 v88, v88, v5
    v_sub_f32 v89, v89, v5
    v_sub_f32 v90, v90, v5
    v_sub_f32 v91, v91, v5
    v_sub_f32 v92, v92, v5
    v_sub_f32 v93, v93, v5
    v_sub_f32 v94, v94, v5
    v_sub_f32 v95, v95, v5
    v_sub_f32 v144, v144, v5
    v_sub_f32 v145, v145, v5
    v_sub_f32 v146, v146, v5
    v_sub_f32 v147, v147, v5
    v_sub_f32 v148, v148, v5
    v_sub_f32 v149, v149, v5
    v_sub_f32 v150, v150, v5
    v_sub_f32 v151, v151, v5
    v_sub_f32 v152, v152, v5
    v_sub_f32 v153, v153, v5
    v_sub_f32 v154, v154, v5
    v_sub_f32 v155, v155, v5
    v_sub_f32 v156, v156, v5
    v_sub_f32 v157, v157, v5
    v_sub_f32 v158, v158, v5
    v_sub_f32 v159, v159, v5
    v_sub_f32 v160, v160, v5
    v_sub_f32 v161, v161, v5
    v_sub_f32 v162, v162, v5
    v_sub_f32 v163, v163, v5
    v_sub_f32 v164, v164, v5
    v_sub_f32 v165, v165, v5
    v_sub_f32 v166, v166, v5
    v_sub_f32 v167, v167, v5
    v_sub_f32 v168, v168, v5
    v_sub_f32 v169, v169, v5
    v_sub_f32 v170, v170, v5
    v_sub_f32 v171, v171, v5
    v_sub_f32 v172, v172, v5
    v_sub_f32 v173, v173, v5
    v_sub_f32 v174, v174, v5
    v_sub_f32 v175, v175, v5
    s_branch at_it1
at_mask0:
    s_mov_b32 s56, 15
    v_mov_b32 v9, 0xf149f2ca
    s_nop 7
    s_nop 3
    v_cmp_gt_i32 s[60:61], 0, v4
    v_cmp_gt_i32 s[62:63], 1, v4
    v_cmp_gt_i32 s[64:65], 2, v4
    v_cmp_gt_i32 s[66:67], 3, v4
    s_nop 0
    v_cndmask_b32 v144, v144, v9, s[60:61]
    v_cndmask_b32 v145, v145, v9, s[62:63]
    v_cndmask_b32 v146, v146, v9, s[64:65]
    v_cndmask_b32 v147, v147, v9, s[66:67]
    v_cmp_gt_i32 s[60:61], 8, v4
    v_cmp_gt_i32 s[62:63], 9, v4
    v_cmp_gt_i32 s[64:65], 10, v4
    v_cmp_gt_i32 s[66:67], 11, v4
    s_nop 0
    v_cndmask_b32 v148, v148, v9, s[60:61]
    v_cndmask_b32 v149, v149, v9, s[62:63]
    v_cndmask_b32 v150, v150, v9, s[64:65]
    v_cndmask_b32 v151, v151, v9, s[66:67]
    v_cmp_gt_i32 s[60:61], 16, v4
    v_cmp_gt_i32 s[62:63], 17, v4
    v_cmp_gt_i32 s[64:65], 18, v4
    v_cmp_gt_i32 s[66:67], 19, v4
    s_nop 0
    v_cndmask_b32 v152, v152, v9, s[60:61]
    v_cndmask_b32 v153, v153, v9, s[62:63]
    v_cndmask_b32 v154, v154, v9, s[64:65]
    v_cndmask_b32 v155, v155, v9, s[66:67]
    v_cmp_gt_i32 s[60:61], 24, v4
    v_cmp_gt_i32 s[62:63], 25, v4
    v_cmp_gt_i32 s[64:65], 26, v4
    v_cmp_gt_i32 s[66:67], 27, v4
    s_nop 0
    v_cndmask_b32 v156, v156, v9, s[60:61]
    v_cndmask_b32 v157, v157, v9, s[62:63]
    v_cndmask_b32 v158, v158, v9, s[64:65]
    v_cndmask_b32 v159, v159, v9, s[66:67]
    v_cmp_gt_i32 s[60:61], 32, v4
    v_cmp_gt_i32 s[62:63], 33, v4
    v_cmp_gt_i32 s[64:65], 34, v4
    v_cmp_gt_i32 s[66:67], 35, v4
    s_nop 0
    v_cndmask_b32 v160, v160, v9, s[60:61]
    v_cndmask_b32 v161, v161, v9, s[62:63]
    v_cndmask_b32 v162, v162, v9, s[64:65]
    v_cndmask_b32 v163, v163, v9, s[66:67]
    v_cmp_gt_i32 s[60:61], 40, v4
    v_cmp_gt_i32 s[62:63], 41, v4
    v_cmp_gt_i32 s[64:65], 42, v4
    v_cmp_gt_i32 s[66:67], 43, v4
    s_nop 0
    v_cndmask_b32 v164, v164, v9, s[60:61]
    v_cndmask_b32 v165, v165, v9, s[62:63]
    v_cndmask_b32 v166, v166, v9, s[64:65]
    v_cndmask_b32 v167, v167, v9, s[66:67]
    v_cmp_gt_i32 s[60:61], 48, v4
    v_cmp_gt_i32 s[62:63], 49, v4
    v_cmp_gt_i32 s[64:65], 50, v4
    v_cmp_gt_i32 s[66:67], 51, v4
    s_nop 0
    v_cndmask_b32 v168, v168, v9, s[60:61]
    v_cndmask_b32 v169, v169, v9, s[62:63]
    v_cndmask_b32 v170, v170, v9, s[64:65]
    v_cndmask_b32 v171, v171, v9, s[66:67]
    v_cmp_gt_i32 s[60:61], 56, v4
    v_cmp_gt_i32 s[62:63], 57, v4
    v_cmp_gt_i32 s[64:65], 58, v4
    v_cmp_gt_i32 s[66:67], 59, v4
    s_nop 0
    v_cndmask_b32 v172, v172, v9, s[60:61]
    v_cndmask_b32 v173, v173, v9, s[62:63]
    v_cndmask_b32 v174, v174, v9, s[64:65]
    v_cndmask_b32 v175, v175, v9, s[66:67]
    s_branch at_mret0
at_fin0:
    v_add_f32 v6, v6, v7
    v_mov_b32 v7, v6
    s_nop 1
    v_permlane32_swap_b32 v7, v6
    s_nop 1
    v_add_f32 v6, v6, v7
    v_mov_b32 v9, v6
    s_nop 1
    ds_write_b64 v15, v[8:9]
    s_nop 3
    s_cmp_eq_u32 s42, 0
    s_cbranch_scc0 at_mg1_0
    ds_write_b128 v13, v[208:211] offset:32768
    ds_write_b128 v13, v[212:215] offset:33792
    ds_write_b128 v13, v[216:219] offset:34816
    ds_write_b128 v13, v[220:223] offset:35840
    ds_write_b128 v13, v[224:227] offset:36864
    ds_write_b128 v13, v[228:231] offset:37888
    ds_write_b128 v13, v[232:235] offset:38912
    ds_write_b128 v13, v[236:239] offset:39936
    s_waitcnt lgkmcnt(0)
    s_barrier
    v_xor_b32 v9, 0x800, v15
    ds_read_b64 v[10:11], v9
    ds_read_b128 v[208:211], v14 offset:0
    ds_read_b128 v[212:215], v14 offset:1024
    ds_read_b128 v[216:219], v14 offset:2048
    ds_read_b128 v[220:223], v14 offset:3072
    ds_read_b128 v[224:227], v14 offset:4096
    ds_read_b128 v[228:231], v14 offset:5120
    ds_read_b128 v[232:235], v14 offset:6144
    ds_read_b128 v[236:239], v14 offset:7168
    s_waitcnt lgkmcnt(8)
    v_min_f32 v9, v8, v10
    v_sub_f32 v8, v9, v8
    v_sub_f32 v10, v9, v10
    v_exp_f32 v8, v8
    v_exp_f32 v10, v10
    s_nop 0
    v_mul_f32 v6, v6, v8
    v_fmac_f32 v6, v11, v10
    v_rcp_f32 v6, v6
    s_nop 0
    v_mul_f32 v8, v8, v6
    v_mul_f32 v10, v10, v6
    v_mul_f32 v176, v176, v8
    v_mul_f32 v177, v177, v8
    v_mul_f32 v178, v178, v8
    v_mul_f32 v179, v179, v8
    v_mul_f32 v180, v180, v8
    v_mul_f32 v181, v181, v8
    v_mul_f32 v182, v182, v8
    v_mul_f32 v183, v183, v8
    v_mul_f32 v184, v184, v8
    v_mul_f32 v185, v185, v8
    v_mul_f32 v186, v186, v8
    v_mul_f32 v187, v187, v8
    v_mul_f32 v188, v188, v8
    v_mul_f32 v189, v189, v8
    v_mul_f32 v190, v190, v8
    v_mul_f32 v191, v191, v8
    v_mul_f32 v192, v192, v8
    v_mul_f32 v193, v193, v8
    v_mul_f32 v194, v194, v8
    v_mul_f32 v195, v195, v8
    v_mul_f32 v196, v196, v8
    v_mul_f32 v197, v197, v8
    v_mul_f32 v198, v198, v8
    v_mul_f32 v199, v199, v8
    v_mul_f32 v200, v200, v8
    v_mul_f32 v201, v201, v8
    v_mul_f32 v202, v202, v8
    v_mul_f32 v203, v203, v8
    v_mul_f32 v204, v204, v8
    v_mul_f32 v205, v205, v8
    v_mul_f32 v206, v206, v8
    v_mul_f32 v207, v207, v8
    s_waitcnt lgkmcnt(0)
    v_fmac_f32 v176, v208, v10
    v_fmac_f32 v177, v209, v10
    v_fmac_f32 v178, v210, v10
    v_fmac_f32 v179, v211, v10
    v_fmac_f32 v180, v212, v10
    v_fmac_f32 v181, v213, v10
    v_fmac_f32 v182, v214, v10
    v_fmac_f32 v183, v215, v10
    v_fmac_f32 v184, v216, v10
    v_fmac_f32 v185, v217, v10
    v_fmac_f32 v186, v218, v10
    v_fmac_f32 v187, v219, v10
    v_fmac_f32 v188, v220, v10
    v_fmac_f32 v189, v221, v10
    v_fmac_f32 v190, v222, v10
    v_fmac_f32 v191, v223, v10
    v_fmac_f32 v192, v224, v10
    v_fmac_f32 v193, v225, v10
    v_fmac_f32 v194, v226, v10
    v_fmac_f32 v195, v227, v10
    v_fmac_f32 v196, v228, v10
    v_fmac_f32 v197, v229, v10
    v_fmac_f32 v198, v230, v10
    v_fmac_f32 v199, v231, v10
    v_fmac_f32 v200, v232, v10
    v_fmac_f32 v201, v233, v10
    v_fmac_f32 v202, v234, v10
    v_fmac_f32 v203, v235, v10
    v_fmac_f32 v204, v236, v10
    v_fmac_f32 v205, v237, v10
    v_fmac_f32 v206, v238, v10
    v_fmac_f32 v207, v239, v10
    v_cvt_pk_bf16_f32 v96, v176, v177
    v_cvt_pk_bf16_f32 v97, v178, v179
    v_cvt_pk_bf16_f32 v98, v180, v181
    v_cvt_pk_bf16_f32 v99, v182, v183
    v_cvt_pk_bf16_f32 v100, v184, v185
    v_cvt_pk_bf16_f32 v101, v186, v187
    v_cvt_pk_bf16_f32 v102, v188, v189
    v_cvt_pk_bf16_f32 v103, v190, v191
    v_cvt_pk_bf16_f32 v104, v192, v193
    v_cvt_pk_bf16_f32 v105, v194, v195
    v_cvt_pk_bf16_f32 v106, v196, v197
    v_cvt_pk_bf16_f32 v107, v198, v199
    v_cvt_pk_bf16_f32 v108, v200, v201
    v_cvt_pk_bf16_f32 v109, v202, v203
    v_cvt_pk_bf16_f32 v110, v204, v205
    v_cvt_pk_bf16_f32 v111, v206, v207
    buffer_store_dwordx4 v[96:99], v1, s[20:23], s52 offen offset:0 sc0 sc1
    buffer_store_dwordx4 v[100:103], v1, s[20:23], s52 offen offset:1024 sc0 sc1
    buffer_store_dwordx4 v[104:107], v1, s[20:23], s52 offen offset:2048 sc0 sc1
    buffer_store_dwordx4 v[108:111], v1, s[20:23], s52 offen offset:3072 sc0 sc1
    s_branch at_mgd0
at_mg1_0:
    ds_write_b128 v14, v[176:179] offset:0
    ds_write_b128 v14, v[180:183] offset:1024
    ds_write_b128 v14, v[184:187] offset:2048
    ds_write_b128 v14, v[188:191] offset:3072
    ds_write_b128 v14, v[192:195] offset:4096
    ds_write_b128 v14, v[196:199] offset:5120
    ds_write_b128 v14, v[200:203] offset:6144
    ds_write_b128 v14, v[204:207] offset:7168
    s_waitcnt lgkmcnt(0)
    s_barrier
    v_xor_b32 v9, 0x800, v15
    ds_read_b64 v[10:11], v9
    ds_read_b128 v[176:179], v13 offset:32768
    ds_read_b128 v[180:183], v13 offset:33792
    ds_read_b128 v[184:187], v13 offset:34816
    ds_read_b128 v[188:191], v13 offset:35840
    ds_read_b128 v[192:195], v13 offset:36864
    ds_read_b128 v[196:199], v13 offset:37888
    ds_read_b128 v[200:203], v13 offset:38912
    ds_read_b128 v[204:207], v13 offset:39936
    s_waitcnt lgkmcnt(8)
    v_min_f32 v9, v8, v10
    v_sub_f32 v8, v9, v8
    v_sub_f32 v10, v9, v10
    v_exp_f32 v8, v8
    v_exp_f32 v10, v10
    s_nop 0
    v_mul_f32 v6, v6, v8
    v_fmac_f32 v6, v11, v10
    v_rcp_f32 v6, v6
    s_nop 0
    v_mul_f32 v8, v8, v6
    v_mul_f32 v10, v10, v6
    v_mul_f32 v208, v208, v8
    v_mul_f32 v209, v209, v8
    v_mul_f32 v210, v210, v8
    v_mul_f32 v211, v211, v8
    v_mul_f32 v212, v212, v8
    v_mul_f32 v213, v213, v8
    v_mul_f32 v214, v214, v8
    v_mul_f32 v215, v215, v8
    v_mul_f32 v216, v216, v8
    v_mul_f32 v217, v217, v8
    v_mul_f32 v218, v218, v8
    v_mul_f32 v219, v219, v8
    v_mul_f32 v220, v220, v8
    v_mul_f32 v221, v221, v8
    v_mul_f32 v222, v222, v8
    v_mul_f32 v223, v223, v8
    v_mul_f32 v224, v224, v8
    v_mul_f32 v225, v225, v8
    v_mul_f32 v226, v226, v8
    v_mul_f32 v227, v227, v8
    v_mul_f32 v228, v228, v8
    v_mul_f32 v229, v229, v8
    v_mul_f32 v230, v230, v8
    v_mul_f32 v231, v231, v8
    v_mul_f32 v232, v232, v8
    v_mul_f32 v233, v233, v8
    v_mul_f32 v234, v234, v8
    v_mul_f32 v235, v235, v8
    v_mul_f32 v236, v236, v8
    v_mul_f32 v237, v237, v8
    v_mul_f32 v238, v238, v8
    v_mul_f32 v239, v239, v8
    s_waitcnt lgkmcnt(0)
    v_fmac_f32 v208, v176, v10
    v_fmac_f32 v209, v177, v10
    v_fmac_f32 v210, v178, v10
    v_fmac_f32 v211, v179, v10
    v_fmac_f32 v212, v180, v10
    v_fmac_f32 v213, v181, v10
    v_fmac_f32 v214, v182, v10
    v_fmac_f32 v215, v183, v10
    v_fmac_f32 v216, v184, v10
    v_fmac_f32 v217, v185, v10
    v_fmac_f32 v218, v186, v10
    v_fmac_f32 v219, v187, v10
    v_fmac_f32 v220, v188, v10
    v_fmac_f32 v221, v189, v10
    v_fmac_f32 v222, v190, v10
    v_fmac_f32 v223, v191, v10
    v_fmac_f32 v224, v192, v10
    v_fmac_f32 v225, v193, v10
    v_fmac_f32 v226, v194, v10
    v_fmac_f32 v227, v195, v10
    v_fmac_f32 v228, v196, v10
    v_fmac_f32 v229, v197, v10
    v_fmac_f32 v230, v198, v10
    v_fmac_f32 v231, v199, v10
    v_fmac_f32 v232, v200, v10
    v_fmac_f32 v233, v201, v10
    v_fmac_f32 v234, v202, v10
    v_fmac_f32 v235, v203, v10
    v_fmac_f32 v236, v204, v10
    v_fmac_f32 v237, v205, v10
    v_fmac_f32 v238, v206, v10
    v_fmac_f32 v239, v207, v10
    v_cvt_pk_bf16_f32 v96, v208, v209
    v_cvt_pk_bf16_f32 v97, v210, v211
    v_cvt_pk_bf16_f32 v98, v212, v213
    v_cvt_pk_bf16_f32 v99, v214, v215
    v_cvt_pk_bf16_f32 v100, v216, v217
    v_cvt_pk_bf16_f32 v101, v218, v219
    v_cvt_pk_bf16_f32 v102, v220, v221
    v_cvt_pk_bf16_f32 v103, v222, v223
    v_cvt_pk_bf16_f32 v104, v224, v225
    v_cvt_pk_bf16_f32 v105, v226, v227
    v_cvt_pk_bf16_f32 v106, v228, v229
    v_cvt_pk_bf16_f32 v107, v230, v231
    v_cvt_pk_bf16_f32 v108, v232, v233
    v_cvt_pk_bf16_f32 v109, v234, v235
    v_cvt_pk_bf16_f32 v110, v236, v237
    v_cvt_pk_bf16_f32 v111, v238, v239
    buffer_store_dwordx4 v[96:99], v1, s[20:23], s52 offen offset:0 sc0 sc1
    buffer_store_dwordx4 v[100:103], v1, s[20:23], s52 offen offset:1024 sc0 sc1
    buffer_store_dwordx4 v[104:107], v1, s[20:23], s52 offen offset:2048 sc0 sc1
    buffer_store_dwordx4 v[108:111], v1, s[20:23], s52 offen offset:3072 sc0 sc1
    s_branch at_mgd0
at_mgd0:
    s_cmp_eq_u32 s54, 16
    s_cbranch_scc1 at_done
    s_barrier
    s_mov_b32 s55, 16
    s_mov_b32 s52, s53
    s_add_u32 s54, s54, 1
    v_mov_b32 v6, 0
    v_mov_b32 v7, 0
    v_mov_b32 v176, 0
    v_mov_b32 v177, 0
    v_mov_b32 v178, 0
    v_mov_b32 v179, 0
    v_mov_b32 v180, 0
    v_mov_b32 v181, 0
    v_mov_b32 v182, 0
    v_mov_b32 v183, 0
    v_mov_b32 v184, 0
    v_mov_b32 v185, 0
    v_mov_b32 v186, 0
    v_mov_b32 v187, 0
    v_mov_b32 v188, 0
    v_mov_b32 v189, 0
    v_mov_b32 v190, 0
    v_mov_b32 v191, 0
    v_mov_b32 v192, 0
    v_mov_b32 v193, 0
    v_mov_b32 v194, 0
    v_mov_b32 v195, 0
    v_mov_b32 v196, 0
    v_mov_b32 v197, 0
    v_mov_b32 v198, 0
    v_mov_b32 v199, 0
    v_mov_b32 v200, 0
    v_mov_b32 v201, 0
    v_mov_b32 v202, 0
    v_mov_b32 v203, 0
    v_mov_b32 v204, 0
    v_mov_b32 v205, 0
    v_mov_b32 v206, 0
    v_mov_b32 v207, 0
    v_mov_b32 v208, 0
    v_mov_b32 v209, 0
    v_mov_b32 v210, 0
    v_mov_b32 v211, 0
    v_mov_b32 v212, 0
    v_mov_b32 v213, 0
    v_mov_b32 v214, 0
    v_mov_b32 v215, 0
    v_mov_b32 v216, 0
    v_mov_b32 v217, 0
    v_mov_b32 v218, 0
    v_mov_b32 v219, 0
    v_mov_b32 v220, 0
    v_mov_b32 v221, 0
    v_mov_b32 v222, 0
    v_mov_b32 v223, 0
    v_mov_b32 v224, 0
    v_mov_b32 v225, 0
    v_mov_b32 v226, 0
    v_mov_b32 v227, 0
    v_mov_b32 v228, 0
    v_mov_b32 v229, 0
    v_mov_b32 v230, 0
    v_mov_b32 v231, 0
    v_mov_b32 v232, 0
    v_mov_b32 v233, 0
    v_mov_b32 v234, 0
    v_mov_b32 v235, 0
    v_mov_b32 v236, 0
    v_mov_b32 v237, 0
    v_mov_b32 v238, 0
    v_mov_b32 v239, 0
    s_branch at_fs0
at_rs1:
    v_mov_b32 v9, v5
    s_nop 7
    v_permlane32_swap_b32 v9, v5
    s_nop 1
    v_max3_f32 v5, v5, v9, 0
    v_mul_f32 v9, -1.0, v5
    v_exp_f32 v9, v9
    v_sub_f32 v80, v80, v5
    v_sub_f32 v81, v81, v5
    v_sub_f32 v82, v82, v5
    v_sub_f32 v83, v83, v5
    v_sub_f32 v84, v84, v5
    v_sub_f32 v85, v85, v5
    v_sub_f32 v86, v86, v5
    v_sub_f32 v87, v87, v5
    v_sub_f32 v88, v88, v5
    v_sub_f32 v89, v89, v5
    v_sub_f32 v90, v90, v5
    v_sub_f32 v91, v91, v5
    v_sub_f32 v92, v92, v5
    v_sub_f32 v93, v93, v5
    v_sub_f32 v94, v94, v5
    v_sub_f32 v95, v95, v5
    v_sub_f32 v112, v112, v5
    v_sub_f32 v113, v113, v5
    v_sub_f32 v114, v114, v5
    v_sub_f32 v115, v115, v5
    v_sub_f32 v116, v116, v5
    v_sub_f32 v117, v117, v5
    v_sub_f32 v118, v118, v5
    v_sub_f32 v119, v119, v5
    v_sub_f32 v120, v120, v5
    v_sub_f32 v121, v121, v5
    v_sub_f32 v122, v122, v5
    v_sub_f32 v123, v123, v5
    v_sub_f32 v124, v124, v5
    v_sub_f32 v125, v125, v5
    v_sub_f32 v126, v126, v5
    v_sub_f32 v127, v127, v5
    v_sub_f32 v128, v128, v5
    v_sub_f32 v129, v129, v5
    v_sub_f32 v130, v130, v5
    v_sub_f32 v131, v131, v5
    v_sub_f32 v132, v132, v5
    v_sub_f32 v133, v133, v5
    v_sub_f32 v134, v134, v5
    v_sub_f32 v135, v135, v5
    v_sub_f32 v136, v136, v5
    v_sub_f32 v137, v137, v5
    v_sub_f32 v138, v138, v5
    v_sub_f32 v139, v139, v5
    v_sub_f32 v140, v140, v5
    v_sub_f32 v141, v141, v5
    v_sub_f32 v142, v142, v5
    v_sub_f32 v143, v143, v5
    v_mul_f32 v176, v176, v9
    v_mul_f32 v177, v177, v9
    v_mul_f32 v178, v178, v9
    v_mul_f32 v179, v179, v9
    v_mul_f32 v180, v180, v9
    v_mul_f32 v181, v181, v9
    v_mul_f32 v182, v182, v9
    v_mul_f32 v183, v183, v9
    v_mul_f32 v184, v184, v9
    v_mul_f32 v185, v185, v9
    v_mul_f32 v186, v186, v9
    v_mul_f32 v187, v187, v9
    v_mul_f32 v188, v188, v9
    v_mul_f32 v189, v189, v9
    v_mul_f32 v190, v190, v9
    v_mul_f32 v191, v191, v9
    v_mul_f32 v192, v192, v9
    v_mul_f32 v193, v193, v9
    v_mul_f32 v194, v194, v9
    v_mul_f32 v195, v195, v9
    v_mul_f32 v196, v196, v9
    v_mul_f32 v197, v197, v9
    v_mul_f32 v198, v198, v9
    v_mul_f32 v199, v199, v9
    v_mul_f32 v200, v200, v9
    v_mul_f32 v201, v201, v9
    v_mul_f32 v202, v202, v9
    v_mul_f32 v203, v203, v9
    v_mul_f32 v204, v204, v9
    v_mul_f32 v205, v205, v9
    v_mul_f32 v206, v206, v9
    v_mul_f32 v207, v207, v9
    v_mul_f32 v208, v208, v9
    v_mul_f32 v209, v209, v9
    v_mul_f32 v210, v210, v9
    v_mul_f32 v211, v211, v9
    v_mul_f32 v212, v212, v9
    v_mul_f32 v213, v213, v9
    v_mul_f32 v214, v214, v9
    v_mul_f32 v215, v215, v9
    v_mul_f32 v216, v216, v9
    v_mul_f32 v217, v217, v9
    v_mul_f32 v218, v218, v9
    v_mul_f32 v219, v219, v9
    v_mul_f32 v220, v220, v9
    v_mul_f32 v221, v221, v9
    v_mul_f32 v222, v222, v9
    v_mul_f32 v223, v223, v9
    v_mul_f32 v224, v224, v9
    v_mul_f32 v225, v225, v9
    v_mul_f32 v226, v226, v9
    v_mul_f32 v227, v227, v9
    v_mul_f32 v228, v228, v9
    v_mul_f32 v229, v229, v9
    v_mul_f32 v230, v230, v9
    v_mul_f32 v231, v231, v9
    v_mul_f32 v232, v232, v9
    v_mul_f32 v233, v233, v9
    v_mul_f32 v234, v234, v9
    v_mul_f32 v235, v235, v9
    v_mul_f32 v236, v236, v9
    v_mul_f32 v237, v237, v9
    v_mul_f32 v238, v238, v9
    v_mul_f32 v239, v239, v9
    v_mul_f32 v6, v6, v9
    v_mul_f32 v7, v7, v9
    s_branch at_it0
at_fs1:
    v_mov_b32 v9, v5
    s_nop 7
    v_permlane32_swap_b32 v9, v5
    s_nop 1
    v_max_f32 v5, v5, v9
    v_sub_f32 v80, v80, v5
    v_sub_f32 v81, v81, v5
    v_sub_f32 v82, v82, v5
    v_sub_f32 v83, v83, v5
    v_sub_f32 v84, v84, v5
    v_sub_f32 v85, v85, v5
    v_sub_f32 v86, v86, v5
    v_sub_f32 v87, v87, v5
    v_sub_f32 v88, v88, v5
    v_sub_f32 v89, v89, v5
    v_sub_f32 v90, v90, v5
    v_sub_f32 v91, v91, v5
    v_sub_f32 v92, v92, v5
    v_sub_f32 v93, v93, v5
    v_sub_f32 v94, v94, v5
    v_sub_f32 v95, v95, v5
    v_sub_f32 v112, v112, v5
    v_sub_f32 v113, v113, v5
    v_sub_f32 v114, v114, v5
    v_sub_f32 v115, v115, v5
    v_sub_f32 v116, v116, v5
    v_sub_f32 v117, v117, v5
    v_sub_f32 v118, v118, v5
    v_sub_f32 v119, v119, v5
    v_sub_f32 v120, v120, v5
    v_sub_f32 v121, v121, v5
    v_sub_f32 v122, v122, v5
    v_sub_f32 v123, v123, v5
    v_sub_f32 v124, v124, v5
    v_sub_f32 v125, v125, v5
    v_sub_f32 v126, v126, v5
    v_sub_f32 v127, v127, v5
    v_sub_f32 v128, v128, v5
    v_sub_f32 v129, v129, v5
    v_sub_f32 v130, v130, v5
    v_sub_f32 v131, v131, v5
    v_sub_f32 v132, v132, v5
    v_sub_f32 v133, v133, v5
    v_sub_f32 v134, v134, v5
    v_sub_f32 v135, v135, v5
    v_sub_f32 v136, v136, v5
    v_sub_f32 v137, v137, v5
    v_sub_f32 v138, v138, v5
    v_sub_f32 v139, v139, v5
    v_sub_f32 v140, v140, v5
    v_sub_f32 v141, v141, v5
    v_sub_f32 v142, v142, v5
    v_sub_f32 v143, v143, v5
    s_branch at_it0
at_mask1:
    s_mov_b32 s56, 15
    v_mov_b32 v9, 0xf149f2ca
    s_nop 7
    s_nop 3
    v_cmp_gt_i32 s[60:61], 0, v4
    v_cmp_gt_i32 s[62:63], 1, v4
    v_cmp_gt_i32 s[64:65], 2, v4
    v_cmp_gt_i32 s[66:67], 3, v4
    s_nop 0
    v_cndmask_b32 v112, v112, v9, s[60:61]
    v_cndmask_b32 v113, v113, v9, s[62:63]
    v_cndmask_b32 v114, v114, v9, s[64:65]
    v_cndmask_b32 v115, v115, v9, s[66:67]
    v_cmp_gt_i32 s[60:61], 8, v4
    v_cmp_gt_i32 s[62:63], 9, v4
    v_cmp_gt_i32 s[64:65], 10, v4
    v_cmp_gt_i32 s[66:67], 11, v4
    s_nop 0
    v_cndmask_b32 v116, v116, v9, s[60:61]
    v_cndmask_b32 v117, v117, v9, s[62:63]
    v_cndmask_b32 v118, v118, v9, s[64:65]
    v_cndmask_b32 v119, v119, v9, s[66:67]
    v_cmp_gt_i32 s[60:61], 16, v4
    v_cmp_gt_i32 s[62:63], 17, v4
    v_cmp_gt_i32 s[64:65], 18, v4
    v_cmp_gt_i32 s[66:67], 19, v4
    s_nop 0
    v_cndmask_b32 v120, v120, v9, s[60:61]
    v_cndmask_b32 v121, v121, v9, s[62:63]
    v_cndmask_b32 v122, v122, v9, s[64:65]
    v_cndmask_b32 v123, v123, v9, s[66:67]
    v_cmp_gt_i32 s[60:61], 24, v4
    v_cmp_gt_i32 s[62:63], 25, v4
    v_cmp_gt_i32 s[64:65], 26, v4
    v_cmp_gt_i32 s[66:67], 27, v4
    s_nop 0
    v_cndmask_b32 v124, v124, v9, s[60:61]
    v_cndmask_b32 v125, v125, v9, s[62:63]
    v_cndmask_b32 v126, v126, v9, s[64:65]
    v_cndmask_b32 v127, v127, v9, s[66:67]
    v_cmp_gt_i32 s[60:61], 32, v4
    v_cmp_gt_i32 s[62:63], 33, v4
    v_cmp_gt_i32 s[64:65], 34, v4
    v_cmp_gt_i32 s[66:67], 35, v4
    s_nop 0
    v_cndmask_b32 v128, v128, v9, s[60:61]
    v_cndmask_b32 v129, v129, v9, s[62:63]
    v_cndmask_b32 v130, v130, v9, s[64:65]
    v_cndmask_b32 v131, v131, v9, s[66:67]
    v_cmp_gt_i32 s[60:61], 40, v4
    v_cmp_gt_i32 s[62:63], 41, v4
    v_cmp_gt_i32 s[64:65], 42, v4
    v_cmp_gt_i32 s[66:67], 43, v4
    s_nop 0
    v_cndmask_b32 v132, v132, v9, s[60:61]
    v_cndmask_b32 v133, v133, v9, s[62:63]
    v_cndmask_b32 v134, v134, v9, s[64:65]
    v_cndmask_b32 v135, v135, v9, s[66:67]
    v_cmp_gt_i32 s[60:61], 48, v4
    v_cmp_gt_i32 s[62:63], 49, v4
    v_cmp_gt_i32 s[64:65], 50, v4
    v_cmp_gt_i32 s[66:67], 51, v4
    s_nop 0
    v_cndmask_b32 v136, v136, v9, s[60:61]
    v_cndmask_b32 v137, v137, v9, s[62:63]
    v_cndmask_b32 v138, v138, v9, s[64:65]
    v_cndmask_b32 v139, v139, v9, s[66:67]
    v_cmp_gt_i32 s[60:61], 56, v4
    v_cmp_gt_i32 s[62:63], 57, v4
    v_cmp_gt_i32 s[64:65], 58, v4
    v_cmp_gt_i32 s[66:67], 59, v4
    s_nop 0
    v_cndmask_b32 v140, v140, v9, s[60:61]
    v_cndmask_b32 v141, v141, v9, s[62:63]
    v_cndmask_b32 v142, v142, v9, s[64:65]
    v_cndmask_b32 v143, v143, v9, s[66:67]
    s_branch at_mret1
at_fin1:
    v_add_f32 v6, v6, v7
    v_mov_b32 v7, v6
    s_nop 1
    v_permlane32_swap_b32 v7, v6
    s_nop 1
    v_add_f32 v6, v6, v7
    v_mov_b32 v9, v6
    s_nop 1
    ds_write_b64 v15, v[8:9]
    s_nop 3
    s_cmp_eq_u32 s42, 0
    s_cbranch_scc0 at_mg1_1
    ds_write_b128 v13, v[208:211] offset:0
    ds_write_b128 v13, v[212:215] offset:1024
    ds_write_b128 v13, v[216:219] offset:2048
    ds_write_b128 v13, v[220:223] offset:3072
    ds_write_b128 v13, v[224:227] offset:4096
    ds_write_b128 v13, v[228:231] offset:5120
    ds_write_b128 v13, v[232:235] offset:6144
    ds_write_b128 v13, v[236:239] offset:7168
    s_waitcnt lgkmcnt(0)
    s_barrier
    v_xor_b32 v9, 0x800, v15
    ds_read_b64 v[10:11], v9
    ds_read_b128 v[208:211], v14 offset:32768
    ds_read_b128 v[212:215], v14 offset:33792
    ds_read_b128 v[216:219], v14 offset:34816
    ds_read_b128 v[220:223], v14 offset:35840
    ds_read_b128 v[224:227], v14 offset:36864
    ds_read_b128 v[228:231], v14 offset:37888
    ds_read_b128 v[232:235], v14 offset:38912
    ds_read_b128 v[236:239], v14 offset:39936
    s_waitcnt lgkmcnt(8)
    v_min_f32 v9, v8, v10
    v_sub_f32 v8, v9, v8
    v_sub_f32 v10, v9, v10
    v_exp_f32 v8, v8
    v_exp_f32 v10, v10
    s_nop 0
    v_mul_f32 v6, v6, v8
    v_fmac_f32 v6, v11, v10
    v_rcp_f32 v6, v6
    s_nop 0
    v_mul_f32 v8, v8, v6
    v_mul_f32 v10, v10, v6
    v_mul_f32 v176, v176, v8
    v_mul_f32 v177, v177, v8
    v_mul_f32 v178, v178, v8
    v_mul_f32 v179, v179, v8
    v_mul_f32 v180, v180, v8
    v_mul_f32 v181, v181, v8
    v_mul_f32 v182, v182, v8
    v_mul_f32 v183, v183, v8
    v_mul_f32 v184, v184, v8
    v_mul_f32 v185, v185, v8
    v_mul_f32 v186, v186, v8
    v_mul_f32 v187, v187, v8
    v_mul_f32 v188, v188, v8
    v_mul_f32 v189, v189, v8
    v_mul_f32 v190, v190, v8
    v_mul_f32 v191, v191, v8
    v_mul_f32 v192, v192, v8
    v_mul_f32 v193, v193, v8
    v_mul_f32 v194, v194, v8
    v_mul_f32 v195, v195, v8
    v_mul_f32 v196, v196, v8
    v_mul_f32 v197, v197, v8
    v_mul_f32 v198, v198, v8
    v_mul_f32 v199, v199, v8
    v_mul_f32 v200, v200, v8
    v_mul_f32 v201, v201, v8
    v_mul_f32 v202, v202, v8
    v_mul_f32 v203, v203, v8
    v_mul_f32 v204, v204, v8
    v_mul_f32 v205, v205, v8
    v_mul_f32 v206, v206, v8
    v_mul_f32 v207, v207, v8
    s_waitcnt lgkmcnt(0)
    v_fmac_f32 v176, v208, v10
    v_fmac_f32 v177, v209, v10
    v_fmac_f32 v178, v210, v10
    v_fmac_f32 v179, v211, v10
    v_fmac_f32 v180, v212, v10
    v_fmac_f32 v181, v213, v10
    v_fmac_f32 v182, v214, v10
    v_fmac_f32 v183, v215, v10
    v_fmac_f32 v184, v216, v10
    v_fmac_f32 v185, v217, v10
    v_fmac_f32 v186, v218, v10
    v_fmac_f32 v187, v219, v10
    v_fmac_f32 v188, v220, v10
    v_fmac_f32 v189, v221, v10
    v_fmac_f32 v190, v222, v10
    v_fmac_f32 v191, v223, v10
    v_fmac_f32 v192, v224, v10
    v_fmac_f32 v193, v225, v10
    v_fmac_f32 v194, v226, v10
    v_fmac_f32 v195, v227, v10
    v_fmac_f32 v196, v228, v10
    v_fmac_f32 v197, v229, v10
    v_fmac_f32 v198, v230, v10
    v_fmac_f32 v199, v231, v10
    v_fmac_f32 v200, v232, v10
    v_fmac_f32 v201, v233, v10
    v_fmac_f32 v202, v234, v10
    v_fmac_f32 v203, v235, v10
    v_fmac_f32 v204, v236, v10
    v_fmac_f32 v205, v237, v10
    v_fmac_f32 v206, v238, v10
    v_fmac_f32 v207, v239, v10
    v_cvt_pk_bf16_f32 v96, v176, v177
    v_cvt_pk_bf16_f32 v97, v178, v179
    v_cvt_pk_bf16_f32 v98, v180, v181
    v_cvt_pk_bf16_f32 v99, v182, v183
    v_cvt_pk_bf16_f32 v100, v184, v185
    v_cvt_pk_bf16_f32 v101, v186, v187
    v_cvt_pk_bf16_f32 v102, v188, v189
    v_cvt_pk_bf16_f32 v103, v190, v191
    v_cvt_pk_bf16_f32 v104, v192, v193
    v_cvt_pk_bf16_f32 v105, v194, v195
    v_cvt_pk_bf16_f32 v106, v196, v197
    v_cvt_pk_bf16_f32 v107, v198, v199
    v_cvt_pk_bf16_f32 v108, v200, v201
    v_cvt_pk_bf16_f32 v109, v202, v203
    v_cvt_pk_bf16_f32 v110, v204, v205
    v_cvt_pk_bf16_f32 v111, v206, v207
    buffer_store_dwordx4 v[96:99], v1, s[20:23], s52 offen offset:0 sc0 sc1
    buffer_store_dwordx4 v[100:103], v1, s[20:23], s52 offen offset:1024 sc0 sc1
    buffer_store_dwordx4 v[104:107], v1, s[20:23], s52 offen offset:2048 sc0 sc1
    buffer_store_dwordx4 v[108:111], v1, s[20:23], s52 offen offset:3072 sc0 sc1
    s_branch at_mgd1
at_mg1_1:
    ds_write_b128 v14, v[176:179] offset:32768
    ds_write_b128 v14, v[180:183] offset:33792
    ds_write_b128 v14, v[184:187] offset:34816
    ds_write_b128 v14, v[188:191] offset:35840
    ds_write_b128 v14, v[192:195] offset:36864
    ds_write_b128 v14, v[196:199] offset:37888
    ds_write_b128 v14, v[200:203] offset:38912
    ds_write_b128 v14, v[204:207] offset:39936
    s_waitcnt lgkmcnt(0)
    s_barrier
    v_xor_b32 v9, 0x800, v15
    ds_read_b64 v[10:11], v9
    ds_read_b128 v[176:179], v13 offset:0
    ds_read_b128 v[180:183], v13 offset:1024
    ds_read_b128 v[184:187], v13 offset:2048
    ds_read_b128 v[188:191], v13 offset:3072
    ds_read_b128 v[192:195], v13 offset:4096
    ds_read_b128 v[196:199], v13 offset:5120
    ds_read_b128 v[200:203], v13 offset:6144
    ds_read_b128 v[204:207], v13 offset:7168
    s_waitcnt lgkmcnt(8)
    v_min_f32 v9, v8, v10
    v_sub_f32 v8, v9, v8
    v_sub_f32 v10, v9, v10
    v_exp_f32 v8, v8
    v_exp_f32 v10, v10
    s_nop 0
    v_mul_f32 v6, v6, v8
    v_fmac_f32 v6, v11, v10
    v_rcp_f32 v6, v6
    s_nop 0
    v_mul_f32 v8, v8, v6
    v_mul_f32 v10, v10, v6
    v_mul_f32 v208, v208, v8
    v_mul_f32 v209, v209, v8
    v_mul_f32 v210, v210, v8
    v_mul_f32 v211, v211, v8
    v_mul_f32 v212, v212, v8
    v_mul_f32 v213, v213, v8
    v_mul_f32 v214, v214, v8
    v_mul_f32 v215, v215, v8
    v_mul_f32 v216, v216, v8
    v_mul_f32 v217, v217, v8
    v_mul_f32 v218, v218, v8
    v_mul_f32 v219, v219, v8
    v_mul_f32 v220, v220, v8
    v_mul_f32 v221, v221, v8
    v_mul_f32 v222, v222, v8
    v_mul_f32 v223, v223, v8
    v_mul_f32 v224, v224, v8
    v_mul_f32 v225, v225, v8
    v_mul_f32 v226, v226, v8
    v_mul_f32 v227, v227, v8
    v_mul_f32 v228, v228, v8
    v_mul_f32 v229, v229, v8
    v_mul_f32 v230, v230, v8
    v_mul_f32 v231, v231, v8
    v_mul_f32 v232, v232, v8
    v_mul_f32 v233, v233, v8
    v_mul_f32 v234, v234, v8
    v_mul_f32 v235, v235, v8
    v_mul_f32 v236, v236, v8
    v_mul_f32 v237, v237, v8
    v_mul_f32 v238, v238, v8
    v_mul_f32 v239, v239, v8
    s_waitcnt lgkmcnt(0)
    v_fmac_f32 v208, v176, v10
    v_fmac_f32 v209, v177, v10
    v_fmac_f32 v210, v178, v10
    v_fmac_f32 v211, v179, v10
    v_fmac_f32 v212, v180, v10
    v_fmac_f32 v213, v181, v10
    v_fmac_f32 v214, v182, v10
    v_fmac_f32 v215, v183, v10
    v_fmac_f32 v216, v184, v10
    v_fmac_f32 v217, v185, v10
    v_fmac_f32 v218, v186, v10
    v_fmac_f32 v219, v187, v10
    v_fmac_f32 v220, v188, v10
    v_fmac_f32 v221, v189, v10
    v_fmac_f32 v222, v190, v10
    v_fmac_f32 v223, v191, v10
    v_fmac_f32 v224, v192, v10
    v_fmac_f32 v225, v193, v10
    v_fmac_f32 v226, v194, v10
    v_fmac_f32 v227, v195, v10
    v_fmac_f32 v228, v196, v10
    v_fmac_f32 v229, v197, v10
    v_fmac_f32 v230, v198, v10
    v_fmac_f32 v231, v199, v10
    v_fmac_f32 v232, v200, v10
    v_fmac_f32 v233, v201, v10
    v_fmac_f32 v234, v202, v10
    v_fmac_f32 v235, v203, v10
    v_fmac_f32 v236, v204, v10
    v_fmac_f32 v237, v205, v10
    v_fmac_f32 v238, v206, v10
    v_fmac_f32 v239, v207, v10
    v_cvt_pk_bf16_f32 v96, v208, v209
    v_cvt_pk_bf16_f32 v97, v210, v211
    v_cvt_pk_bf16_f32 v98, v212, v213
    v_cvt_pk_bf16_f32 v99, v214, v215
    v_cvt_pk_bf16_f32 v100, v216, v217
    v_cvt_pk_bf16_f32 v101, v218, v219
    v_cvt_pk_bf16_f32 v102, v220, v221
    v_cvt_pk_bf16_f32 v103, v222, v223
    v_cvt_pk_bf16_f32 v104, v224, v225
    v_cvt_pk_bf16_f32 v105, v226, v227
    v_cvt_pk_bf16_f32 v106, v228, v229
    v_cvt_pk_bf16_f32 v107, v230, v231
    v_cvt_pk_bf16_f32 v108, v232, v233
    v_cvt_pk_bf16_f32 v109, v234, v235
    v_cvt_pk_bf16_f32 v110, v236, v237
    v_cvt_pk_bf16_f32 v111, v238, v239
    buffer_store_dwordx4 v[96:99], v1, s[20:23], s52 offen offset:0 sc0 sc1
    buffer_store_dwordx4 v[100:103], v1, s[20:23], s52 offen offset:1024 sc0 sc1
    buffer_store_dwordx4 v[104:107], v1, s[20:23], s52 offen offset:2048 sc0 sc1
    buffer_store_dwordx4 v[108:111], v1, s[20:23], s52 offen offset:3072 sc0 sc1
    s_branch at_mgd1
at_mgd1:
    s_cmp_eq_u32 s54, 16
    s_cbranch_scc1 at_done
    s_barrier
    s_mov_b32 s55, 16
    s_mov_b32 s52, s53
    s_add_u32 s54, s54, 1
    v_mov_b32 v6, 0
    v_mov_b32 v7, 0
    v_mov_b32 v176, 0
    v_mov_b32 v177, 0
    v_mov_b32 v178, 0
    v_mov_b32 v179, 0
    v_mov_b32 v180, 0
    v_mov_b32 v181, 0
    v_mov_b32 v182, 0
    v_mov_b32 v183, 0
    v_mov_b32 v184, 0
    v_mov_b32 v185, 0
    v_mov_b32 v186, 0
    v_mov_b32 v187, 0
    v_mov_b32 v188, 0
    v_mov_b32 v189, 0
    v_mov_b32 v190, 0
    v_mov_b32 v191, 0
    v_mov_b32 v192, 0
    v_mov_b32 v193, 0
    v_mov_b32 v194, 0
    v_mov_b32 v195, 0
    v_mov_b32 v196, 0
    v_mov_b32 v197, 0
    v_mov_b32 v198, 0
    v_mov_b32 v199, 0
    v_mov_b32 v200, 0
    v_mov_b32 v201, 0
    v_mov_b32 v202, 0
    v_mov_b32 v203, 0
    v_mov_b32 v204, 0
    v_mov_b32 v205, 0
    v_mov_b32 v206, 0
    v_mov_b32 v207, 0
    v_mov_b32 v208, 0
    v_mov_b32 v209, 0
    v_mov_b32 v210, 0
    v_mov_b32 v211, 0
    v_mov_b32 v212, 0
    v_mov_b32 v213, 0
    v_mov_b32 v214, 0
    v_mov_b32 v215, 0
    v_mov_b32 v216, 0
    v_mov_b32 v217, 0
    v_mov_b32 v218, 0
    v_mov_b32 v219, 0
    v_mov_b32 v220, 0
    v_mov_b32 v221, 0
    v_mov_b32 v222, 0
    v_mov_b32 v223, 0
    v_mov_b32 v224, 0
    v_mov_b32 v225, 0
    v_mov_b32 v226, 0
    v_mov_b32 v227, 0
    v_mov_b32 v228, 0
    v_mov_b32 v229, 0
    v_mov_b32 v230, 0
    v_mov_b32 v231, 0
    v_mov_b32 v232, 0
    v_mov_b32 v233, 0
    v_mov_b32 v234, 0
    v_mov_b32 v235, 0
    v_mov_b32 v236, 0
    v_mov_b32 v237, 0
    v_mov_b32 v238, 0
    v_mov_b32 v239, 0
    s_branch at_fs1
at_last:
    s_waitcnt lgkmcnt(0)
    v_mov_b32 v8, v80
    ds_read_b128 v[16:19], v3 offset:0
    ds_read_b128 v[20:23], v3 offset:4096
    ds_read_b128 v[24:27], v3 offset:8192
    ds_read_b128 v[28:31], v3 offset:12288
    ds_read_b128 v[32:35], v3 offset:1024
    ds_read_b128 v[36:39], v3 offset:5120
    ds_read_b128 v[40:43], v3 offset:9216
    ds_read_b128 v[44:47], v3 offset:13312
    s_lshl_b32 s36, s2, 3
    s_add_u32 s36, s36, s40
    s_lshl_b32 s36, s36, 10
    s_lshl_b32 s37, s36, 1
    s_mov_b32 s12, s90
    s_mov_b32 s13, s91
    s_mov_b32 s14, 4194304
    s_mov_b32 s15, 0x00020000
    buffer_load_dwordx4 v[48:51], v1, s[12:15], s37 offen
    buffer_load_dwordx4 v[48:51], v1, s[12:15], s37 offen offset:1024
    s_mov_b32 s16, s92
    s_mov_b32 s17, s93
    s_mov_b32 s18, 1835008
    s_mov_b32 s19, 0x00020000
    buffer_load_dwordx4 v[48:51], v1, s[16:19], s36 offen
    s_mov_b32 s16, s94
    s_mov_b32 s17, s95
    s_mov_b32 s18, 1835008
    s_mov_b32 s19, 0x00020000
    buffer_load_dwordx4 v[48:51], v1, s[16:19], s36 offen
    s_mov_b32 s16, s10
    s_mov_b32 s17, s11
    s_mov_b32 s18, 1835008
    s_mov_b32 s19, 0x00020000
    buffer_load_dwordx4 v[48:51], v1, s[16:19], s36 offen
    v_exp_f32 v112, v112
    v_exp_f32 v113, v113
    v_exp_f32 v114, v114
    v_exp_f32 v115, v115
    v_exp_f32 v116, v116
    v_exp_f32 v117, v117
    v_exp_f32 v118, v118
    v_exp_f32 v119, v119
    v_exp_f32 v120, v120
    v_exp_f32 v121, v121
    v_cvt_pk_bf16_f32 v96, v112, v113
    v_add_f32 v6, v6, v112
    v_add_f32 v7, v7, v113
    v_cvt_pk_bf16_f32 v97, v114, v115
    v_add_f32 v6, v6, v114
    v_add_f32 v7, v7, v115
    v_cvt_pk_bf16_f32 v98, v116, v117
    v_add_f32 v6, v6, v116
    v_add_f32 v7, v7, v117
    v_cvt_pk_bf16_f32 v99, v118, v119
    v_add_f32 v6, v6, v118
    v_add_f32 v7, v7, v119
    s_waitcnt lgkmcnt(7)
    v_mfma_f32_32x32x16_bf16 v[176:191], v[16:19], v[96:99], v[176:191]
    v_exp_f32 v122, v122
    v_exp_f32 v123, v123
    v_cvt_pk_bf16_f32 v100, v120, v121
    v_add_f32 v6, v6, v120
    v_add_f32 v7, v7, v121
    s_waitcnt lgkmcnt(6)
    v_mfma_f32_32x32x16_bf16 v[192:207], v[20:23], v[96:99], v[192:207]
    v_exp_f32 v124, v124
    v_exp_f32 v125, v125
    v_cvt_pk_bf16_f32 v101, v122, v123
    v_add_f32 v6, v6, v122
    v_add_f32 v7, v7, v123
    s_waitcnt lgkmcnt(5)
    v_mfma_f32_32x32x16_bf16 v[208:223], v[24:27], v[96:99], v[208:223]
    ds_read_b128 v[16:19], v3 offset:2048
    v_exp_f32 v126, v126
    v_exp_f32 v127, v127
    v_cvt_pk_bf16_f32 v102, v124, v125
    v_add_f32 v6, v6, v124
    v_add_f32 v7, v7, v125
    s_waitcnt lgkmcnt(5)
    v_mfma_f32_32x32x16_bf16 v[224:239], v[28:31], v[96:99], v[224:239]
    ds_read_b128 v[20:23], v3 offset:6144
    v_exp_f32 v128, v128
    v_exp_f32 v129, v129
    v_cvt_pk_bf16_f32 v103, v126, v127
    v_add_f32 v6, v6, v126
    v_add_f32 v7, v7, v127
    s_waitcnt lgkmcnt(5)
    v_mfma_f32_32x32x16_bf16 v[176:191], v[32:35], v[100:103], v[176:191]
    ds_read_b128 v[24:27], v3 offset:10240
    v_exp_f32 v130, v130
    v_exp_f32 v131, v131
    v_cvt_pk_bf16_f32 v104, v128, v129
    v_add_f32 v6, v6, v128
    v_add_f32 v7, v7, v129
    s_waitcnt lgkmcnt(5)
    v_mfma_f32_32x32x16_bf16 v[192:207], v[36:39], v[100:103], v[192:207]
    ds_read_b128 v[28:31], v3 offset:14336
    v_exp_f32 v132, v132
    v_exp_f32 v133, v133
    v_cvt_pk_bf16_f32 v105, v130, v131
    v_add_f32 v6, v6, v130
    v_add_f32 v7, v7, v131
    s_waitcnt lgkmcnt(5)
    v_mfma_f32_32x32x16_bf16 v[208:223], v[40:43], v[100:103], v[208:223]
    ds_read_b128 v[32:35], v3 offset:3072
    v_exp_f32 v134, v134
    v_exp_f32 v135, v135
    v_cvt_pk_bf16_f32 v106, v132, v133
    v_add_f32 v6, v6, v132
    v_add_f32 v7, v7, v133
    s_waitcnt lgkmcnt(5)
    v_mfma_f32_32x32x16_bf16 v[224:239], v[44:47], v[100:103], v[224:239]
    ds_read_b128 v[36:39], v3 offset:7168
    v_exp_f32 v136, v136
    v_exp_f32 v137, v137
    v_cvt_pk_bf16_f32 v107, v134, v135
    v_add_f32 v6, v6, v134
    v_add_f32 v7, v7, v135
    s_waitcnt lgkmcnt(5)
    v_mfma_f32_32x32x16_bf16 v[176:191], v[16:19], v[104:107], v[176:191]
    ds_read_b128 v[40:43], v3 offset:11264
    v_exp_f32 v138, v138
    v_exp_f32 v139, v139
    v_cvt_pk_bf16_f32 v108, v136, v137
    v_add_f32 v6, v6, v136
    v_add_f32 v7, v7, v137
    s_waitcnt lgkmcnt(5)
    v_mfma_f32_32x32x16_bf16 v[192:207], v[20:23], v[104:107], v[192:207]
    ds_read_b128 v[44:47], v3 offset:15360
    v_exp_f32 v140, v140
    v_exp_f32 v141, v141
    v_cvt_pk_bf16_f32 v109, v138, v139
    v_add_f32 v6, v6, v138
    v_add_f32 v7, v7, v139
    s_waitcnt lgkmcnt(5)
    v_mfma_f32_32x32x16_bf16 v[208:223], v[24:27], v[104:107], v[208:223]
    v_exp_f32 v142, v142
    v_exp_f32 v143, v143
    v_cvt_pk_bf16_f32 v110, v140, v141
    v_add_f32 v6, v6, v140
    v_add_f32 v7, v7, v141
    s_waitcnt lgkmcnt(4)
    v_mfma_f32_32x32x16_bf16 v[224:239], v[28:31], v[104:107], v[224:239]
    v_cvt_pk_bf16_f32 v111, v142, v143
    v_add_f32 v6, v6, v142
    v_add_f32 v7, v7, v143
    s_waitcnt lgkmcnt(3)
    v_mfma_f32_32x32x16_bf16 v[176:191], v[32:35], v[108:111], v[176:191]
    s_waitcnt lgkmcnt(2)
    v_mfma_f32_32x32x16_bf16 v[192:207], v[36:39], v[108:111], v[192:207]
    s_waitcnt lgkmcnt(1)
    v_mfma_f32_32x32x16_bf16 v[208:223], v[40:43], v[108:111], v[208:223]
    s_waitcnt lgkmcnt(0)
    v_mfma_f32_32x32x16_bf16 v[224:239], v[44:47], v[108:111], v[224:239]
    s_barrier
    s_branch at_fin0
at_done:
    s_waitcnt vmcnt(0)
at_end:
    s_endpgm
.text
.globl op_kernel
.p2align 8
.type op_kernel,@function
op_kernel:
    s_load_dwordx2 s[8:9], s[0:1], 40
    s_load_dwordx2 s[6:7], s[0:1], 112
    s_cmp_ge_u32 s2, 256
    s_cbranch_scc1 op_end
    s_bfe_u32 s33, s2, 0x20001
    s_and_b32 s34, s2, 1
    s_lshl_b32 s34, s34, 3
    s_lshr_b32 s35, s2, 5
    s_add_u32 s34, s34, s35
    s_bfe_u32 s35, s2, 0x20003
    v_and_b32 v1, 63, v0
    v_lshrrev_b32 v2, 6, v0
    s_nop 0
    v_readfirstlane_b32 s40, v2
    v_lshrrev_b32 v8, 3, v1
    v_and_b32 v9, 7, v1
    v_bfe_u32 v10, v1, 4, 1
    v_lshrrev_b32 v11, 2, v9
    v_xor_b32 v10, v10, v11
    v_and_b32 v9, 3, v9
    v_mul_u32_u24 v8, 1024, v8
    v_lshl_add_u32 v8, v10, 6, v8
    v_lshl_add_u32 v8, v9, 4, v8
    s_lshr_b32 s41, s40, 1
    s_and_b32 s42, s40, 1
    v_lshrrev_b32 v4, 5, v1
    v_lshlrev_b32 v4, 9, v4
    v_bfe_u32 v5, v1, 2, 2
    v_lshl_add_u32 v4, v5, 7, v4
    v_bfe_u32 v5, v1, 4, 1
    v_lshl_add_u32 v4, v5, 5, v4
    v_and_b32 v5, 3, v1
    v_lshl_add_u32 v4, v5, 3, v4
    v_bfe_u32 v5, v1, 3, 1
    v_lshl_add_u32 v4, v5, 6, v4
    v_lshlrev_b32 v1, 4, v1
    s_mul_i32 s43, s41, 4096
    s_add_u32 s43, s43, 0
    v_add_u32 v2, s43, v1
    v_add_u32 v3, 0x10000, v2
    v_add_u32 v4, 0, v4
    s_mul_i32 s43, s42, 8192
    v_add_u32 v4, s43, v4
    v_xor_b32 v6, 64, v4
    v_add_u32 v5, 0x10000, v4
    v_add_u32 v7, 0x10000, v6
    v_add_u32 v9, 7168, v8
    s_mul_i32 s44, s40, 2048
    s_mul_i32 s45, s40, 2048
    s_add_u32 s45, s45, 16384
    s_add_u32 s44, s44, 0
    s_waitcnt lgkmcnt(0)
    s_add_u32 s12, s6, 50331648
    s_addc_u32 s13, s7, 0
    s_mov_b32 s14, 16777216
    s_mov_b32 s15, 0x00020000
    s_mov_b32 s16, s8
    s_mov_b32 s17, s9
    s_mov_b32 s18, 4194304
    s_mov_b32 s19, 0x00020000
    s_add_u32 s20, s6, 67108864
    s_addc_u32 s21, s7, 0
    s_mov_b32 s22, 8388608
    s_mov_b32 s23, 0x00020000
    s_lshl_b32 s46, s34, 2
    s_add_u32 s46, s46, s41
    s_lshl_b32 s46, s46, 18
    s_lshl_b32 s36, s33, 16
    s_add_u32 s46, s46, s36
    s_lshl_b32 s36, s42, 11
    s_add_u32 s46, s46, s36
    s_lshr_b32 s47, s40, 2
    s_lshl_b32 s47, s47, 7
    s_and_b32 s36, s40, 3
    s_lshl_b32 s36, s36, 14
    s_add_u32 s47, s47, s36
    s_lshl_b32 s36, s35, 8
    s_add_u32 s47, s47, s36
    s_lshl_b32 s36, s33, 20
    s_add_u32 s47, s47, s36
    s_lshr_b32 s64, s2, 3
    s_lshr_b32 s65, s2, 5
    s_add_u32 s64, s64, s65
    s_and_b32 s64, s64, 1
    s_mul_i32 s64, s64, 8
    s_mov_b32 s62, s46
    s_mov_b32 s63, s47
    s_add_u32 s60, s46, 65536
    s_add_u32 s61, s47, 1048576
    s_mul_i32 s65, s64, 4096
    s_add_u32 s46, s46, s65
    s_mul_i32 s65, s64, 65536
    s_add_u32 s47, s47, s65
    s_add_u32 m0, s44, 0
    s_nop 0
    buffer_load_dwordx4 v1, s[12:15], s46 offen offset:0 lds
    buffer_load_dwordx4 v1, s[12:15], s46 offen offset:1024 lds
    s_add_u32 s46, s46, 4096
    s_cmp_eq_u32 s46, s60
    s_cselect_b32 s46, s62, s46
    s_add_u32 m0, s45, 0
    s_nop 0
    buffer_load_dwordx4 v8, s[16:19], s47 offen offset:0 lds
    buffer_load_dwordx4 v9, s[16:19], s47 offen offset:1024 lds
    s_add_u32 s47, s47, 65536
    s_cmp_eq_u32 s47, s61
    s_cselect_b32 s47, s63, s47
    s_add_u32 m0, s44, 32768
    s_nop 0
    buffer_load_dwordx4 v1, s[12:15], s46 offen offset:0 lds
    buffer_load_dwordx4 v1, s[12:15], s46 offen offset:1024 lds
    s_add_u32 s46, s46, 4096
    s_cmp_eq_u32 s46, s60
    s_cselect_b32 s46, s62, s46
    s_add_u32 m0, s45, 32768
    s_nop 0
    buffer_load_dwordx4 v8, s[16:19], s47 offen offset:0 lds
    buffer_load_dwordx4 v9, s[16:19], s47 offen offset:1024 lds
    s_add_u32 s47, s47, 65536
    s_cmp_eq_u32 s47, s61
    s_cselect_b32 s47, s63, s47
    s_add_u32 m0, s44, 65536
    s_nop 0
    buffer_load_dwordx4 v1, s[12:15], s46 offen offset:0 lds
    buffer_load_dwordx4 v1, s[12:15], s46 offen offset:1024 lds
    s_add_u32 s46, s46, 4096
    s_cmp_eq_u32 s46, s60
    s_cselect_b32 s46, s62, s46
    s_add_u32 m0, s45, 65536
    s_nop 0
    buffer_load_dwordx4 v8, s[16:19], s47 offen offset:0 lds
    buffer_load_dwordx4 v9, s[16:19], s47 offen offset:1024 lds
    s_add_u32 s47, s47, 65536
    s_cmp_eq_u32 s47, s61
    s_cselect_b32 s47, s63, s47
    s_add_u32 m0, s44, 98304
    s_nop 0
    buffer_load_dwordx4 v1, s[12:15], s46 offen offset:0 lds
    buffer_load_dwordx4 v1, s[12:15], s46 offen offset:1024 lds
    s_add_u32 s46, s46, 4096
    s_cmp_eq_u32 s46, s60
    s_cselect_b32 s46, s62, s46
    s_add_u32 m0, s45, 98304
    s_nop 0
    buffer_load_dwordx4 v8, s[16:19], s47 offen offset:0 lds
    buffer_load_dwordx4 v9, s[16:19], s47 offen offset:1024 lds
    s_add_u32 s47, s47, 65536
    s_cmp_eq_u32 s47, s61
    s_cselect_b32 s47, s63, s47
    s_lshl_b32 s36, s33, 21
    s_lshl_b32 s37, s34, 17
    s_add_u32 s36, s36, s37
    s_lshl_b32 s37, s41, 15
    s_add_u32 s36, s36, s37
    s_lshl_b32 s37, s35, 13
    s_add_u32 s36, s36, s37
    s_lshl_b32 s37, s42, 12
    s_add_u32 s36, s36, s37
    s_waitcnt vmcnt(12)
    s_barrier
    ds_read_b64_tr_b16 v[16:17], v4 offset:16384
    ds_read_b64_tr_b16 v[18:19], v4 offset:17408
    ds_read_b128 v[12:15], v2 offset:0
    ds_read_b64_tr_b16 v[20:21], v6 offset:16384
    ds_read_b64_tr_b16 v[22:23], v6 offset:17408
    ds_read_b64_tr_b16 v[28:29], v4 offset:18432
    ds_read_b64_tr_b16 v[30:31], v4 offset:19456
    ds_read_b128 v[24:27], v2 offset:1024
    ds_read_b64_tr_b16 v[32:33], v6 offset:18432
    ds_read_b64_tr_b16 v[34:35], v6 offset:19456
    ds_read_b64_tr_b16 v[40:41], v4 offset:20480
    ds_read_b64_tr_b16 v[42:43], v4 offset:21504
    ds_read_b128 v[36:39], v2 offset:2048
    ds_read_b64_tr_b16 v[44:45], v6 offset:20480
    ds_read_b64_tr_b16 v[46:47], v6 offset:21504
    ds_read_b64_tr_b16 v[52:53], v4 offset:22528
    ds_read_b64_tr_b16 v[54:55], v4 offset:23552
    ds_read_b128 v[48:51], v2 offset:3072
    ds_read_b64_tr_b16 v[56:57], v6 offset:22528
    ds_read_b64_tr_b16 v[58:59], v6 offset:23552
    s_waitcnt lgkmcnt(10)
    v_mfma_f32_32x32x16_bf16 v[60:75], v[16:19], v[12:15], 0
    v_mfma_f32_32x32x16_bf16 v[76:91], v[20:23], v[12:15], 0
    v_mfma_f32_32x32x16_bf16 v[60:75], v[28:31], v[24:27], v[60:75]
    v_mfma_f32_32x32x16_bf16 v[76:91], v[32:35], v[24:27], v[76:91]
    s_waitcnt vmcnt(8) lgkmcnt(0)
    s_barrier
    ds_read_b64_tr_b16 v[16:17], v4 offset:49152
    ds_read_b64_tr_b16 v[18:19], v4 offset:50176
    ds_read_b128 v[12:15], v2 offset:32768
    ds_read_b64_tr_b16 v[20:21], v6 offset:49152
    ds_read_b64_tr_b16 v[22:23], v6 offset:50176
    ds_read_b64_tr_b16 v[28:29], v4 offset:51200
    ds_read_b64_tr_b16 v[30:31], v4 offset:52224
    ds_read_b128 v[24:27], v2 offset:33792
    ds_read_b64_tr_b16 v[32:33], v6 offset:51200
    ds_read_b64_tr_b16 v[34:35], v6 offset:52224
    v_mfma_f32_32x32x16_bf16 v[60:75], v[40:43], v[36:39], v[60:75]
    s_add_u32 m0, s44, 0
    s_nop 0
    buffer_load_dwordx4 v1, s[12:15], s46 offen offset:0 lds
    v_mfma_f32_32x32x16_bf16 v[76:91], v[44:47], v[36:39], v[76:91]
    buffer_load_dwordx4 v1, s[12:15], s46 offen offset:1024 lds
    s_add_u32 s46, s46, 4096
    s_cmp_eq_u32 s46, s60
    s_cselect_b32 s46, s62, s46
    v_mfma_f32_32x32x16_bf16 v[60:75], v[52:55], v[48:51], v[60:75]
    s_add_u32 m0, s45, 0
    s_nop 0
    buffer_load_dwordx4 v8, s[16:19], s47 offen offset:0 lds
    v_mfma_f32_32x32x16_bf16 v[76:91], v[56:59], v[48:51], v[76:91]
    buffer_load_dwordx4 v9, s[16:19], s47 offen offset:1024 lds
    s_add_u32 s47, s47, 65536
    s_cmp_eq_u32 s47, s61
    s_cselect_b32 s47, s63, s47
    ds_read_b64_tr_b16 v[40:41], v4 offset:53248
    ds_read_b64_tr_b16 v[42:43], v4 offset:54272
    ds_read_b128 v[36:39], v2 offset:34816
    ds_read_b64_tr_b16 v[44:45], v6 offset:53248
    ds_read_b64_tr_b16 v[46:47], v6 offset:54272
    ds_read_b64_tr_b16 v[52:53], v4 offset:55296
    ds_read_b64_tr_b16 v[54:55], v4 offset:56320
    ds_read_b128 v[48:51], v2 offset:35840
    ds_read_b64_tr_b16 v[56:57], v6 offset:55296
    ds_read_b64_tr_b16 v[58:59], v6 offset:56320
    s_waitcnt lgkmcnt(10)
    v_mfma_f32_32x32x16_bf16 v[60:75], v[16:19], v[12:15], v[60:75]
    v_mfma_f32_32x32x16_bf16 v[76:91], v[20:23], v[12:15], v[76:91]
    v_mfma_f32_32x32x16_bf16 v[60:75], v[28:31], v[24:27], v[60:75]
    v_mfma_f32_32x32x16_bf16 v[76:91], v[32:35], v[24:27], v[76:91]
    s_waitcnt vmcnt(8) lgkmcnt(0)
    s_barrier
    ds_read_b64_tr_b16 v[16:17], v5 offset:16384
    ds_read_b64_tr_b16 v[18:19], v5 offset:17408
    ds_read_b128 v[12:15], v3 offset:0
    ds_read_b64_tr_b16 v[20:21], v7 offset:16384
    ds_read_b64_tr_b16 v[22:23], v7 offset:17408
    ds_read_b64_tr_b16 v[28:29], v5 offset:18432
    ds_read_b64_tr_b16 v[30:31], v5 offset:19456
    ds_read_b128 v[24:27], v3 offset:1024
    ds_read_b64_tr_b16 v[32:33], v7 offset:18432
    ds_read_b64_tr_b16 v[34:35], v7 offset:19456
    v_mfma_f32_32x32x16_bf16 v[60:75], v[40:43], v[36:39], v[60:75]
    s_add_u32 m0, s44, 32768
    s_nop 0
    buffer_load_dwordx4 v1, s[12:15], s46 offen offset:0 lds
    v_mfma_f32_32x32x16_bf16 v[76:91], v[44:47], v[36:39], v[76:91]
    buffer_load_dwordx4 v1, s[12:15], s46 offen offset:1024 lds
    s_add_u32 s46, s46, 4096
    s_cmp_eq_u32 s46, s60
    s_cselect_b32 s46, s62, s46
    v_mfma_f32_32x32x16_bf16 v[60:75], v[52:55], v[48:51], v[60:75]
    s_add_u32 m0, s45, 32768
    s_nop 0
    buffer_load_dwordx4 v8, s[16:19], s47 offen offset:0 lds
    v_mfma_f32_32x32x16_bf16 v[76:91], v[56:59], v[48:51], v[76:91]
    buffer_load_dwordx4 v9, s[16:19], s47 offen offset:1024 lds
    s_add_u32 s47, s47, 65536
    s_cmp_eq_u32 s47, s61
    s_cselect_b32 s47, s63, s47
    ds_read_b64_tr_b16 v[40:41], v5 offset:20480
    ds_read_b64_tr_b16 v[42:43], v5 offset:21504
    ds_read_b128 v[36:39], v3 offset:2048
    ds_read_b64_tr_b16 v[44:45], v7 offset:20480
    ds_read_b64_tr_b16 v[46:47], v7 offset:21504
    ds_read_b64_tr_b16 v[52:53], v5 offset:22528
    ds_read_b64_tr_b16 v[54:55], v5 offset:23552
    ds_read_b128 v[48:51], v3 offset:3072
    ds_read_b64_tr_b16 v[56:57], v7 offset:22528
    ds_read_b64_tr_b16 v[58:59], v7 offset:23552
    s_waitcnt lgkmcnt(10)
    v_mfma_f32_32x32x16_bf16 v[60:75], v[16:19], v[12:15], v[60:75]
    v_mfma_f32_32x32x16_bf16 v[76:91], v[20:23], v[12:15], v[76:91]
    v_mfma_f32_32x32x16_bf16 v[60:75], v[28:31], v[24:27], v[60:75]
    v_mfma_f32_32x32x16_bf16 v[76:91], v[32:35], v[24:27], v[76:91]
    s_waitcnt vmcnt(8) lgkmcnt(0)
    s_barrier
    ds_read_b64_tr_b16 v[16:17], v5 offset:49152
    ds_read_b64_tr_b16 v[18:19], v5 offset:50176
    ds_read_b128 v[12:15], v3 offset:32768
    ds_read_b64_tr_b16 v[20:21], v7 offset:49152
    ds_read_b64_tr_b16 v[22:23], v7 offset:50176
    ds_read_b64_tr_b16 v[28:29], v5 offset:51200
    ds_read_b64_tr_b16 v[30:31], v5 offset:52224
    ds_read_b128 v[24:27], v3 offset:33792
    ds_read_b64_tr_b16 v[32:33], v7 offset:51200
    ds_read_b64_tr_b16 v[34:35], v7 offset:52224
    v_mfma_f32_32x32x16_bf16 v[60:75], v[40:43], v[36:39], v[60:75]
    s_add_u32 m0, s44, 65536
    s_nop 0
    buffer_load_dwordx4 v1, s[12:15], s46 offen offset:0 lds
    v_mfma_f32_32x32x16_bf16 v[76:91], v[44:47], v[36:39], v[76:91]
    buffer_load_dwordx4 v1, s[12:15], s46 offen offset:1024 lds
    s_add_u32 s46, s46, 4096
    s_cmp_eq_u32 s46, s60
    s_cselect_b32 s46, s62, s46
    v_mfma_f32_32x32x16_bf16 v[60:75], v[52:55], v[48:51], v[60:75]
    s_add_u32 m0, s45, 65536
    s_nop 0
    buffer_load_dwordx4 v8, s[16:19], s47 offen offset:0 lds
    v_mfma_f32_32x32x16_bf16 v[76:91], v[56:59], v[48:51], v[76:91]
    buffer_load_dwordx4 v9, s[16:19], s47 offen offset:1024 lds
    s_add_u32 s47, s47, 65536
    s_cmp_eq_u32 s47, s61
    s_cselect_b32 s47, s63, s47
    ds_read_b64_tr_b16 v[40:41], v5 offset:53248
    ds_read_b64_tr_b16 v[42:43], v5 offset:54272
    ds_read_b128 v[36:39], v3 offset:34816
    ds_read_b64_tr_b16 v[44:45], v7 offset:53248
    ds_read_b64_tr_b16 v[46:47], v7 offset:54272
    ds_read_b64_tr_b16 v[52:53], v5 offset:55296
    ds_read_b64_tr_b16 v[54:55], v5 offset:56320
    ds_read_b128 v[48:51], v3 offset:35840
    ds_read_b64_tr_b16 v[56:57], v7 offset:55296
    ds_read_b64_tr_b16 v[58:59], v7 offset:56320
    s_waitcnt lgkmcnt(10)
    v_mfma_f32_32x32x16_bf16 v[60:75], v[16:19], v[12:15], v[60:75]
    v_mfma_f32_32x32x16_bf16 v[76:91], v[20:23], v[12:15], v[76:91]
    v_mfma_f32_32x32x16_bf16 v[60:75], v[28:31], v[24:27], v[60:75]
    v_mfma_f32_32x32x16_bf16 v[76:91], v[32:35], v[24:27], v[76:91]
    s_waitcnt vmcnt(8) lgkmcnt(0)
    s_barrier
    ds_read_b64_tr_b16 v[16:17], v4 offset:16384
    ds_read_b64_tr_b16 v[18:19], v4 offset:17408
    ds_read_b128 v[12:15], v2 offset:0
    ds_read_b64_tr_b16 v[20:21], v6 offset:16384
    ds_read_b64_tr_b16 v[22:23], v6 offset:17408
    ds_read_b64_tr_b16 v[28:29], v4 offset:18432
    ds_read_b64_tr_b16 v[30:31], v4 offset:19456
    ds_read_b128 v[24:27], v2 offset:1024
    ds_read_b64_tr_b16 v[32:33], v6 offset:18432
    ds_read_b64_tr_b16 v[34:35], v6 offset:19456
    v_mfma_f32_32x32x16_bf16 v[60:75], v[40:43], v[36:39], v[60:75]
    s_add_u32 m0, s44, 98304
    s_nop 0
    buffer_load_dwordx4 v1, s[12:15], s46 offen offset:0 lds
    v_mfma_f32_32x32x16_bf16 v[76:91], v[44:47], v[36:39], v[76:91]
    buffer_load_dwordx4 v1, s[12:15], s46 offen offset:1024 lds
    s_add_u32 s46, s46, 4096
    s_cmp_eq_u32 s46, s60
    s_cselect_b32 s46, s62, s46
    v_mfma_f32_32x32x16_bf16 v[60:75], v[52:55], v[48:51], v[60:75]
    s_add_u32 m0, s45, 98304
    s_nop 0
    buffer_load_dwordx4 v8, s[16:19], s47 offen offset:0 lds
    v_mfma_f32_32x32x16_bf16 v[76:91], v[56:59], v[48:51], v[76:91]
    buffer_load_dwordx4 v9, s[16:19], s47 offen offset:1024 lds
    s_add_u32 s47, s47, 65536
    s_cmp_eq_u32 s47, s61
    s_cselect_b32 s47, s63, s47
    ds_read_b64_tr_b16 v[40:41], v4 offset:20480
    ds_read_b64_tr_b16 v[42:43], v4 offset:21504
    ds_read_b128 v[36:39], v2 offset:2048
    ds_read_b64_tr_b16 v[44:45], v6 offset:20480
    ds_read_b64_tr_b16 v[46:47], v6 offset:21504
    ds_read_b64_tr_b16 v[52:53], v4 offset:22528
    ds_read_b64_tr_b16 v[54:55], v4 offset:23552
    ds_read_b128 v[48:51], v2 offset:3072
    ds_read_b64_tr_b16 v[56:57], v6 offset:22528
    ds_read_b64_tr_b16 v[58:59], v6 offset:23552
    s_waitcnt lgkmcnt(10)
    v_mfma_f32_32x32x16_bf16 v[60:75], v[16:19], v[12:15], v[60:75]
    v_mfma_f32_32x32x16_bf16 v[76:91], v[20:23], v[12:15], v[76:91]
    v_mfma_f32_32x32x16_bf16 v[60:75], v[28:31], v[24:27], v[60:75]
    v_mfma_f32_32x32x16_bf16 v[76:91], v[32:35], v[24:27], v[76:91]
    s_waitcnt vmcnt(8) lgkmcnt(0)
    s_barrier
    ds_read_b64_tr_b16 v[16:17], v4 offset:49152
    ds_read_b64_tr_b16 v[18:19], v4 offset:50176
    ds_read_b128 v[12:15], v2 offset:32768
    ds_read_b64_tr_b16 v[20:21], v6 offset:49152
    ds_read_b64_tr_b16 v[22:23], v6 offset:50176
    ds_read_b64_tr_b16 v[28:29], v4 offset:51200
    ds_read_b64_tr_b16 v[30:31], v4 offset:52224
    ds_read_b128 v[24:27], v2 offset:33792
    ds_read_b64_tr_b16 v[32:33], v6 offset:51200
    ds_read_b64_tr_b16 v[34:35], v6 offset:52224
    v_mfma_f32_32x32x16_bf16 v[60:75], v[40:43], v[36:39], v[60:75]
    s_add_u32 m0, s44, 0
    s_nop 0
    buffer_load_dwordx4 v1, s[12:15], s46 offen offset:0 lds
    v_mfma_f32_32x32x16_bf16 v[76:91], v[44:47], v[36:39], v[76:91]
    buffer_load_dwordx4 v1, s[12:15], s46 offen offset:1024 lds
    s_add_u32 s46, s46, 4096
    s_cmp_eq_u32 s46, s60
    s_cselect_b32 s46, s62, s46
    v_mfma_f32_32x32x16_bf16 v[60:75], v[52:55], v[48:51], v[60:75]
    s_add_u32 m0, s45, 0
    s_nop 0
    buffer_load_dwordx4 v8, s[16:19], s47 offen offset:0 lds
    v_mfma_f32_32x32x16_bf16 v[76:91], v[56:59], v[48:51], v[76:91]
    buffer_load_dwordx4 v9, s[16:19], s47 offen offset:1024 lds
    s_add_u32 s47, s47, 65536
    s_cmp_eq_u32 s47, s61
    s_cselect_b32 s47, s63, s47
    ds_read_b64_tr_b16 v[40:41], v4 offset:53248
    ds_read_b64_tr_b16 v[42:43], v4 offset:54272
    ds_read_b128 v[36:39], v2 offset:34816
    ds_read_b64_tr_b16 v[44:45], v6 offset:53248
    ds_read_b64_tr_b16 v[46:47], v6 offset:54272
    ds_read_b64_tr_b16 v[52:53], v4 offset:55296
    ds_read_b64_tr_b16 v[54:55], v4 offset:56320
    ds_read_b128 v[48:51], v2 offset:35840
    ds_read_b64_tr_b16 v[56:57], v6 offset:55296
    ds_read_b64_tr_b16 v[58:59], v6 offset:56320
    s_waitcnt lgkmcnt(10)
    v_mfma_f32_32x32x16_bf16 v[60:75], v[16:19], v[12:15], v[60:75]
    v_mfma_f32_32x32x16_bf16 v[76:91], v[20:23], v[12:15], v[76:91]
    v_mfma_f32_32x32x16_bf16 v[60:75], v[28:31], v[24:27], v[60:75]
    v_mfma_f32_32x32x16_bf16 v[76:91], v[32:35], v[24:27], v[76:91]
    s_waitcnt vmcnt(8) lgkmcnt(0)
    s_barrier
    ds_read_b64_tr_b16 v[16:17], v5 offset:16384
    ds_read_b64_tr_b16 v[18:19], v5 offset:17408
    ds_read_b128 v[12:15], v3 offset:0
    ds_read_b64_tr_b16 v[20:21], v7 offset:16384
    ds_read_b64_tr_b16 v[22:23], v7 offset:17408
    ds_read_b64_tr_b16 v[28:29], v5 offset:18432
    ds_read_b64_tr_b16 v[30:31], v5 offset:19456
    ds_read_b128 v[24:27], v3 offset:1024
    ds_read_b64_tr_b16 v[32:33], v7 offset:18432
    ds_read_b64_tr_b16 v[34:35], v7 offset:19456
    v_mfma_f32_32x32x16_bf16 v[60:75], v[40:43], v[36:39], v[60:75]
    s_add_u32 m0, s44, 32768
    s_nop 0
    buffer_load_dwordx4 v1, s[12:15], s46 offen offset:0 lds
    v_mfma_f32_32x32x16_bf16 v[76:91], v[44:47], v[36:39], v[76:91]
    buffer_load_dwordx4 v1, s[12:15], s46 offen offset:1024 lds
    s_add_u32 s46, s46, 4096
    s_cmp_eq_u32 s46, s60
    s_cselect_b32 s46, s62, s46
    v_mfma_f32_32x32x16_bf16 v[60:75], v[52:55], v[48:51], v[60:75]
    s_add_u32 m0, s45, 32768
    s_nop 0
    buffer_load_dwordx4 v8, s[16:19], s47 offen offset:0 lds
    v_mfma_f32_32x32x16_bf16 v[76:91], v[56:59], v[48:51], v[76:91]
    buffer_load_dwordx4 v9, s[16:19], s47 offen offset:1024 lds
    s_add_u32 s47, s47, 65536
    s_cmp_eq_u32 s47, s61
    s_cselect_b32 s47, s63, s47
    ds_read_b64_tr_b16 v[40:41], v5 offset:20480
    ds_read_b64_tr_b16 v[42:43], v5 offset:21504
    ds_read_b128 v[36:39], v3 offset:2048
    ds_read_b64_tr_b16 v[44:45], v7 offset:20480
    ds_read_b64_tr_b16 v[46:47], v7 offset:21504
    ds_read_b64_tr_b16 v[52:53], v5 offset:22528
    ds_read_b64_tr_b16 v[54:55], v5 offset:23552
    ds_read_b128 v[48:51], v3 offset:3072
    ds_read_b64_tr_b16 v[56:57], v7 offset:22528
    ds_read_b64_tr_b16 v[58:59], v7 offset:23552
    s_waitcnt lgkmcnt(10)
    v_mfma_f32_32x32x16_bf16 v[60:75], v[16:19], v[12:15], v[60:75]
    v_mfma_f32_32x32x16_bf16 v[76:91], v[20:23], v[12:15], v[76:91]
    v_mfma_f32_32x32x16_bf16 v[60:75], v[28:31], v[24:27], v[60:75]
    v_mfma_f32_32x32x16_bf16 v[76:91], v[32:35], v[24:27], v[76:91]
    s_waitcnt vmcnt(8) lgkmcnt(0)
    s_barrier
    ds_read_b64_tr_b16 v[16:17], v5 offset:49152
    ds_read_b64_tr_b16 v[18:19], v5 offset:50176
    ds_read_b128 v[12:15], v3 offset:32768
    ds_read_b64_tr_b16 v[20:21], v7 offset:49152
    ds_read_b64_tr_b16 v[22:23], v7 offset:50176
    ds_read_b64_tr_b16 v[28:29], v5 offset:51200
    ds_read_b64_tr_b16 v[30:31], v5 offset:52224
    ds_read_b128 v[24:27], v3 offset:33792
    ds_read_b64_tr_b16 v[32:33], v7 offset:51200
    ds_read_b64_tr_b16 v[34:35], v7 offset:52224
    v_mfma_f32_32x32x16_bf16 v[60:75], v[40:43], v[36:39], v[60:75]
    s_add_u32 m0, s44, 65536
    s_nop 0
    buffer_load_dwordx4 v1, s[12:15], s46 offen offset:0 lds
    v_mfma_f32_32x32x16_bf16 v[76:91], v[44:47], v[36:39], v[76:91]
    buffer_load_dwordx4 v1, s[12:15], s46 offen offset:1024 lds
    s_add_u32 s46, s46, 4096
    s_cmp_eq_u32 s46, s60
    s_cselect_b32 s46, s62, s46
    v_mfma_f32_32x32x16_bf16 v[60:75], v[52:55], v[48:51], v[60:75]
    s_add_u32 m0, s45, 65536
    s_nop 0
    buffer_load_dwordx4 v8, s[16:19], s47 offen offset:0 lds
    v_mfma_f32_32x32x16_bf16 v[76:91], v[56:59], v[48:51], v[76:91]
    buffer_load_dwordx4 v9, s[16:19], s47 offen offset:1024 lds
    s_add_u32 s47, s47, 65536
    s_cmp_eq_u32 s47, s61
    s_cselect_b32 s47, s63, s47
    ds_read_b64_tr_b16 v[40:41], v5 offset:53248
    ds_read_b64_tr_b16 v[42:43], v5 offset:54272
    ds_read_b128 v[36:39], v3 offset:34816
    ds_read_b64_tr_b16 v[44:45], v7 offset:53248
    ds_read_b64_tr_b16 v[46:47], v7 offset:54272
    ds_read_b64_tr_b16 v[52:53], v5 offset:55296
    ds_read_b64_tr_b16 v[54:55], v5 offset:56320
    ds_read_b128 v[48:51], v3 offset:35840
    ds_read_b64_tr_b16 v[56:57], v7 offset:55296
    ds_read_b64_tr_b16 v[58:59], v7 offset:56320
    s_waitcnt lgkmcnt(10)
    v_mfma_f32_32x32x16_bf16 v[60:75], v[16:19], v[12:15], v[60:75]
    v_mfma_f32_32x32x16_bf16 v[76:91], v[20:23], v[12:15], v[76:91]
    v_mfma_f32_32x32x16_bf16 v[60:75], v[28:31], v[24:27], v[60:75]
    v_mfma_f32_32x32x16_bf16 v[76:91], v[32:35], v[24:27], v[76:91]
    s_waitcnt vmcnt(8) lgkmcnt(0)
    s_barrier
    ds_read_b64_tr_b16 v[16:17], v4 offset:16384
    ds_read_b64_tr_b16 v[18:19], v4 offset:17408
    ds_read_b128 v[12:15], v2 offset:0
    ds_read_b64_tr_b16 v[20:21], v6 offset:16384
    ds_read_b64_tr_b16 v[22:23], v6 offset:17408
    ds_read_b64_tr_b16 v[28:29], v4 offset:18432
    ds_read_b64_tr_b16 v[30:31], v4 offset:19456
    ds_read_b128 v[24:27], v2 offset:1024
    ds_read_b64_tr_b16 v[32:33], v6 offset:18432
    ds_read_b64_tr_b16 v[34:35], v6 offset:19456
    v_mfma_f32_32x32x16_bf16 v[60:75], v[40:43], v[36:39], v[60:75]
    s_add_u32 m0, s44, 98304
    s_nop 0
    buffer_load_dwordx4 v1, s[12:15], s46 offen offset:0 lds
    v_mfma_f32_32x32x16_bf16 v[76:91], v[44:47], v[36:39], v[76:91]
    buffer_load_dwordx4 v1, s[12:15], s46 offen offset:1024 lds
    s_add_u32 s46, s46, 4096
    s_cmp_eq_u32 s46, s60
    s_cselect_b32 s46, s62, s46
    v_mfma_f32_32x32x16_bf16 v[60:75], v[52:55], v[48:51], v[60:75]
    s_add_u32 m0, s45, 98304
    s_nop 0
    buffer_load_dwordx4 v8, s[16:19], s47 offen offset:0 lds
    v_mfma_f32_32x32x16_bf16 v[76:91], v[56:59], v[48:51], v[76:91]
    buffer_load_dwordx4 v9, s[16:19], s47 offen offset:1024 lds
    s_add_u32 s47, s47, 65536
    s_cmp_eq_u32 s47, s61
    s_cselect_b32 s47, s63, s47
    ds_read_b64_tr_b16 v[40:41], v4 offset:20480
    ds_read_b64_tr_b16 v[42:43], v4 offset:21504
    ds_read_b128 v[36:39], v2 offset:2048
    ds_read_b64_tr_b16 v[44:45], v6 offset:20480
    ds_read_b64_tr_b16 v[46:47], v6 offset:21504
    ds_read_b64_tr_b16 v[52:53], v4 offset:22528
    ds_read_b64_tr_b16 v[54:55], v4 offset:23552
    ds_read_b128 v[48:51], v2 offset:3072
    ds_read_b64_tr_b16 v[56:57], v6 offset:22528
    ds_read_b64_tr_b16 v[58:59], v6 offset:23552
    s_waitcnt lgkmcnt(10)
    v_mfma_f32_32x32x16_bf16 v[60:75], v[16:19], v[12:15], v[60:75]
    v_mfma_f32_32x32x16_bf16 v[76:91], v[20:23], v[12:15], v[76:91]
    v_mfma_f32_32x32x16_bf16 v[60:75], v[28:31], v[24:27], v[60:75]
    v_mfma_f32_32x32x16_bf16 v[76:91], v[32:35], v[24:27], v[76:91]
    s_waitcnt vmcnt(8) lgkmcnt(0)
    s_barrier
    ds_read_b64_tr_b16 v[16:17], v4 offset:49152
    ds_read_b64_tr_b16 v[18:19], v4 offset:50176
    ds_read_b128 v[12:15], v2 offset:32768
    ds_read_b64_tr_b16 v[20:21], v6 offset:49152
    ds_read_b64_tr_b16 v[22:23], v6 offset:50176
    ds_read_b64_tr_b16 v[28:29], v4 offset:51200
    ds_read_b64_tr_b16 v[30:31], v4 offset:52224
    ds_read_b128 v[24:27], v2 offset:33792
    ds_read_b64_tr_b16 v[32:33], v6 offset:51200
    ds_read_b64_tr_b16 v[34:35], v6 offset:52224
    v_mfma_f32_32x32x16_bf16 v[60:75], v[40:43], v[36:39], v[60:75]
    s_add_u32 m0, s44, 0
    s_nop 0
    buffer_load_dwordx4 v1, s[12:15], s46 offen offset:0 lds
    v_mfma_f32_32x32x16_bf16 v[76:91], v[44:47], v[36:39], v[76:91]
    buffer_load_dwordx4 v1, s[12:15], s46 offen offset:1024 lds
    s_add_u32 s46, s46, 4096
    s_cmp_eq_u32 s46, s60
    s_cselect_b32 s46, s62, s46
    v_mfma_f32_32x32x16_bf16 v[60:75], v[52:55], v[48:51], v[60:75]
    s_add_u32 m0, s45, 0
    s_nop 0
    buffer_load_dwordx4 v8, s[16:19], s47 offen offset:0 lds
    v_mfma_f32_32x32x16_bf16 v[76:91], v[56:59], v[48:51], v[76:91]
    buffer_load_dwordx4 v9, s[16:19], s47 offen offset:1024 lds
    s_add_u32 s47, s47, 65536
    s_cmp_eq_u32 s47, s61
    s_cselect_b32 s47, s63, s47
    ds_read_b64_tr_b16 v[40:41], v4 offset:53248
    ds_read_b64_tr_b16 v[42:43], v4 offset:54272
    ds_read_b128 v[36:39], v2 offset:34816
    ds_read_b64_tr_b16 v[44:45], v6 offset:53248
    ds_read_b64_tr_b16 v[46:47], v6 offset:54272
    ds_read_b64_tr_b16 v[52:53], v4 offset:55296
    ds_read_b64_tr_b16 v[54:55], v4 offset:56320
    ds_read_b128 v[48:51], v2 offset:35840
    ds_read_b64_tr_b16 v[56:57], v6 offset:55296
    ds_read_b64_tr_b16 v[58:59], v6 offset:56320
    s_waitcnt lgkmcnt(10)
    v_mfma_f32_32x32x16_bf16 v[60:75], v[16:19], v[12:15], v[60:75]
    v_mfma_f32_32x32x16_bf16 v[76:91], v[20:23], v[12:15], v[76:91]
    v_mfma_f32_32x32x16_bf16 v[60:75], v[28:31], v[24:27], v[60:75]
    v_mfma_f32_32x32x16_bf16 v[76:91], v[32:35], v[24:27], v[76:91]
    s_waitcnt vmcnt(8) lgkmcnt(0)
    s_barrier
    ds_read_b64_tr_b16 v[16:17], v5 offset:16384
    ds_read_b64_tr_b16 v[18:19], v5 offset:17408
    ds_read_b128 v[12:15], v3 offset:0
    ds_read_b64_tr_b16 v[20:21], v7 offset:16384
    ds_read_b64_tr_b16 v[22:23], v7 offset:17408
    ds_read_b64_tr_b16 v[28:29], v5 offset:18432
    ds_read_b64_tr_b16 v[30:31], v5 offset:19456
    ds_read_b128 v[24:27], v3 offset:1024
    ds_read_b64_tr_b16 v[32:33], v7 offset:18432
    ds_read_b64_tr_b16 v[34:35], v7 offset:19456
    v_mfma_f32_32x32x16_bf16 v[60:75], v[40:43], v[36:39], v[60:75]
    s_add_u32 m0, s44, 32768
    s_nop 0
    buffer_load_dwordx4 v1, s[12:15], s46 offen offset:0 lds
    v_mfma_f32_32x32x16_bf16 v[76:91], v[44:47], v[36:39], v[76:91]
    buffer_load_dwordx4 v1, s[12:15], s46 offen offset:1024 lds
    s_add_u32 s46, s46, 4096
    s_cmp_eq_u32 s46, s60
    s_cselect_b32 s46, s62, s46
    v_mfma_f32_32x32x16_bf16 v[60:75], v[52:55], v[48:51], v[60:75]
    s_add_u32 m0, s45, 32768
    s_nop 0
    buffer_load_dwordx4 v8, s[16:19], s47 offen offset:0 lds
    v_mfma_f32_32x32x16_bf16 v[76:91], v[56:59], v[48:51], v[76:91]
    buffer_load_dwordx4 v9, s[16:19], s47 offen offset:1024 lds
    s_add_u32 s47, s47, 65536
    s_cmp_eq_u32 s47, s61
    s_cselect_b32 s47, s63, s47
    ds_read_b64_tr_b16 v[40:41], v5 offset:20480
    ds_read_b64_tr_b16 v[42:43], v5 offset:21504
    ds_read_b128 v[36:39], v3 offset:2048
    ds_read_b64_tr_b16 v[44:45], v7 offset:20480
    ds_read_b64_tr_b16 v[46:47], v7 offset:21504
    ds_read_b64_tr_b16 v[52:53], v5 offset:22528
    ds_read_b64_tr_b16 v[54:55], v5 offset:23552
    ds_read_b128 v[48:51], v3 offset:3072
    ds_read_b64_tr_b16 v[56:57], v7 offset:22528
    ds_read_b64_tr_b16 v[58:59], v7 offset:23552
    s_waitcnt lgkmcnt(10)
    v_mfma_f32_32x32x16_bf16 v[60:75], v[16:19], v[12:15], v[60:75]
    v_mfma_f32_32x32x16_bf16 v[76:91], v[20:23], v[12:15], v[76:91]
    v_mfma_f32_32x32x16_bf16 v[60:75], v[28:31], v[24:27], v[60:75]
    v_mfma_f32_32x32x16_bf16 v[76:91], v[32:35], v[24:27], v[76:91]
    s_waitcnt vmcnt(8) lgkmcnt(0)
    s_barrier
    ds_read_b64_tr_b16 v[16:17], v5 offset:49152
    ds_read_b64_tr_b16 v[18:19], v5 offset:50176
    ds_read_b128 v[12:15], v3 offset:32768
    ds_read_b64_tr_b16 v[20:21], v7 offset:49152
    ds_read_b64_tr_b16 v[22:23], v7 offset:50176
    ds_read_b64_tr_b16 v[28:29], v5 offset:51200
    ds_read_b64_tr_b16 v[30:31], v5 offset:52224
    ds_read_b128 v[24:27], v3 offset:33792
    ds_read_b64_tr_b16 v[32:33], v7 offset:51200
    ds_read_b64_tr_b16 v[34:35], v7 offset:52224
    v_mfma_f32_32x32x16_bf16 v[60:75], v[40:43], v[36:39], v[60:75]
    s_add_u32 m0, s44, 65536
    s_nop 0
    buffer_load_dwordx4 v1, s[12:15], s46 offen offset:0 lds
    v_mfma_f32_32x32x16_bf16 v[76:91], v[44:47], v[36:39], v[76:91]
    buffer_load_dwordx4 v1, s[12:15], s46 offen offset:1024 lds
    s_add_u32 s46, s46, 4096
    s_cmp_eq_u32 s46, s60
    s_cselect_b32 s46, s62, s46
    v_mfma_f32_32x32x16_bf16 v[60:75], v[52:55], v[48:51], v[60:75]
    s_add_u32 m0, s45, 65536
    s_nop 0
    buffer_load_dwordx4 v8, s[16:19], s47 offen offset:0 lds
    v_mfma_f32_32x32x16_bf16 v[76:91], v[56:59], v[48:51], v[76:91]
    buffer_load_dwordx4 v9, s[16:19], s47 offen offset:1024 lds
    s_add_u32 s47, s47, 65536
    s_cmp_eq_u32 s47, s61
    s_cselect_b32 s47, s63, s47
    ds_read_b64_tr_b16 v[40:41], v5 offset:53248
    ds_read_b64_tr_b16 v[42:43], v5 offset:54272
    ds_read_b128 v[36:39], v3 offset:34816
    ds_read_b64_tr_b16 v[44:45], v7 offset:53248
    ds_read_b64_tr_b16 v[46:47], v7 offset:54272
    ds_read_b64_tr_b16 v[52:53], v5 offset:55296
    ds_read_b64_tr_b16 v[54:55], v5 offset:56320
    ds_read_b128 v[48:51], v3 offset:35840
    ds_read_b64_tr_b16 v[56:57], v7 offset:55296
    ds_read_b64_tr_b16 v[58:59], v7 offset:56320
    s_waitcnt lgkmcnt(10)
    v_mfma_f32_32x32x16_bf16 v[60:75], v[16:19], v[12:15], v[60:75]
    v_mfma_f32_32x32x16_bf16 v[76:91], v[20:23], v[12:15], v[76:91]
    v_mfma_f32_32x32x16_bf16 v[60:75], v[28:31], v[24:27], v[60:75]
    v_mfma_f32_32x32x16_bf16 v[76:91], v[32:35], v[24:27], v[76:91]
    s_waitcnt vmcnt(8) lgkmcnt(0)
    s_barrier
    ds_read_b64_tr_b16 v[16:17], v4 offset:16384
    ds_read_b64_tr_b16 v[18:19], v4 offset:17408
    ds_read_b128 v[12:15], v2 offset:0
    ds_read_b64_tr_b16 v[20:21], v6 offset:16384
    ds_read_b64_tr_b16 v[22:23], v6 offset:17408
    ds_read_b64_tr_b16 v[28:29], v4 offset:18432
    ds_read_b64_tr_b16 v[30:31], v4 offset:19456
    ds_read_b128 v[24:27], v2 offset:1024
    ds_read_b64_tr_b16 v[32:33], v6 offset:18432
    ds_read_b64_tr_b16 v[34:35], v6 offset:19456
    v_mfma_f32_32x32x16_bf16 v[60:75], v[40:43], v[36:39], v[60:75]
    s_add_u32 m0, s44, 98304
    s_nop 0
    buffer_load_dwordx4 v1, s[12:15], s46 offen offset:0 lds
    v_mfma_f32_32x32x16_bf16 v[76:91], v[44:47], v[36:39], v[76:91]
    buffer_load_dwordx4 v1, s[12:15], s46 offen offset:1024 lds
    s_add_u32 s46, s46, 4096
    s_cmp_eq_u32 s46, s60
    s_cselect_b32 s46, s62, s46
    v_mfma_f32_32x32x16_bf16 v[60:75], v[52:55], v[48:51], v[60:75]
    s_add_u32 m0, s45, 98304
    s_nop 0
    buffer_load_dwordx4 v8, s[16:19], s47 offen offset:0 lds
    v_mfma_f32_32x32x16_bf16 v[76:91], v[56:59], v[48:51], v[76:91]
    buffer_load_dwordx4 v9, s[16:19], s47 offen offset:1024 lds
    s_add_u32 s47, s47, 65536
    s_cmp_eq_u32 s47, s61
    s_cselect_b32 s47, s63, s47
    ds_read_b64_tr_b16 v[40:41], v4 offset:20480
    ds_read_b64_tr_b16 v[42:43], v4 offset:21504
    ds_read_b128 v[36:39], v2 offset:2048
    ds_read_b64_tr_b16 v[44:45], v6 offset:20480
    ds_read_b64_tr_b16 v[46:47], v6 offset:21504
    ds_read_b64_tr_b16 v[52:53], v4 offset:22528
    ds_read_b64_tr_b16 v[54:55], v4 offset:23552
    ds_read_b128 v[48:51], v2 offset:3072
    ds_read_b64_tr_b16 v[56:57], v6 offset:22528
    ds_read_b64_tr_b16 v[58:59], v6 offset:23552
    s_waitcnt lgkmcnt(10)
    v_mfma_f32_32x32x16_bf16 v[60:75], v[16:19], v[12:15], v[60:75]
    v_mfma_f32_32x32x16_bf16 v[76:91], v[20:23], v[12:15], v[76:91]
    v_mfma_f32_32x32x16_bf16 v[60:75], v[28:31], v[24:27], v[60:75]
    v_mfma_f32_32x32x16_bf16 v[76:91], v[32:35], v[24:27], v[76:91]
    s_waitcnt vmcnt(8) lgkmcnt(0)
    s_barrier
    ds_read_b64_tr_b16 v[16:17], v4 offset:49152
    ds_read_b64_tr_b16 v[18:19], v4 offset:50176
    ds_read_b128 v[12:15], v2 offset:32768
    ds_read_b64_tr_b16 v[20:21], v6 offset:49152
    ds_read_b64_tr_b16 v[22:23], v6 offset:50176
    ds_read_b64_tr_b16 v[28:29], v4 offset:51200
    ds_read_b64_tr_b16 v[30:31], v4 offset:52224
    ds_read_b128 v[24:27], v2 offset:33792
    ds_read_b64_tr_b16 v[32:33], v6 offset:51200
    ds_read_b64_tr_b16 v[34:35], v6 offset:52224
    v_mfma_f32_32x32x16_bf16 v[60:75], v[40:43], v[36:39], v[60:75]
    v_mfma_f32_32x32x16_bf16 v[76:91], v[44:47], v[36:39], v[76:91]
    v_mfma_f32_32x32x16_bf16 v[60:75], v[52:55], v[48:51], v[60:75]
    v_mfma_f32_32x32x16_bf16 v[76:91], v[56:59], v[48:51], v[76:91]
    ds_read_b64_tr_b16 v[40:41], v4 offset:53248
    ds_read_b64_tr_b16 v[42:43], v4 offset:54272
    ds_read_b128 v[36:39], v2 offset:34816
    ds_read_b64_tr_b16 v[44:45], v6 offset:53248
    ds_read_b64_tr_b16 v[46:47], v6 offset:54272
    ds_read_b64_tr_b16 v[52:53], v4 offset:55296
    ds_read_b64_tr_b16 v[54:55], v4 offset:56320
    ds_read_b128 v[48:51], v2 offset:35840
    ds_read_b64_tr_b16 v[56:57], v6 offset:55296
    ds_read_b64_tr_b16 v[58:59], v6 offset:56320
    s_waitcnt lgkmcnt(10)
    v_mfma_f32_32x32x16_bf16 v[60:75], v[16:19], v[12:15], v[60:75]
    v_mfma_f32_32x32x16_bf16 v[76:91], v[20:23], v[12:15], v[76:91]
    v_mfma_f32_32x32x16_bf16 v[60:75], v[28:31], v[24:27], v[60:75]
    v_mfma_f32_32x32x16_bf16 v[76:91], v[32:35], v[24:27], v[76:91]
    s_waitcnt vmcnt(4) lgkmcnt(0)
    s_barrier
    ds_read_b64_tr_b16 v[16:17], v5 offset:16384
    ds_read_b64_tr_b16 v[18:19], v5 offset:17408
    ds_read_b128 v[12:15], v3 offset:0
    ds_read_b64_tr_b16 v[20:21], v7 offset:16384
    ds_read_b64_tr_b16 v[22:23], v7 offset:17408
    ds_read_b64_tr_b16 v[28:29], v5 offset:18432
    ds_read_b64_tr_b16 v[30:31], v5 offset:19456
    ds_read_b128 v[24:27], v3 offset:1024
    ds_read_b64_tr_b16 v[32:33], v7 offset:18432
    ds_read_b64_tr_b16 v[34:35], v7 offset:19456
    v_mfma_f32_32x32x16_bf16 v[60:75], v[40:43], v[36:39], v[60:75]
    v_mfma_f32_32x32x16_bf16 v[76:91], v[44:47], v[36:39], v[76:91]
    v_mfma_f32_32x32x16_bf16 v[60:75], v[52:55], v[48:51], v[60:75]
    v_mfma_f32_32x32x16_bf16 v[76:91], v[56:59], v[48:51], v[76:91]
    ds_read_b64_tr_b16 v[40:41], v5 offset:20480
    ds_read_b64_tr_b16 v[42:43], v5 offset:21504
    ds_read_b128 v[36:39], v3 offset:2048
    ds_read_b64_tr_b16 v[44:45], v7 offset:20480
    ds_read_b64_tr_b16 v[46:47], v7 offset:21504
    ds_read_b64_tr_b16 v[52:53], v5 offset:22528
    ds_read_b64_tr_b16 v[54:55], v5 offset:23552
    ds_read_b128 v[48:51], v3 offset:3072
    ds_read_b64_tr_b16 v[56:57], v7 offset:22528
    ds_read_b64_tr_b16 v[58:59], v7 offset:23552
    s_waitcnt lgkmcnt(10)
    v_mfma_f32_32x32x16_bf16 v[60:75], v[16:19], v[12:15], v[60:75]
    v_mfma_f32_32x32x16_bf16 v[76:91], v[20:23], v[12:15], v[76:91]
    v_mfma_f32_32x32x16_bf16 v[60:75], v[28:31], v[24:27], v[60:75]
    v_mfma_f32_32x32x16_bf16 v[76:91], v[32:35], v[24:27], v[76:91]
    s_waitcnt vmcnt(0) lgkmcnt(0)
    s_barrier
    ds_read_b64_tr_b16 v[16:17], v5 offset:49152
    ds_read_b64_tr_b16 v[18:19], v5 offset:50176
    ds_read_b128 v[12:15], v3 offset:32768
    ds_read_b64_tr_b16 v[20:21], v7 offset:49152
    ds_read_b64_tr_b16 v[22:23], v7 offset:50176
    ds_read_b64_tr_b16 v[28:29], v5 offset:51200
    ds_read_b64_tr_b16 v[30:31], v5 offset:52224
    ds_read_b128 v[24:27], v3 offset:33792
    ds_read_b64_tr_b16 v[32:33], v7 offset:51200
    ds_read_b64_tr_b16 v[34:35], v7 offset:52224
    v_mfma_f32_32x32x16_bf16 v[60:75], v[40:43], v[36:39], v[60:75]
    v_mfma_f32_32x32x16_bf16 v[76:91], v[44:47], v[36:39], v[76:91]
    v_mfma_f32_32x32x16_bf16 v[60:75], v[52:55], v[48:51], v[60:75]
    v_mfma_f32_32x32x16_bf16 v[76:91], v[56:59], v[48:51], v[76:91]
    ds_read_b64_tr_b16 v[40:41], v5 offset:53248
    ds_read_b64_tr_b16 v[42:43], v5 offset:54272
    ds_read_b128 v[36:39], v3 offset:34816
    ds_read_b64_tr_b16 v[44:45], v7 offset:53248
    ds_read_b64_tr_b16 v[46:47], v7 offset:54272
    ds_read_b64_tr_b16 v[52:53], v5 offset:55296
    ds_read_b64_tr_b16 v[54:55], v5 offset:56320
    ds_read_b128 v[48:51], v3 offset:35840
    ds_read_b64_tr_b16 v[56:57], v7 offset:55296
    ds_read_b64_tr_b16 v[58:59], v7 offset:56320
    s_waitcnt lgkmcnt(10)
    v_mfma_f32_32x32x16_bf16 v[60:75], v[16:19], v[12:15], v[60:75]
    v_mfma_f32_32x32x16_bf16 v[76:91], v[20:23], v[12:15], v[76:91]
    v_mfma_f32_32x32x16_bf16 v[60:75], v[28:31], v[24:27], v[60:75]
    v_mfma_f32_32x32x16_bf16 v[76:91], v[32:35], v[24:27], v[76:91]
    s_waitcnt lgkmcnt(0)
    v_mfma_f32_32x32x16_bf16 v[60:75], v[40:43], v[36:39], v[60:75]
    v_mfma_f32_32x32x16_bf16 v[76:91], v[44:47], v[36:39], v[76:91]
    v_mfma_f32_32x32x16_bf16 v[60:75], v[52:55], v[48:51], v[60:75]
    v_mfma_f32_32x32x16_bf16 v[76:91], v[56:59], v[48:51], v[76:91]
    s_nop 7
    s_nop 7
    v_cvt_pk_bf16_f32 v12, v60, v61
    v_cvt_pk_bf16_f32 v13, v62, v63
    v_cvt_pk_bf16_f32 v14, v64, v65
    v_cvt_pk_bf16_f32 v15, v66, v67
    v_cvt_pk_bf16_f32 v16, v68, v69
    v_cvt_pk_bf16_f32 v17, v70, v71
    v_cvt_pk_bf16_f32 v18, v72, v73
    v_cvt_pk_bf16_f32 v19, v74, v75
    v_cvt_pk_bf16_f32 v20, v76, v77
    v_cvt_pk_bf16_f32 v21, v78, v79
    v_cvt_pk_bf16_f32 v22, v80, v81
    v_cvt_pk_bf16_f32 v23, v82, v83
    v_cvt_pk_bf16_f32 v24, v84, v85
    v_cvt_pk_bf16_f32 v25, v86, v87
    v_cvt_pk_bf16_f32 v26, v88, v89
    v_cvt_pk_bf16_f32 v27, v90, v91
    buffer_store_dwordx4 v[12:15], v1, s[20:23], s36 offen offset:0 sc0 sc1
    buffer_store_dwordx4 v[16:19], v1, s[20:23], s36 offen offset:1024 sc0 sc1
    buffer_store_dwordx4 v[20:23], v1, s[20:23], s36 offen offset:2048 sc0 sc1
    buffer_store_dwordx4 v[24:27], v1, s[20:23], s36 offen offset:3072 sc0 sc1
    s_add_u32 s36, s36, 32768
op_end:
    s_endpgm
.text
.globl ln2_kernel
.p2align 8
.type ln2_kernel,@function
ln2_kernel:
    s_load_dwordx2 s[4:5], s[0:1], 0
    s_load_dwordx2 s[6:7], s[0:1], 112
    s_cmp_ge_u32 s2, 256
    s_cbranch_scc1 ln2_end
    s_waitcnt lgkmcnt(0)
    s_mov_b32 s12, s4
    s_mov_b32 s13, s5
    s_mov_b32 s14, 2097152
    s_mov_b32 s15, 0x00020000
    s_add_u32 s16, s6, 67108864
    s_addc_u32 s17, s7, 0
    s_mov_b32 s18, 8388608
    s_mov_b32 s19, 0x00020000
    s_mov_b32 s20, s6
    s_mov_b32 s21, s7
    s_mov_b32 s22, 12288
    s_mov_b32 s23, 0x00020000
    s_add_u32 s24, s6, 7340032
    s_addc_u32 s25, s7, 0
    s_mov_b32 s26, 2097152
    s_mov_b32 s27, 0x00020000
    s_add_u32 s28, s6, 5242880
    s_addc_u32 s29, s7, 0
    s_mov_b32 s30, 2097152
    s_mov_b32 s31, 0x00020000
    v_and_b32 v1, 7, v0
    v_bfe_u32 v2, v0, 3, 1
    v_lshrrev_b32 v3, 4, v0
    v_lshlrev_b32 v5, 4, v1
    v_lshl_add_u32 v5, v2, 9, v5
    v_lshl_add_u32 v5, v3, 10, v5
    v_add_u32 v6, 0x4000, v5
    s_lshr_b32 s33, s2, 2
    s_and_b32 s34, s2, 3
    s_lshl_b32 s34, s34, 7
    s_lshl_b32 s33, s33, 15
    s_add_u32 s33, s33, s34
    s_mov_b32 s35, s33
    buffer_load_dwordx4 v[96:99], v5, s[16:19], s35 offen
    buffer_load_dwordx4 v[100:103], v6, s[16:19], s35 offen
    s_add_u32 s35, s35, 2097152
    buffer_load_dwordx4 v[104:107], v5, s[16:19], s35 offen
    buffer_load_dwordx4 v[108:111], v6, s[16:19], s35 offen
    s_add_u32 s35, s35, 2097152
    buffer_load_dwordx4 v[112:115], v5, s[16:19], s35 offen
    buffer_load_dwordx4 v[116:119], v6, s[16:19], s35 offen
    s_add_u32 s35, s35, 2097152
    buffer_load_dwordx4 v[120:123], v5, s[16:19], s35 offen
    buffer_load_dwordx4 v[124:127], v6, s[16:19], s35 offen
    s_add_u32 s35, s35, 2097152
    v_lshlrev_b32 v4, 10, v1
    v_lshl_add_u32 v4, v2, 3, v4
    v_lshl_add_u32 v4, v3, 5, v4
    s_lshl_b32 s36, s2, 13
    buffer_load_dwordx2 v[8:9], v4, s[12:15], s36 offen
    buffer_load_dwordx2 v[10:11], v4, s[12:15], s36 offen offset:16
    buffer_load_dwordx2 v[12:13], v4, s[12:15], s36 offen offset:512
    buffer_load_dwordx2 v[14:15], v4, s[12:15], s36 offen offset:528
    v_lshlrev_b32 v4, 4, v2
    v_lshl_add_u32 v4, v3, 6, v4
    s_mov_b32 s36, 4096
    buffer_load_dwordx4 v[16:19], v4, s[20:23], s36 offen offset:0
    buffer_load_dwordx4 v[20:23], v4, s[20:23], s36 offen offset:32
    buffer_load_dwordx4 v[24:27], v4, s[20:23], s36 offen offset:1024
    buffer_load_dwordx4 v[28:31], v4, s[20:23], s36 offen offset:1056
    s_mov_b32 s36, 8192
    buffer_load_dwordx4 v[32:35], v4, s[20:23], s36 offen offset:0
    buffer_load_dwordx4 v[36:39], v4, s[20:23], s36 offen offset:32
    buffer_load_dwordx4 v[40:43], v4, s[20:23], s36 offen offset:1024
    buffer_load_dwordx4 v[44:47], v4, s[20:23], s36 offen offset:1056
    s_mov_b32 s36, 6144
    buffer_load_dwordx4 v[48:51], v4, s[20:23], s36 offen offset:0
    buffer_load_dwordx4 v[52:55], v4, s[20:23], s36 offen offset:32
    buffer_load_dwordx4 v[56:59], v4, s[20:23], s36 offen offset:1024
    buffer_load_dwordx4 v[60:63], v4, s[20:23], s36 offen offset:1056
    s_waitcnt vmcnt(16)
    v_and_b32 v65, 0xffff0000, v96
    v_lshlrev_b32 v64, 16, v96
    v_and_b32 v81, 0xffff0000, v104
    v_lshlrev_b32 v80, 16, v104
    v_add_f32 v64, v64, v80
    v_add_f32 v65, v65, v81
    v_and_b32 v81, 0xffff0000, v112
    v_lshlrev_b32 v80, 16, v112
    v_add_f32 v64, v64, v80
    v_add_f32 v65, v65, v81
    v_and_b32 v81, 0xffff0000, v120
    v_lshlrev_b32 v80, 16, v120
    v_add_f32 v64, v64, v80
    v_add_f32 v65, v65, v81
    v_and_b32 v67, 0xffff0000, v97
    v_lshlrev_b32 v66, 16, v97
    v_and_b32 v81, 0xffff0000, v105
    v_lshlrev_b32 v80, 16, v105
    v_add_f32 v66, v66, v80
    v_add_f32 v67, v67, v81
    v_and_b32 v81, 0xffff0000, v113
    v_lshlrev_b32 v80, 16, v113
    v_add_f32 v66, v66, v80
    v_add_f32 v67, v67, v81
    v_and_b32 v81, 0xffff0000, v121
    v_lshlrev_b32 v80, 16, v121
    v_add_f32 v66, v66, v80
    v_add_f32 v67, v67, v81
    v_and_b32 v69, 0xffff0000, v98
    v_lshlrev_b32 v68, 16, v98
    v_and_b32 v81, 0xffff0000, v106
    v_lshlrev_b32 v80, 16, v106
    v_add_f32 v68, v68, v80
    v_add_f32 v69, v69, v81
    v_and_b32 v81, 0xffff0000, v114
    v_lshlrev_b32 v80, 16, v114
    v_add_f32 v68, v68, v80
    v_add_f32 v69, v69, v81
    v_and_b32 v81, 0xffff0000, v122
    v_lshlrev_b32 v80, 16, v122
    v_add_f32 v68, v68, v80
    v_add_f32 v69, v69, v81
    v_and_b32 v71, 0xffff0000, v99
    v_lshlrev_b32 v70, 16, v99
    v_and_b32 v81, 0xffff0000, v107
    v_lshlrev_b32 v80, 16, v107
    v_add_f32 v70, v70, v80
    v_add_f32 v71, v71, v81
    v_and_b32 v81, 0xffff0000, v115
    v_lshlrev_b32 v80, 16, v115
    v_add_f32 v70, v70, v80
    v_add_f32 v71, v71, v81
    v_and_b32 v81, 0xffff0000, v123
    v_lshlrev_b32 v80, 16, v123
    v_add_f32 v70, v70, v80
    v_add_f32 v71, v71, v81
    v_and_b32 v73, 0xffff0000, v100
    v_lshlrev_b32 v72, 16, v100
    v_and_b32 v81, 0xffff0000, v108
    v_lshlrev_b32 v80, 16, v108
    v_add_f32 v72, v72, v80
    v_add_f32 v73, v73, v81
    v_and_b32 v81, 0xffff0000, v116
    v_lshlrev_b32 v80, 16, v116
    v_add_f32 v72, v72, v80
    v_add_f32 v73, v73, v81
    v_and_b32 v81, 0xffff0000, v124
    v_lshlrev_b32 v80, 16, v124
    v_add_f32 v72, v72, v80
    v_add_f32 v73, v73, v81
    v_and_b32 v75, 0xffff0000, v101
    v_lshlrev_b32 v74, 16, v101
    v_and_b32 v81, 0xffff0000, v109
    v_lshlrev_b32 v80, 16, v109
    v_add_f32 v74, v74, v80
    v_add_f32 v75, v75, v81
    v_and_b32 v81, 0xffff0000, v117
    v_lshlrev_b32 v80, 16, v117
    v_add_f32 v74, v74, v80
    v_add_f32 v75, v75, v81
    v_and_b32 v81, 0xffff0000, v125
    v_lshlrev_b32 v80, 16, v125
    v_add_f32 v74, v74, v80
    v_add_f32 v75, v75, v81
    v_and_b32 v77, 0xffff0000, v102
    v_lshlrev_b32 v76, 16, v102
    v_and_b32 v81, 0xffff0000, v110
    v_lshlrev_b32 v80, 16, v110
    v_add_f32 v76, v76, v80
    v_add_f32 v77, v77, v81
    v_and_b32 v81, 0xffff0000, v118
    v_lshlrev_b32 v80, 16, v118
    v_add_f32 v76, v76, v80
    v_add_f32 v77, v77, v81
    v_and_b32 v81, 0xffff0000, v126
    v_lshlrev_b32 v80, 16, v126
    v_add_f32 v76, v76, v80
    v_add_f32 v77, v77, v81
    v_and_b32 v79, 0xffff0000, v103
    v_lshlrev_b32 v78, 16, v103
    v_and_b32 v81, 0xffff0000, v111
    v_lshlrev_b32 v80, 16, v111
    v_add_f32 v78, v78, v80
    v_add_f32 v79, v79, v81
    v_and_b32 v81, 0xffff0000, v119
    v_lshlrev_b32 v80, 16, v119
    v_add_f32 v78, v78, v80
    v_add_f32 v79, v79, v81
    v_and_b32 v81, 0xffff0000, v127
    v_lshlrev_b32 v80, 16, v127
    v_add_f32 v78, v78, v80
    v_add_f32 v79, v79, v81
    s_waitcnt vmcnt(0)
    v_and_b32 v81, 0xffff0000, v8
    v_lshlrev_b32 v80, 16, v8
    v_and_b32 v83, 0xffff0000, v9
    v_lshlrev_b32 v82, 16, v9
    v_and_b32 v85, 0xffff0000, v10
    v_lshlrev_b32 v84, 16, v10
    v_and_b32 v87, 0xffff0000, v11
    v_lshlrev_b32 v86, 16, v11
    v_and_b32 v89, 0xffff0000, v12
    v_lshlrev_b32 v88, 16, v12
    v_and_b32 v91, 0xffff0000, v13
    v_lshlrev_b32 v90, 16, v13
    v_and_b32 v93, 0xffff0000, v14
    v_lshlrev_b32 v92, 16, v14
    v_and_b32 v95, 0xffff0000, v15
    v_lshlrev_b32 v94, 16, v15
    v_fmac_f32 v80, v64, v16
    v_fmac_f32 v81, v65, v17
    v_fmac_f32 v82, v66, v18
    v_fmac_f32 v83, v67, v19
    v_fmac_f32 v84, v68, v20
    v_fmac_f32 v85, v69, v21
    v_fmac_f32 v86, v70, v22
    v_fmac_f32 v87, v71, v23
    v_fmac_f32 v88, v72, v24
    v_fmac_f32 v89, v73, v25
    v_fmac_f32 v90, v74, v26
    v_fmac_f32 v91, v75, v27
    v_fmac_f32 v92, v76, v28
    v_fmac_f32 v93, v77, v29
    v_fmac_f32 v94, v78, v30
    v_fmac_f32 v95, v79, v31
    v_cvt_pk_bf16_f32 v8, v80, v81
    v_cvt_pk_bf16_f32 v9, v82, v83
    v_cvt_pk_bf16_f32 v10, v84, v85
    v_cvt_pk_bf16_f32 v11, v86, v87
    v_cvt_pk_bf16_f32 v12, v88, v89
    v_cvt_pk_bf16_f32 v13, v90, v91
    v_cvt_pk_bf16_f32 v14, v92, v93
    v_cvt_pk_bf16_f32 v15, v94, v95
    buffer_store_dwordx4 v[8:11], v5, s[24:27], s33 offen sc0 sc1
    buffer_store_dwordx4 v[12:15], v6, s[24:27], s33 offen sc0 sc1
    v_and_b32 v81, 0xffff0000, v8
    v_lshlrev_b32 v80, 16, v8
    v_and_b32 v83, 0xffff0000, v9
    v_lshlrev_b32 v82, 16, v9
    v_and_b32 v85, 0xffff0000, v10
    v_lshlrev_b32 v84, 16, v10
    v_and_b32 v87, 0xffff0000, v11
    v_lshlrev_b32 v86, 16, v11
    v_and_b32 v89, 0xffff0000, v12
    v_lshlrev_b32 v88, 16, v12
    v_and_b32 v91, 0xffff0000, v13
    v_lshlrev_b32 v90, 16, v13
    v_and_b32 v93, 0xffff0000, v14
    v_lshlrev_b32 v92, 16, v14
    v_and_b32 v95, 0xffff0000, v15
    v_lshlrev_b32 v94, 16, v15
    v_add_f32 v64, v80, v81
    v_mul_f32 v65, v80, v80
    v_fmac_f32 v65, v81, v81
    v_add_f32 v64, v64, v82
    v_fmac_f32 v65, v82, v82
    v_add_f32 v64, v64, v83
    v_fmac_f32 v65, v83, v83
    v_add_f32 v64, v64, v84
    v_fmac_f32 v65, v84, v84
    v_add_f32 v64, v64, v85
    v_fmac_f32 v65, v85, v85
    v_add_f32 v64, v64, v86
    v_fmac_f32 v65, v86, v86
    v_add_f32 v64, v64, v87
    v_fmac_f32 v65, v87, v87
    v_add_f32 v64, v64, v88
    v_fmac_f32 v65, v88, v88
    v_add_f32 v64, v64, v89
    v_fmac_f32 v65, v89, v89
    v_add_f32 v64, v64, v90
    v_fmac_f32 v65, v90, v90
    v_add_f32 v64, v64, v91
    v_fmac_f32 v65, v91, v91
    v_add_f32 v64, v64, v92
    v_fmac_f32 v65, v92, v92
    v_add_f32 v64, v64, v93
    v_fmac_f32 v65, v93, v93
    v_add_f32 v64, v64, v94
    v_fmac_f32 v65, v94, v94
    v_add_f32 v64, v64, v95
    v_fmac_f32 v65, v95, v95
    s_nop 1
    v_add_f32_dpp v64, v64, v64 row_ror:8 row_mask:0xf bank_mask:0xf
    v_add_f32_dpp v65, v65, v65 row_ror:8 row_mask:0xf bank_mask:0xf
    v_mov_b32 v66, v64
    v_mov_b32 v67, v65
    s_nop 1
    v_permlane16_swap_b32 v66, v64
    v_permlane16_swap_b32 v67, v65
    s_nop 1
    v_add_f32 v64, v64, v66
    v_add_f32 v65, v65, v67
    v_mov_b32 v66, v64
    v_mov_b32 v67, v65
    s_nop 1
    v_permlane32_swap_b32 v66, v64
    v_permlane32_swap_b32 v67, v65
    s_nop 1
    v_add_f32 v64, v64, v66
    v_add_f32 v65, v65, v67
    v_and_b32 v66, 7, v0
    v_mul_u32_u24 v66, 32, v66
    v_lshrrev_b32 v67, 6, v0
    v_lshl_add_u32 v67, v67, 3, v66
    ds_write_b64 v67, v[64:65] offset:0
    s_waitcnt lgkmcnt(0)
    s_barrier
    ds_read_b128 v[68:71], v66 offset:0
    ds_read_b128 v[72:75], v66 offset:16
    s_waitcnt lgkmcnt(0)
    v_add_f32 v64, v68, v70
    v_add_f32 v65, v69, v71
    v_add_f32 v64, v64, v72
    v_add_f32 v65, v65, v73
    v_add_f32 v64, v64, v74
    v_add_f32 v65, v65, v75
    v_mul_f32 v64, 0x3b000000, v64
    v_mul_f32 v65, 0x3b000000, v65
    v_fma_f32 v65, -v64, v64, v65
    v_max_f32 v65, 0, v65
    v_add_f32 v65, 0x3727c5ac, v65
    v_rsq_f32 v65, v65
    v_sub_f32 v80, v80, v64
    v_mul_f32 v32, v32, v65
    v_fma_f32 v80, v80, v32, v48
    v_sub_f32 v81, v81, v64
    v_mul_f32 v33, v33, v65
    v_fma_f32 v81, v81, v33, v49
    v_sub_f32 v82, v82, v64
    v_mul_f32 v34, v34, v65
    v_fma_f32 v82, v82, v34, v50
    v_sub_f32 v83, v83, v64
    v_mul_f32 v35, v35, v65
    v_fma_f32 v83, v83, v35, v51
    v_sub_f32 v84, v84, v64
    v_mul_f32 v36, v36, v65
    v_fma_f32 v84, v84, v36, v52
    v_sub_f32 v85, v85, v64
    v_mul_f32 v37, v37, v65
    v_fma_f32 v85, v85, v37, v53
    v_sub_f32 v86, v86, v64
    v_mul_f32 v38, v38, v65
    v_fma_f32 v86, v86, v38, v54
    v_sub_f32 v87, v87, v64
    v_mul_f32 v39, v39, v65
    v_fma_f32 v87, v87, v39, v55
    v_sub_f32 v88, v88, v64
    v_mul_f32 v40, v40, v65
    v_fma_f32 v88, v88, v40, v56
    v_sub_f32 v89, v89, v64
    v_mul_f32 v41, v41, v65
    v_fma_f32 v89, v89, v41, v57
    v_sub_f32 v90, v90, v64
    v_mul_f32 v42, v42, v65
    v_fma_f32 v90, v90, v42, v58
    v_sub_f32 v91, v91, v64
    v_mul_f32 v43, v43, v65
    v_fma_f32 v91, v91, v43, v59
    v_sub_f32 v92, v92, v64
    v_mul_f32 v44, v44, v65
    v_fma_f32 v92, v92, v44, v60
    v_sub_f32 v93, v93, v64
    v_mul_f32 v45, v45, v65
    v_fma_f32 v93, v93, v45, v61
    v_sub_f32 v94, v94, v64
    v_mul_f32 v46, v46, v65
    v_fma_f32 v94, v94, v46, v62
    v_sub_f32 v95, v95, v64
    v_mul_f32 v47, v47, v65
    v_fma_f32 v95, v95, v47, v63
    v_cvt_pk_bf16_f32 v24, v80, v81
    v_cvt_pk_bf16_f32 v25, v82, v83
    v_cvt_pk_bf16_f32 v26, v84, v85
    v_cvt_pk_bf16_f32 v27, v86, v87
    v_cvt_pk_bf16_f32 v28, v88, v89
    v_cvt_pk_bf16_f32 v29, v90, v91
    v_cvt_pk_bf16_f32 v30, v92, v93
    v_cvt_pk_bf16_f32 v31, v94, v95
    buffer_store_dwordx4 v[24:27], v5, s[28:31], s33 offen sc0 sc1
    buffer_store_dwordx4 v[28:31], v6, s[28:31], s33 offen sc0 sc1
ln2_end:
    s_endpgm
.text
.globl gu_kernel
.p2align 8
.type gu_kernel,@function
gu_kernel:
    s_load_dwordx4 s[8:11], s[0:1], 56
    s_load_dwordx2 s[6:7], s[0:1], 112
    s_cmp_ge_u32 s2, 224
    s_cbranch_scc1 gu_end
    s_and_b32 s34, s2, 7
    s_lshr_b32 s35, s2, 3
    v_and_b32 v1, 63, v0
    v_lshrrev_b32 v2, 6, v0
    s_nop 0
    v_readfirstlane_b32 s40, v2
    v_lshrrev_b32 v8, 3, v1
    v_and_b32 v9, 7, v1
    v_bfe_u32 v10, v1, 4, 1
    v_lshrrev_b32 v11, 2, v9
    v_xor_b32 v10, v10, v11
    v_and_b32 v9, 3, v9
    v_mul_u32_u24 v8, 3584, v8
    v_lshl_add_u32 v8, v10, 6, v8
    v_lshl_add_u32 v8, v9, 4, v8
    s_lshr_b32 s41, s40, 1
    s_and_b32 s42, s40, 1
    v_lshrrev_b32 v4, 5, v1
    v_lshlrev_b32 v4, 9, v4
    v_bfe_u32 v5, v1, 2, 2
    v_lshl_add_u32 v4, v5, 7, v4
    v_bfe_u32 v5, v1, 4, 1
    v_lshl_add_u32 v4, v5, 5, v4
    v_and_b32 v5, 3, v1
    v_lshl_add_u32 v4, v5, 3, v4
    v_bfe_u32 v5, v1, 3, 1
    v_lshl_add_u32 v4, v5, 6, v4
    v_lshlrev_b32 v1, 4, v1
    s_mul_i32 s43, s41, 4096
    s_add_u32 s43, s43, 0
    v_add_u32 v2, s43, v1
    v_add_u32 v3, 0x10000, v2
    v_add_u32 v4, 0, v4
    v_xor_b32 v6, 64, v4
    v_add_u32 v5, 0x10000, v4
    v_add_u32 v7, 0x10000, v6
    s_mul_i32 s44, s40, 2048
    s_mul_i32 s45, s40, 1024
    s_add_u32 s45, s45, 16384
    s_add_u32 s44, s44, 0
    s_lshl_b32 s43, s42, 6
    v_xor_b32 v4, s43, v4
    v_xor_b32 v5, s43, v5
    s_waitcnt lgkmcnt(0)
    s_cmp_ge_u32 s40, 4
    s_cselect_b32 s8, s10, s8
    s_cselect_b32 s9, s11, s9
    s_add_u32 s12, s6, 5242880
    s_addc_u32 s13, s7, 0
    s_mov_b32 s14, 2097152
    s_mov_b32 s15, 0x00020000
    s_mov_b32 s16, s8
    s_mov_b32 s17, s9
    s_mov_b32 s18, 1835008
    s_mov_b32 s19, 0x00020000
    s_add_u32 s20, s6, 9437184
    s_addc_u32 s21, s7, 0
    s_mov_b32 s22, 7340032
    s_mov_b32 s23, 0x00020000
    s_lshl_b32 s46, s34, 3
    s_add_u32 s46, s46, s40
    s_lshl_b32 s46, s46, 15
    s_and_b32 s47, s40, 3
    s_mul_i32 s47, s47, 28672
    s_lshl_b32 s36, s35, 7
    s_add_u32 s47, s47, s36
    s_mov_b32 s64, 0
    s_mov_b32 s62, s46
    s_mov_b32 s63, s47
    s_add_u32 s60, s46, 32768
    s_add_u32 s61, s47, 1835008
    s_mul_i32 s65, s64, 2048
    s_add_u32 s46, s46, s65
    s_mul_i32 s65, s64, 114688
    s_add_u32 s47, s47, s65
    s_add_u32 m0, s44, 0
    s_nop 0
    buffer_load_dwordx4 v1, s[12:15], s46 offen offset:0 lds
    buffer_load_dwordx4 v1, s[12:15], s46 offen offset:1024 lds
    s_add_u32 s46, s46, 2048
    s_cmp_eq_u32 s46, s60
    s_cselect_b32 s46, s62, s46
    s_add_u32 m0, s45, 0
    s_nop 0
    buffer_load_dwordx4 v8, s[16:19], s47 offen offset:0 lds
    s_add_u32 s47, s47, 114688
    s_cmp_eq_u32 s47, s61
    s_cselect_b32 s47, s63, s47
    s_add_u32 m0, s44, 24576
    s_nop 0
    buffer_load_dwordx4 v1, s[12:15], s46 offen offset:0 lds
    buffer_load_dwordx4 v1, s[12:15], s46 offen offset:1024 lds
    s_add_u32 s46, s46, 2048
    s_cmp_eq_u32 s46, s60
    s_cselect_b32 s46, s62, s46
    s_add_u32 m0, s45, 24576
    s_nop 0
    buffer_load_dwordx4 v8, s[16:19], s47 offen offset:0 lds
    s_add_u32 s47, s47, 114688
    s_cmp_eq_u32 s47, s61
    s_cselect_b32 s47, s63, s47
    s_add_u32 m0, s44, 49152
    s_nop 0
    buffer_load_dwordx4 v1, s[12:15], s46 offen offset:0 lds
    buffer_load_dwordx4 v1, s[12:15], s46 offen offset:1024 lds
    s_add_u32 s46, s46, 2048
    s_cmp_eq_u32 s46, s60
    s_cselect_b32 s46, s62, s46
    s_add_u32 m0, s45, 49152
    s_nop 0
    buffer_load_dwordx4 v8, s[16:19], s47 offen offset:0 lds
    s_add_u32 s47, s47, 114688
    s_cmp_eq_u32 s47, s61
    s_cselect_b32 s47, s63, s47
    s_add_u32 m0, s44, 73728
    s_nop 0
    buffer_load_dwordx4 v1, s[12:15], s46 offen offset:0 lds
    buffer_load_dwordx4 v1, s[12:15], s46 offen offset:1024 lds
    s_add_u32 s46, s46, 2048
    s_cmp_eq_u32 s46, s60
    s_cselect_b32 s46, s62, s46
    s_add_u32 m0, s45, 73728
    s_nop 0
    buffer_load_dwordx4 v8, s[16:19], s47 offen offset:0 lds
    s_add_u32 s47, s47, 114688
    s_cmp_eq_u32 s47, s61
    s_cselect_b32 s47, s63, s47
    s_add_u32 m0, s44, 98304
    s_nop 0
    buffer_load_dwordx4 v1, s[12:15], s46 offen offset:0 lds
    buffer_load_dwordx4 v1, s[12:15], s46 offen offset:1024 lds
    s_add_u32 s46, s46, 2048
    s_cmp_eq_u32 s46, s60
    s_cselect_b32 s46, s62, s46
    s_add_u32 m0, s45, 98304
    s_nop 0
    buffer_load_dwordx4 v8, s[16:19], s47 offen offset:0 lds
    s_add_u32 s47, s47, 114688
    s_cmp_eq_u32 s47, s61
    s_cselect_b32 s47, s63, s47
    s_lshl_b32 s36, s34, 3
    s_lshl_b32 s37, s41, 1
    s_add_u32 s36, s36, s37
    s_mul_i32 s36, s36, 114688
    s_lshl_b32 s37, s35, 12
    s_add_u32 s36, s36, s37
    s_lshl_b32 s37, s42, 11
    s_add_u32 s36, s36, s37
    s_waitcnt vmcnt(12)
    s_barrier
    ds_read_b64_tr_b16 v[20:21], v4 offset:16384
    ds_read_b64_tr_b16 v[22:23], v4 offset:17408
    ds_read_b128 v[12:15], v2 offset:0
    ds_read_b64_tr_b16 v[24:25], v4 offset:20480
    ds_read_b64_tr_b16 v[26:27], v4 offset:21504
    ds_read_b128 v[16:19], v2 offset:2048
    ds_read_b64_tr_b16 v[36:37], v4 offset:18432
    ds_read_b64_tr_b16 v[38:39], v4 offset:19456
    ds_read_b128 v[28:31], v2 offset:1024
    ds_read_b64_tr_b16 v[40:41], v4 offset:22528
    ds_read_b64_tr_b16 v[42:43], v4 offset:23552
    ds_read_b128 v[32:35], v2 offset:3072
    s_waitcnt lgkmcnt(6)
    v_mfma_f32_32x32x16_bf16 v[44:59], v[20:23], v[12:15], 0
    v_mfma_f32_32x32x16_bf16 v[60:75], v[24:27], v[12:15], 0
    v_mfma_f32_32x32x16_bf16 v[76:91], v[20:23], v[16:19], 0
    v_mfma_f32_32x32x16_bf16 v[92:107], v[24:27], v[16:19], 0
    s_waitcnt vmcnt(9) lgkmcnt(0)
    s_barrier
    ds_read_b64_tr_b16 v[20:21], v4 offset:40960
    ds_read_b64_tr_b16 v[22:23], v4 offset:41984
    ds_read_b128 v[12:15], v2 offset:24576
    ds_read_b64_tr_b16 v[24:25], v4 offset:45056
    ds_read_b64_tr_b16 v[26:27], v4 offset:46080
    ds_read_b128 v[16:19], v2 offset:26624
    v_mfma_f32_32x32x16_bf16 v[44:59], v[36:39], v[28:31], v[44:59]
    s_add_u32 m0, s44, 0
    s_nop 0
    buffer_load_dwordx4 v1, s[12:15], s46 offen offset:0 lds
    v_mfma_f32_32x32x16_bf16 v[60:75], v[40:43], v[28:31], v[60:75]
    buffer_load_dwordx4 v1, s[12:15], s46 offen offset:1024 lds
    s_add_u32 s46, s46, 2048
    s_cmp_eq_u32 s46, s60
    s_cselect_b32 s46, s62, s46
    v_mfma_f32_32x32x16_bf16 v[76:91], v[36:39], v[32:35], v[76:91]
    s_add_u32 m0, s45, 0
    s_nop 0
    buffer_load_dwordx4 v8, s[16:19], s47 offen offset:0 lds
    s_add_u32 s47, s47, 114688
    s_cmp_eq_u32 s47, s61
    s_cselect_b32 s47, s63, s47
    v_mfma_f32_32x32x16_bf16 v[92:107], v[40:43], v[32:35], v[92:107]
    ds_read_b64_tr_b16 v[36:37], v4 offset:43008
    ds_read_b64_tr_b16 v[38:39], v4 offset:44032
    ds_read_b128 v[28:31], v2 offset:25600
    ds_read_b64_tr_b16 v[40:41], v4 offset:47104
    ds_read_b64_tr_b16 v[42:43], v4 offset:48128
    ds_read_b128 v[32:35], v2 offset:27648
    s_waitcnt lgkmcnt(6)
    v_mfma_f32_32x32x16_bf16 v[44:59], v[20:23], v[12:15], v[44:59]
    v_mfma_f32_32x32x16_bf16 v[60:75], v[24:27], v[12:15], v[60:75]
    v_mfma_f32_32x32x16_bf16 v[76:91], v[20:23], v[16:19], v[76:91]
    v_mfma_f32_32x32x16_bf16 v[92:107], v[24:27], v[16:19], v[92:107]
    s_waitcnt vmcnt(9) lgkmcnt(0)
    s_barrier
    ds_read_b64_tr_b16 v[20:21], v5 offset:0
    ds_read_b64_tr_b16 v[22:23], v5 offset:1024
    ds_read_b128 v[12:15], v2 offset:49152
    ds_read_b64_tr_b16 v[24:25], v5 offset:4096
    ds_read_b64_tr_b16 v[26:27], v5 offset:5120
    ds_read_b128 v[16:19], v2 offset:51200
    v_mfma_f32_32x32x16_bf16 v[44:59], v[36:39], v[28:31], v[44:59]
    s_add_u32 m0, s44, 24576
    s_nop 0
    buffer_load_dwordx4 v1, s[12:15], s46 offen offset:0 lds
    v_mfma_f32_32x32x16_bf16 v[60:75], v[40:43], v[28:31], v[60:75]
    buffer_load_dwordx4 v1, s[12:15], s46 offen offset:1024 lds
    s_add_u32 s46, s46, 2048
    s_cmp_eq_u32 s46, s60
    s_cselect_b32 s46, s62, s46
    v_mfma_f32_32x32x16_bf16 v[76:91], v[36:39], v[32:35], v[76:91]
    s_add_u32 m0, s45, 24576
    s_nop 0
    buffer_load_dwordx4 v8, s[16:19], s47 offen offset:0 lds
    s_add_u32 s47, s47, 114688
    s_cmp_eq_u32 s47, s61
    s_cselect_b32 s47, s63, s47
    v_mfma_f32_32x32x16_bf16 v[92:107], v[40:43], v[32:35], v[92:107]
    ds_read_b64_tr_b16 v[36:37], v5 offset:2048
    ds_read_b64_tr_b16 v[38:39], v5 offset:3072
    ds_read_b128 v[28:31], v2 offset:50176
    ds_read_b64_tr_b16 v[40:41], v5 offset:6144
    ds_read_b64_tr_b16 v[42:43], v5 offset:7168
    ds_read_b128 v[32:35], v2 offset:52224
    s_waitcnt lgkmcnt(6)
    v_mfma_f32_32x32x16_bf16 v[44:59], v[20:23], v[12:15], v[44:59]
    v_mfma_f32_32x32x16_bf16 v[60:75], v[24:27], v[12:15], v[60:75]
    v_mfma_f32_32x32x16_bf16 v[76:91], v[20:23], v[16:19], v[76:91]
    v_mfma_f32_32x32x16_bf16 v[92:107], v[24:27], v[16:19], v[92:107]
    s_waitcnt vmcnt(9) lgkmcnt(0)
    s_barrier
    ds_read_b64_tr_b16 v[20:21], v5 offset:24576
    ds_read_b64_tr_b16 v[22:23], v5 offset:25600
    ds_read_b128 v[12:15], v3 offset:8192
    ds_read_b64_tr_b16 v[24:25], v5 offset:28672
    ds_read_b64_tr_b16 v[26:27], v5 offset:29696
    ds_read_b128 v[16:19], v3 offset:10240
    v_mfma_f32_32x32x16_bf16 v[44:59], v[36:39], v[28:31], v[44:59]
    s_add_u32 m0, s44, 49152
    s_nop 0
    buffer_load_dwordx4 v1, s[12:15], s46 offen offset:0 lds
    v_mfma_f32_32x32x16_bf16 v[60:75], v[40:43], v[28:31], v[60:75]
    buffer_load_dwordx4 v1, s[12:15], s46 offen offset:1024 lds
    s_add_u32 s46, s46, 2048
    s_cmp_eq_u32 s46, s60
    s_cselect_b32 s46, s62, s46
    v_mfma_f32_32x32x16_bf16 v[76:91], v[36:39], v[32:35], v[76:91]
    s_add_u32 m0, s45, 49152
    s_nop 0
    buffer_load_dwordx4 v8, s[16:19], s47 offen offset:0 lds
    s_add_u32 s47, s47, 114688
    s_cmp_eq_u32 s47, s61
    s_cselect_b32 s47, s63, s47
    v_mfma_f32_32x32x16_bf16 v[92:107], v[40:43], v[32:35], v[92:107]
    ds_read_b64_tr_b16 v[36:37], v5 offset:26624
    ds_read_b64_tr_b16 v[38:39], v5 offset:27648
    ds_read_b128 v[28:31], v3 offset:9216
    ds_read_b64_tr_b16 v[40:41], v5 offset:30720
    ds_read_b64_tr_b16 v[42:43], v5 offset:31744
    ds_read_b128 v[32:35], v3 offset:11264
    s_waitcnt lgkmcnt(6)
    v_mfma_f32_32x32x16_bf16 v[44:59], v[20:23], v[12:15], v[44:59]
    v_mfma_f32_32x32x16_bf16 v[60:75], v[24:27], v[12:15], v[60:75]
    v_mfma_f32_32x32x16_bf16 v[76:91], v[20:23], v[16:19], v[76:91]
    v_mfma_f32_32x32x16_bf16 v[92:107], v[24:27], v[16:19], v[92:107]
    s_waitcnt vmcnt(9) lgkmcnt(0)
    s_barrier
    ds_read_b64_tr_b16 v[20:21], v5 offset:49152
    ds_read_b64_tr_b16 v[22:23], v5 offset:50176
    ds_read_b128 v[12:15], v3 offset:32768
    ds_read_b64_tr_b16 v[24:25], v5 offset:53248
    ds_read_b64_tr_b16 v[26:27], v5 offset:54272
    ds_read_b128 v[16:19], v3 offset:34816
    v_mfma_f32_32x32x16_bf16 v[44:59], v[36:39], v[28:31], v[44:59]
    s_add_u32 m0, s44, 73728
    s_nop 0
    buffer_load_dwordx4 v1, s[12:15], s46 offen offset:0 lds
    v_mfma_f32_32x32x16_bf16 v[60:75], v[40:43], v[28:31], v[60:75]
    buffer_load_dwordx4 v1, s[12:15], s46 offen offset:1024 lds
    s_add_u32 s46, s46, 2048
    s_cmp_eq_u32 s46, s60
    s_cselect_b32 s46, s62, s46
    v_mfma_f32_32x32x16_bf16 v[76:91], v[36:39], v[32:35], v[76:91]
    s_add_u32 m0, s45, 73728
    s_nop 0
    buffer_load_dwordx4 v8, s[16:19], s47 offen offset:0 lds
    s_add_u32 s47, s47, 114688
    s_cmp_eq_u32 s47, s61
    s_cselect_b32 s47, s63, s47
    v_mfma_f32_32x32x16_bf16 v[92:107], v[40:43], v[32:35], v[92:107]
    ds_read_b64_tr_b16 v[36:37], v5 offset:51200
    ds_read_b64_tr_b16 v[38:39], v5 offset:52224
    ds_read_b128 v[28:31], v3 offset:33792
    ds_read_b64_tr_b16 v[40:41], v5 offset:55296
    ds_read_b64_tr_b16 v[42:43], v5 offset:56320
    ds_read_b128 v[32:35], v3 offset:35840
    s_waitcnt lgkmcnt(6)
    v_mfma_f32_32x32x16_bf16 v[44:59], v[20:23], v[12:15], v[44:59]
    v_mfma_f32_32x32x16_bf16 v[60:75], v[24:27], v[12:15], v[60:75]
    v_mfma_f32_32x32x16_bf16 v[76:91], v[20:23], v[16:19], v[76:91]
    v_mfma_f32_32x32x16_bf16 v[92:107], v[24:27], v[16:19], v[92:107]
    s_waitcnt vmcnt(9) lgkmcnt(0)
    s_barrier
    ds_read_b64_tr_b16 v[20:21], v4 offset:16384
    ds_read_b64_tr_b16 v[22:23], v4 offset:17408
    ds_read_b128 v[12:15], v2 offset:0
    ds_read_b64_tr_b16 v[24:25], v4 offset:20480
    ds_read_b64_tr_b16 v[26:27], v4 offset:21504
    ds_read_b128 v[16:19], v2 offset:2048
    v_mfma_f32_32x32x16_bf16 v[44:59], v[36:39], v[28:31], v[44:59]
    s_add_u32 m0, s44, 98304
    s_nop 0
    buffer_load_dwordx4 v1, s[12:15], s46 offen offset:0 lds
    v_mfma_f32_32x32x16_bf16 v[60:75], v[40:43], v[28:31], v[60:75]
    buffer_load_dwordx4 v1, s[12:15], s46 offen offset:1024 lds
    s_add_u32 s46, s46, 2048
    s_cmp_eq_u32 s46, s60
    s_cselect_b32 s46, s62, s46
    v_mfma_f32_32x32x16_bf16 v[76:91], v[36:39], v[32:35], v[76:91]
    s_add_u32 m0, s45, 98304
    s_nop 0
    buffer_load_dwordx4 v8, s[16:19], s47 offen offset:0 lds
    s_add_u32 s47, s47, 114688
    s_cmp_eq_u32 s47, s61
    s_cselect_b32 s47, s63, s47
    v_mfma_f32_32x32x16_bf16 v[92:107], v[40:43], v[32:35], v[92:107]
    ds_read_b64_tr_b16 v[36:37], v4 offset:18432
    ds_read_b64_tr_b16 v[38:39], v4 offset:19456
    ds_read_b128 v[28:31], v2 offset:1024
    ds_read_b64_tr_b16 v[40:41], v4 offset:22528
    ds_read_b64_tr_b16 v[42:43], v4 offset:23552
    ds_read_b128 v[32:35], v2 offset:3072
    s_waitcnt lgkmcnt(6)
    v_mfma_f32_32x32x16_bf16 v[44:59], v[20:23], v[12:15], v[44:59]
    v_mfma_f32_32x32x16_bf16 v[60:75], v[24:27], v[12:15], v[60:75]
    v_mfma_f32_32x32x16_bf16 v[76:91], v[20:23], v[16:19], v[76:91]
    v_mfma_f32_32x32x16_bf16 v[92:107], v[24:27], v[16:19], v[92:107]
    s_waitcnt vmcnt(9) lgkmcnt(0)
    s_barrier
    ds_read_b64_tr_b16 v[20:21], v4 offset:40960
    ds_read_b64_tr_b16 v[22:23], v4 offset:41984
    ds_read_b128 v[12:15], v2 offset:24576
    ds_read_b64_tr_b16 v[24:25], v4 offset:45056
    ds_read_b64_tr_b16 v[26:27], v4 offset:46080
    ds_read_b128 v[16:19], v2 offset:26624
    v_mfma_f32_32x32x16_bf16 v[44:59], v[36:39], v[28:31], v[44:59]
    s_add_u32 m0, s44, 0
    s_nop 0
    buffer_load_dwordx4 v1, s[12:15], s46 offen offset:0 lds
    v_mfma_f32_32x32x16_bf16 v[60:75], v[40:43], v[28:31], v[60:75]
    buffer_load_dwordx4 v1, s[12:15], s46 offen offset:1024 lds
    s_add_u32 s46, s46, 2048
    s_cmp_eq_u32 s46, s60
    s_cselect_b32 s46, s62, s46
    v_mfma_f32_32x32x16_bf16 v[76:91], v[36:39], v[32:35], v[76:91]
    s_add_u32 m0, s45, 0
    s_nop 0
    buffer_load_dwordx4 v8, s[16:19], s47 offen offset:0 lds
    s_add_u32 s47, s47, 114688
    s_cmp_eq_u32 s47, s61
    s_cselect_b32 s47, s63, s47
    v_mfma_f32_32x32x16_bf16 v[92:107], v[40:43], v[32:35], v[92:107]
    ds_read_b64_tr_b16 v[36:37], v4 offset:43008
    ds_read_b64_tr_b16 v[38:39], v4 offset:44032
    ds_read_b128 v[28:31], v2 offset:25600
    ds_read_b64_tr_b16 v[40:41], v4 offset:47104
    ds_read_b64_tr_b16 v[42:43], v4 offset:48128
    ds_read_b128 v[32:35], v2 offset:27648
    s_waitcnt lgkmcnt(6)
    v_mfma_f32_32x32x16_bf16 v[44:59], v[20:23], v[12:15], v[44:59]
    v_mfma_f32_32x32x16_bf16 v[60:75], v[24:27], v[12:15], v[60:75]
    v_mfma_f32_32x32x16_bf16 v[76:91], v[20:23], v[16:19], v[76:91]
    v_mfma_f32_32x32x16_bf16 v[92:107], v[24:27], v[16:19], v[92:107]
    s_waitcnt vmcnt(9) lgkmcnt(0)
    s_barrier
    ds_read_b64_tr_b16 v[20:21], v5 offset:0
    ds_read_b64_tr_b16 v[22:23], v5 offset:1024
    ds_read_b128 v[12:15], v2 offset:49152
    ds_read_b64_tr_b16 v[24:25], v5 offset:4096
    ds_read_b64_tr_b16 v[26:27], v5 offset:5120
    ds_read_b128 v[16:19], v2 offset:51200
    v_mfma_f32_32x32x16_bf16 v[44:59], v[36:39], v[28:31], v[44:59]
    s_add_u32 m0, s44, 24576
    s_nop 0
    buffer_load_dwordx4 v1, s[12:15], s46 offen offset:0 lds
    v_mfma_f32_32x32x16_bf16 v[60:75], v[40:43], v[28:31], v[60:75]
    buffer_load_dwordx4 v1, s[12:15], s46 offen offset:1024 lds
    s_add_u32 s46, s46, 2048
    s_cmp_eq_u32 s46, s60
    s_cselect_b32 s46, s62, s46
    v_mfma_f32_32x32x16_bf16 v[76:91], v[36:39], v[32:35], v[76:91]
    s_add_u32 m0, s45, 24576
    s_nop 0
    buffer_load_dwordx4 v8, s[16:19], s47 offen offset:0 lds
    s_add_u32 s47, s47, 114688
    s_cmp_eq_u32 s47, s61
    s_cselect_b32 s47, s63, s47
    v_mfma_f32_32x32x16_bf16 v[92:107], v[40:43], v[32:35], v[92:107]
    ds_read_b64_tr_b16 v[36:37], v5 offset:2048
    ds_read_b64_tr_b16 v[38:39], v5 offset:3072
    ds_read_b128 v[28:31], v2 offset:50176
    ds_read_b64_tr_b16 v[40:41], v5 offset:6144
    ds_read_b64_tr_b16 v[42:43], v5 offset:7168
    ds_read_b128 v[32:35], v2 offset:52224
    s_waitcnt lgkmcnt(6)
    v_mfma_f32_32x32x16_bf16 v[44:59], v[20:23], v[12:15], v[44:59]
    v_mfma_f32_32x32x16_bf16 v[60:75], v[24:27], v[12:15], v[60:75]
    v_mfma_f32_32x32x16_bf16 v[76:91], v[20:23], v[16:19], v[76:91]
    v_mfma_f32_32x32x16_bf16 v[92:107], v[24:27], v[16:19], v[92:107]
    s_waitcnt vmcnt(9) lgkmcnt(0)
    s_barrier
    ds_read_b64_tr_b16 v[20:21], v5 offset:24576
    ds_read_b64_tr_b16 v[22:23], v5 offset:25600
    ds_read_b128 v[12:15], v3 offset:8192
    ds_read_b64_tr_b16 v[24:25], v5 offset:28672
    ds_read_b64_tr_b16 v[26:27], v5 offset:29696
    ds_read_b128 v[16:19], v3 offset:10240
    v_mfma_f32_32x32x16_bf16 v[44:59], v[36:39], v[28:31], v[44:59]
    s_add_u32 m0, s44, 49152
    s_nop 0
    buffer_load_dwordx4 v1, s[12:15], s46 offen offset:0 lds
    v_mfma_f32_32x32x16_bf16 v[60:75], v[40:43], v[28:31], v[60:75]
    buffer_load_dwordx4 v1, s[12:15], s46 offen offset:1024 lds
    s_add_u32 s46, s46, 2048
    s_cmp_eq_u32 s46, s60
    s_cselect_b32 s46, s62, s46
    v_mfma_f32_32x32x16_bf16 v[76:91], v[36:39], v[32:35], v[76:91]
    s_add_u32 m0, s45, 49152
    s_nop 0
    buffer_load_dwordx4 v8, s[16:19], s47 offen offset:0 lds
    s_add_u32 s47, s47, 114688
    s_cmp_eq_u32 s47, s61
    s_cselect_b32 s47, s63, s47
    v_mfma_f32_32x32x16_bf16 v[92:107], v[40:43], v[32:35], v[92:107]
    ds_read_b64_tr_b16 v[36:37], v5 offset:26624
    ds_read_b64_tr_b16 v[38:39], v5 offset:27648
    ds_read_b128 v[28:31], v3 offset:9216
    ds_read_b64_tr_b16 v[40:41], v5 offset:30720
    ds_read_b64_tr_b16 v[42:43], v5 offset:31744
    ds_read_b128 v[32:35], v3 offset:11264
    s_waitcnt lgkmcnt(6)
    v_mfma_f32_32x32x16_bf16 v[44:59], v[20:23], v[12:15], v[44:59]
    v_mfma_f32_32x32x16_bf16 v[60:75], v[24:27], v[12:15], v[60:75]
    v_mfma_f32_32x32x16_bf16 v[76:91], v[20:23], v[16:19], v[76:91]
    v_mfma_f32_32x32x16_bf16 v[92:107], v[24:27], v[16:19], v[92:107]
    s_waitcnt vmcnt(9) lgkmcnt(0)
    s_barrier
    ds_read_b64_tr_b16 v[20:21], v5 offset:49152
    ds_read_b64_tr_b16 v[22:23], v5 offset:50176
    ds_read_b128 v[12:15], v3 offset:32768
    ds_read_b64_tr_b16 v[24:25], v5 offset:53248
    ds_read_b64_tr_b16 v[26:27], v5 offset:54272
    ds_read_b128 v[16:19], v3 offset:34816
    v_mfma_f32_32x32x16_bf16 v[44:59], v[36:39], v[28:31], v[44:59]
    s_add_u32 m0, s44, 73728
    s_nop 0
    buffer_load_dwordx4 v1, s[12:15], s46 offen offset:0 lds
    v_mfma_f32_32x32x16_bf16 v[60:75], v[40:43], v[28:31], v[60:75]
    buffer_load_dwordx4 v1, s[12:15], s46 offen offset:1024 lds
    s_add_u32 s46, s46, 2048
    s_cmp_eq_u32 s46, s60
    s_cselect_b32 s46, s62, s46
    v_mfma_f32_32x32x16_bf16 v[76:91], v[36:39], v[32:35], v[76:91]
    s_add_u32 m0, s45, 73728
    s_nop 0
    buffer_load_dwordx4 v8, s[16:19], s47 offen offset:0 lds
    s_add_u32 s47, s47, 114688
    s_cmp_eq_u32 s47, s61
    s_cselect_b32 s47, s63, s47
    v_mfma_f32_32x32x16_bf16 v[92:107], v[40:43], v[32:35], v[92:107]
    ds_read_b64_tr_b16 v[36:37], v5 offset:51200
    ds_read_b64_tr_b16 v[38:39], v5 offset:52224
    ds_read_b128 v[28:31], v3 offset:33792
    ds_read_b64_tr_b16 v[40:41], v5 offset:55296
    ds_read_b64_tr_b16 v[42:43], v5 offset:56320
    ds_read_b128 v[32:35], v3 offset:35840
    s_waitcnt lgkmcnt(6)
    v_mfma_f32_32x32x16_bf16 v[44:59], v[20:23], v[12:15], v[44:59]
    v_mfma_f32_32x32x16_bf16 v[60:75], v[24:27], v[12:15], v[60:75]
    v_mfma_f32_32x32x16_bf16 v[76:91], v[20:23], v[16:19], v[76:91]
    v_mfma_f32_32x32x16_bf16 v[92:107], v[24:27], v[16:19], v[92:107]
    s_waitcnt vmcnt(9) lgkmcnt(0)
    s_barrier
    ds_read_b64_tr_b16 v[20:21], v4 offset:16384
    ds_read_b64_tr_b16 v[22:23], v4 offset:17408
    ds_read_b128 v[12:15], v2 offset:0
    ds_read_b64_tr_b16 v[24:25], v4 offset:20480
    ds_read_b64_tr_b16 v[26:27], v4 offset:21504
    ds_read_b128 v[16:19], v2 offset:2048
    v_mfma_f32_32x32x16_bf16 v[44:59], v[36:39], v[28:31], v[44:59]
    s_add_u32 m0, s44, 98304
    s_nop 0
    buffer_load_dwordx4 v1, s[12:15], s46 offen offset:0 lds
    v_mfma_f32_32x32x16_bf16 v[60:75], v[40:43], v[28:31], v[60:75]
    buffer_load_dwordx4 v1, s[12:15], s46 offen offset:1024 lds
    s_add_u32 s46, s46, 2048
    s_cmp_eq_u32 s46, s60
    s_cselect_b32 s46, s62, s46
    v_mfma_f32_32x32x16_bf16 v[76:91], v[36:39], v[32:35], v[76:91]
    s_add_u32 m0, s45, 98304
    s_nop 0
    buffer_load_dwordx4 v8, s[16:19], s47 offen offset:0 lds
    s_add_u32 s47, s47, 114688
    s_cmp_eq_u32 s47, s61
    s_cselect_b32 s47, s63, s47
    v_mfma_f32_32x32x16_bf16 v[92:107], v[40:43], v[32:35], v[92:107]
    ds_read_b64_tr_b16 v[36:37], v4 offset:18432
    ds_read_b64_tr_b16 v[38:39], v4 offset:19456
    ds_read_b128 v[28:31], v2 offset:1024
    ds_read_b64_tr_b16 v[40:41], v4 offset:22528
    ds_read_b64_tr_b16 v[42:43], v4 offset:23552
    ds_read_b128 v[32:35], v2 offset:3072
    s_waitcnt lgkmcnt(6)
    v_mfma_f32_32x32x16_bf16 v[44:59], v[20:23], v[12:15], v[44:59]
    v_mfma_f32_32x32x16_bf16 v[60:75], v[24:27], v[12:15], v[60:75]
    v_mfma_f32_32x32x16_bf16 v[76:91], v[20:23], v[16:19], v[76:91]
    v_mfma_f32_32x32x16_bf16 v[92:107], v[24:27], v[16:19], v[92:107]
    s_waitcnt vmcnt(9) lgkmcnt(0)
    s_barrier
    ds_read_b64_tr_b16 v[20:21], v4 offset:40960
    ds_read_b64_tr_b16 v[22:23], v4 offset:41984
    ds_read_b128 v[12:15], v2 offset:24576
    ds_read_b64_tr_b16 v[24:25], v4 offset:45056
    ds_read_b64_tr_b16 v[26:27], v4 offset:46080
    ds_read_b128 v[16:19], v2 offset:26624
    v_mfma_f32_32x32x16_bf16 v[44:59], v[36:39], v[28:31], v[44:59]
    s_add_u32 m0, s44, 0
    s_nop 0
    buffer_load_dwordx4 v1, s[12:15], s46 offen offset:0 lds
    v_mfma_f32_32x32x16_bf16 v[60:75], v[40:43], v[28:31], v[60:75]
    buffer_load_dwordx4 v1, s[12:15], s46 offen offset:1024 lds
    s_add_u32 s46, s46, 2048
    s_cmp_eq_u32 s46, s60
    s_cselect_b32 s46, s62, s46
    v_mfma_f32_32x32x16_bf16 v[76:91], v[36:39], v[32:35], v[76:91]
    s_add_u32 m0, s45, 0
    s_nop 0
    buffer_load_dwordx4 v8, s[16:19], s47 offen offset:0 lds
    s_add_u32 s47, s47, 114688
    s_cmp_eq_u32 s47, s61
    s_cselect_b32 s47, s63, s47
    v_mfma_f32_32x32x16_bf16 v[92:107], v[40:43], v[32:35], v[92:107]
    ds_read_b64_tr_b16 v[36:37], v4 offset:43008
    ds_read_b64_tr_b16 v[38:39], v4 offset:44032
    ds_read_b128 v[28:31], v2 offset:25600
    ds_read_b64_tr_b16 v[40:41], v4 offset:47104
    ds_read_b64_tr_b16 v[42:43], v4 offset:48128
    ds_read_b128 v[32:35], v2 offset:27648
    s_waitcnt lgkmcnt(6)
    v_mfma_f32_32x32x16_bf16 v[44:59], v[20:23], v[12:15], v[44:59]
    v_mfma_f32_32x32x16_bf16 v[60:75], v[24:27], v[12:15], v[60:75]
    v_mfma_f32_32x32x16_bf16 v[76:91], v[20:23], v[16:19], v[76:91]
    v_mfma_f32_32x32x16_bf16 v[92:107], v[24:27], v[16:19], v[92:107]
    s_waitcnt vmcnt(9) lgkmcnt(0)
    s_barrier
    ds_read_b64_tr_b16 v[20:21], v5 offset:0
    ds_read_b64_tr_b16 v[22:23], v5 offset:1024
    ds_read_b128 v[12:15], v2 offset:49152
    ds_read_b64_tr_b16 v[24:25], v5 offset:4096
    ds_read_b64_tr_b16 v[26:27], v5 offset:5120
    ds_read_b128 v[16:19], v2 offset:51200
    v_mfma_f32_32x32x16_bf16 v[44:59], v[36:39], v[28:31], v[44:59]
    v_mfma_f32_32x32x16_bf16 v[60:75], v[40:43], v[28:31], v[60:75]
    v_mfma_f32_32x32x16_bf16 v[76:91], v[36:39], v[32:35], v[76:91]
    v_mfma_f32_32x32x16_bf16 v[92:107], v[40:43], v[32:35], v[92:107]
    ds_read_b64_tr_b16 v[36:37], v5 offset:2048
    ds_read_b64_tr_b16 v[38:39], v5 offset:3072
    ds_read_b128 v[28:31], v2 offset:50176
    ds_read_b64_tr_b16 v[40:41], v5 offset:6144
    ds_read_b64_tr_b16 v[42:43], v5 offset:7168
    ds_read_b128 v[32:35], v2 offset:52224
    s_waitcnt lgkmcnt(6)
    v_mfma_f32_32x32x16_bf16 v[44:59], v[20:23], v[12:15], v[44:59]
    v_mfma_f32_32x32x16_bf16 v[60:75], v[24:27], v[12:15], v[60:75]
    v_mfma_f32_32x32x16_bf16 v[76:91], v[20:23], v[16:19], v[76:91]
    v_mfma_f32_32x32x16_bf16 v[92:107], v[24:27], v[16:19], v[92:107]
    s_waitcnt vmcnt(6) lgkmcnt(0)
    s_barrier
    ds_read_b64_tr_b16 v[20:21], v5 offset:24576
    ds_read_b64_tr_b16 v[22:23], v5 offset:25600
    ds_read_b128 v[12:15], v3 offset:8192
    ds_read_b64_tr_b16 v[24:25], v5 offset:28672
    ds_read_b64_tr_b16 v[26:27], v5 offset:29696
    ds_read_b128 v[16:19], v3 offset:10240
    v_mfma_f32_32x32x16_bf16 v[44:59], v[36:39], v[28:31], v[44:59]
    v_mfma_f32_32x32x16_bf16 v[60:75], v[40:43], v[28:31], v[60:75]
    v_mfma_f32_32x32x16_bf16 v[76:91], v[36:39], v[32:35], v[76:91]
    v_mfma_f32_32x32x16_bf16 v[92:107], v[40:43], v[32:35], v[92:107]
    ds_read_b64_tr_b16 v[36:37], v5 offset:26624
    ds_read_b64_tr_b16 v[38:39], v5 offset:27648
    ds_read_b128 v[28:31], v3 offset:9216
    ds_read_b64_tr_b16 v[40:41], v5 offset:30720
    ds_read_b64_tr_b16 v[42:43], v5 offset:31744
    ds_read_b128 v[32:35], v3 offset:11264
    s_waitcnt lgkmcnt(6)
    v_mfma_f32_32x32x16_bf16 v[44:59], v[20:23], v[12:15], v[44:59]
    v_mfma_f32_32x32x16_bf16 v[60:75], v[24:27], v[12:15], v[60:75]
    v_mfma_f32_32x32x16_bf16 v[76:91], v[20:23], v[16:19], v[76:91]
    v_mfma_f32_32x32x16_bf16 v[92:107], v[24:27], v[16:19], v[92:107]
    s_waitcnt vmcnt(3) lgkmcnt(0)
    s_barrier
    ds_read_b64_tr_b16 v[20:21], v5 offset:49152
    ds_read_b64_tr_b16 v[22:23], v5 offset:50176
    ds_read_b128 v[12:15], v3 offset:32768
    ds_read_b64_tr_b16 v[24:25], v5 offset:53248
    ds_read_b64_tr_b16 v[26:27], v5 offset:54272
    ds_read_b128 v[16:19], v3 offset:34816
    v_mfma_f32_32x32x16_bf16 v[44:59], v[36:39], v[28:31], v[44:59]
    v_mfma_f32_32x32x16_bf16 v[60:75], v[40:43], v[28:31], v[60:75]
    v_mfma_f32_32x32x16_bf16 v[76:91], v[36:39], v[32:35], v[76:91]
    v_mfma_f32_32x32x16_bf16 v[92:107], v[40:43], v[32:35], v[92:107]
    ds_read_b64_tr_b16 v[36:37], v5 offset:51200
    ds_read_b64_tr_b16 v[38:39], v5 offset:52224
    ds_read_b128 v[28:31], v3 offset:33792
    ds_read_b64_tr_b16 v[40:41], v5 offset:55296
    ds_read_b64_tr_b16 v[42:43], v5 offset:56320
    ds_read_b128 v[32:35], v3 offset:35840
    s_waitcnt lgkmcnt(6)
    v_mfma_f32_32x32x16_bf16 v[44:59], v[20:23], v[12:15], v[44:59]
    v_mfma_f32_32x32x16_bf16 v[60:75], v[24:27], v[12:15], v[60:75]
    v_mfma_f32_32x32x16_bf16 v[76:91], v[20:23], v[16:19], v[76:91]
    v_mfma_f32_32x32x16_bf16 v[92:107], v[24:27], v[16:19], v[92:107]
    s_waitcnt vmcnt(0) lgkmcnt(0)
    s_barrier
    ds_read_b64_tr_b16 v[20:21], v4 offset:16384
    ds_read_b64_tr_b16 v[22:23], v4 offset:17408
    ds_read_b128 v[12:15], v2 offset:0
    ds_read_b64_tr_b16 v[24:25], v4 offset:20480
    ds_read_b64_tr_b16 v[26:27], v4 offset:21504
    ds_read_b128 v[16:19], v2 offset:2048
    v_mfma_f32_32x32x16_bf16 v[44:59], v[36:39], v[28:31], v[44:59]
    v_mfma_f32_32x32x16_bf16 v[60:75], v[40:43], v[28:31], v[60:75]
    v_mfma_f32_32x32x16_bf16 v[76:91], v[36:39], v[32:35], v[76:91]
    v_mfma_f32_32x32x16_bf16 v[92:107], v[40:43], v[32:35], v[92:107]
    ds_read_b64_tr_b16 v[36:37], v4 offset:18432
    ds_read_b64_tr_b16 v[38:39], v4 offset:19456
    ds_read_b128 v[28:31], v2 offset:1024
    ds_read_b64_tr_b16 v[40:41], v4 offset:22528
    ds_read_b64_tr_b16 v[42:43], v4 offset:23552
    ds_read_b128 v[32:35], v2 offset:3072
    s_waitcnt lgkmcnt(6)
    v_mfma_f32_32x32x16_bf16 v[44:59], v[20:23], v[12:15], v[44:59]
    v_mfma_f32_32x32x16_bf16 v[60:75], v[24:27], v[12:15], v[60:75]
    v_mfma_f32_32x32x16_bf16 v[76:91], v[20:23], v[16:19], v[76:91]
    v_mfma_f32_32x32x16_bf16 v[92:107], v[24:27], v[16:19], v[92:107]
    s_waitcnt lgkmcnt(0)
    v_mfma_f32_32x32x16_bf16 v[44:59], v[36:39], v[28:31], v[44:59]
    v_mfma_f32_32x32x16_bf16 v[60:75], v[40:43], v[28:31], v[60:75]
    v_mfma_f32_32x32x16_bf16 v[76:91], v[36:39], v[32:35], v[76:91]
    v_mfma_f32_32x32x16_bf16 v[92:107], v[40:43], v[32:35], v[92:107]
    s_nop 7
    s_nop 7
    v_mul_f32 v44, v44, v60
    v_mul_f32 v45, v45, v61
    v_mul_f32 v46, v46, v62
    v_mul_f32 v47, v47, v63
    v_mul_f32 v48, v48, v64
    v_mul_f32 v49, v49, v65
    v_mul_f32 v50, v50, v66
    v_mul_f32 v51, v51, v67
    v_mul_f32 v52, v52, v68
    v_mul_f32 v53, v53, v69
    v_mul_f32 v54, v54, v70
    v_mul_f32 v55, v55, v71
    v_mul_f32 v56, v56, v72
    v_mul_f32 v57, v57, v73
    v_mul_f32 v58, v58, v74
    v_mul_f32 v59, v59, v75
    v_cvt_pk_bf16_f32 v12, v44, v45
    v_cvt_pk_bf16_f32 v13, v46, v47
    v_cvt_pk_bf16_f32 v14, v48, v49
    v_cvt_pk_bf16_f32 v15, v50, v51
    v_cvt_pk_bf16_f32 v16, v52, v53
    v_cvt_pk_bf16_f32 v17, v54, v55
    v_cvt_pk_bf16_f32 v18, v56, v57
    v_cvt_pk_bf16_f32 v19, v58, v59
    buffer_store_dwordx4 v[12:15], v1, s[20:23], s36 offen sc0 sc1
    buffer_store_dwordx4 v[16:19], v1, s[20:23], s36 offen offset:1024 sc0 sc1
    s_add_u32 s36, s36, 114688
    v_mul_f32 v76, v76, v92
    v_mul_f32 v77, v77, v93
    v_mul_f32 v78, v78, v94
    v_mul_f32 v79, v79, v95
    v_mul_f32 v80, v80, v96
    v_mul_f32 v81, v81, v97
    v_mul_f32 v82, v82, v98
    v_mul_f32 v83, v83, v99
    v_mul_f32 v84, v84, v100
    v_mul_f32 v85, v85, v101
    v_mul_f32 v86, v86, v102
    v_mul_f32 v87, v87, v103
    v_mul_f32 v88, v88, v104
    v_mul_f32 v89, v89, v105
    v_mul_f32 v90, v90, v106
    v_mul_f32 v91, v91, v107
    v_cvt_pk_bf16_f32 v20, v76, v77
    v_cvt_pk_bf16_f32 v21, v78, v79
    v_cvt_pk_bf16_f32 v22, v80, v81
    v_cvt_pk_bf16_f32 v23, v82, v83
    v_cvt_pk_bf16_f32 v24, v84, v85
    v_cvt_pk_bf16_f32 v25, v86, v87
    v_cvt_pk_bf16_f32 v26, v88, v89
    v_cvt_pk_bf16_f32 v27, v90, v91
    buffer_store_dwordx4 v[20:23], v1, s[20:23], s36 offen sc0 sc1
    buffer_store_dwordx4 v[24:27], v1, s[20:23], s36 offen offset:1024 sc0 sc1
    s_add_u32 s36, s36, 114688
gu_end:
    s_endpgm
.text
.globl dn_kernel
.p2align 8
.type dn_kernel,@function
dn_kernel:
    s_load_dwordx2 s[8:9], s[0:1], 72
    s_load_dwordx2 s[6:7], s[0:1], 112
    s_load_dwordx2 s[4:5], s[0:1], 96
    s_cmp_ge_u32 s2, 256
    s_cbranch_scc1 dn_end
    s_and_b32 s34, s2, 7
    s_lshl_b32 s34, s34, 2
    s_bfe_u32 s35, s2, 0x20003
    s_add_u32 s34, s34, s35
    s_lshr_b32 s35, s2, 5
    v_and_b32 v1, 63, v0
    v_lshrrev_b32 v2, 6, v0
    s_nop 0
    v_readfirstlane_b32 s40, v2
    v_lshrrev_b32 v8, 3, v1
    v_and_b32 v9, 7, v1
    v_bfe_u32 v10, v1, 4, 1
    v_lshrrev_b32 v11, 2, v9
    v_xor_b32 v10, v10, v11
    v_and_b32 v9, 3, v9
    v_mul_u32_u24 v8, 1024, v8
    v_lshl_add_u32 v8, v10, 6, v8
    v_lshl_add_u32 v8, v9, 4, v8
    s_lshr_b32 s41, s40, 1
    s_and_b32 s42, s40, 1
    v_lshrrev_b32 v4, 5, v1
    v_lshlrev_b32 v4, 9, v4
    v_bfe_u32 v5, v1, 2, 2
    v_lshl_add_u32 v4, v5, 7, v4
    v_bfe_u32 v5, v1, 4, 1
    v_lshl_add_u32 v4, v5, 5, v4
    v_and_b32 v5, 3, v1
    v_lshl_add_u32 v4, v5, 3, v4
    v_bfe_u32 v5, v1, 3, 1
    v_lshl_add_u32 v4, v5, 6, v4
    v_lshlrev_b32 v1, 4, v1
    s_mul_i32 s43, s41, 4096
    s_add_u32 s43, s43, 0
    v_add_u32 v2, s43, v1
    v_add_u32 v3, 0x10000, v2
    v_add_u32 v4, 0, v4
    v_xor_b32 v6, 64, v4
    v_add_u32 v5, 0x10000, v4
    v_add_u32 v7, 0x10000, v6
    v_add_u32 v9, 7168, v8
    s_mul_i32 s44, s40, 2048
    s_mul_i32 s45, s40, 2048
    s_add_u32 s45, s45, 8192
    s_add_u32 s44, s44, 0
    s_lshl_b32 s43, s42, 6
    v_xor_b32 v4, s43, v4
    v_xor_b32 v5, s43, v5
    s_waitcnt lgkmcnt(0)
    s_add_u32 s12, s6, 9437184
    s_addc_u32 s13, s7, 0
    s_mov_b32 s14, 7340032
    s_mov_b32 s15, 0x00020000
    s_mov_b32 s16, s8
    s_mov_b32 s17, s9
    s_mov_b32 s18, 1835008
    s_mov_b32 s19, 0x00020000
    s_mov_b32 s20, s4
    s_mov_b32 s21, s5
    s_mov_b32 s22, 2097152
    s_mov_b32 s23, 0x00020000
    s_add_u32 s24, s6, 7340032
    s_addc_u32 s25, s7, 0
    s_mov_b32 s26, 2097152
    s_mov_b32 s27, 0x00020000
    s_mov_b32 s28, s6
    s_mov_b32 s29, s7
    s_mov_b32 s30, 12288
    s_mov_b32 s31, 0x00020000
    s_lshl_b32 s36, s34, 1
    s_add_u32 s36, s36, s41
    s_lshl_b32 s37, s35, 1
    s_add_u32 s37, s37, s42
    s_lshl_b32 s38, s36, 15
    s_lshl_b32 s39, s37, 11
    s_add_u32 s39, s38, s39
    buffer_load_dwordx4 v[92:95], v1, s[24:27], s39 offen
    buffer_load_dwordx4 v[96:99], v1, s[24:27], s39 offen offset:1024
    v_lshrrev_b32 v10, 9, v1
    v_lshlrev_b32 v10, 4, v10
    s_lshl_b32 s39, s37, 7
    s_add_u32 s39, s39, 10240
    buffer_load_dwordx4 v[100:103], v10, s[28:31], s39 offen offset:0
    buffer_load_dwordx4 v[104:107], v10, s[28:31], s39 offen offset:32
    buffer_load_dwordx4 v[108:111], v10, s[28:31], s39 offen offset:64
    buffer_load_dwordx4 v[112:115], v10, s[28:31], s39 offen offset:96
    v_and_b32 v11, 0x1f0, v1
    v_lshl_add_u32 v10, v11, 6, v10
    s_lshl_b32 s37, s37, 6
    s_add_u32 s38, s38, s37
    s_mul_i32 s46, s36, 114688
    s_lshl_b32 s37, s42, 11
    s_add_u32 s46, s46, s37
    s_lshl_b32 s47, s40, 14
    s_lshl_b32 s37, s35, 7
    s_add_u32 s47, s47, s37
    s_lshr_b32 s64, s2, 3
    s_lshr_b32 s65, s2, 5
    s_add_u32 s64, s64, s65
    s_and_b32 s64, s64, 1
    s_mul_i32 s64, s64, 14
    s_mov_b32 s62, s46
    s_mov_b32 s63, s47
    s_add_u32 s60, s46, 114688
    s_add_u32 s61, s47, 1835008
    s_mul_i32 s65, s64, 4096
    s_add_u32 s46, s46, s65
    s_mul_i32 s65, s64, 65536
    s_add_u32 s47, s47, s65
    s_add_u32 m0, s44, 0
    s_nop 0
    buffer_load_dwordx4 v1, s[12:15], s46 offen offset:0 lds
    buffer_load_dwordx4 v1, s[12:15], s46 offen offset:1024 lds
    s_add_u32 s46, s46, 4096
    s_cmp_eq_u32 s46, s60
    s_cselect_b32 s46, s62, s46
    s_add_u32 m0, s45, 0
    s_nop 0
    buffer_load_dwordx4 v8, s[16:19], s47 offen offset:0 lds
    buffer_load_dwordx4 v9, s[16:19], s47 offen offset:1024 lds
    s_add_u32 s47, s47, 65536
    s_cmp_eq_u32 s47, s61
    s_cselect_b32 s47, s63, s47
    s_add_u32 m0, s44, 16384
    s_nop 0
    buffer_load_dwordx4 v1, s[12:15], s46 offen offset:0 lds
    buffer_load_dwordx4 v1, s[12:15], s46 offen offset:1024 lds
    s_add_u32 s46, s46, 4096
    s_cmp_eq_u32 s46, s60
    s_cselect_b32 s46, s62, s46
    s_add_u32 m0, s45, 16384
    s_nop 0
    buffer_load_dwordx4 v8, s[16:19], s47 offen offset:0 lds
    buffer_load_dwordx4 v9, s[16:19], s47 offen offset:1024 lds
    s_add_u32 s47, s47, 65536
    s_cmp_eq_u32 s47, s61
    s_cselect_b32 s47, s63, s47
    s_add_u32 m0, s44, 32768
    s_nop 0
    buffer_load_dwordx4 v1, s[12:15], s46 offen offset:0 lds
    buffer_load_dwordx4 v1, s[12:15], s46 offen offset:1024 lds
    s_add_u32 s46, s46, 4096
    s_cmp_eq_u32 s46, s60
    s_cselect_b32 s46, s62, s46
    s_add_u32 m0, s45, 32768
    s_nop 0
    buffer_load_dwordx4 v8, s[16:19], s47 offen offset:0 lds
    buffer_load_dwordx4 v9, s[16:19], s47 offen offset:1024 lds
    s_add_u32 s47, s47, 65536
    s_cmp_eq_u32 s47, s61
    s_cselect_b32 s47, s63, s47
    s_add_u32 m0, s44, 49152
    s_nop 0
    buffer_load_dwordx4 v1, s[12:15], s46 offen offset:0 lds
    buffer_load_dwordx4 v1, s[12:15], s46 offen offset:1024 lds
    s_add_u32 s46, s46, 4096
    s_cmp_eq_u32 s46, s60
    s_cselect_b32 s46, s62, s46
    s_add_u32 m0, s45, 49152
    s_nop 0
    buffer_load_dwordx4 v8, s[16:19], s47 offen offset:0 lds
    buffer_load_dwordx4 v9, s[16:19], s47 offen offset:1024 lds
    s_add_u32 s47, s47, 65536
    s_cmp_eq_u32 s47, s61
    s_cselect_b32 s47, s63, s47
    s_add_u32 m0, s44, 65536
    s_nop 0
    buffer_load_dwordx4 v1, s[12:15], s46 offen offset:0 lds
    buffer_load_dwordx4 v1, s[12:15], s46 offen offset:1024 lds
    s_add_u32 s46, s46, 4096
    s_cmp_eq_u32 s46, s60
    s_cselect_b32 s46, s62, s46
    s_add_u32 m0, s45, 65536
    s_nop 0
    buffer_load_dwordx4 v8, s[16:19], s47 offen offset:0 lds
    buffer_load_dwordx4 v9, s[16:19], s47 offen offset:1024 lds
    s_add_u32 s47, s47, 65536
    s_cmp_eq_u32 s47, s61
    s_cselect_b32 s47, s63, s47
    s_add_u32 m0, s44, 81920
    s_nop 0
    buffer_load_dwordx4 v1, s[12:15], s46 offen offset:0 lds
    buffer_load_dwordx4 v1, s[12:15], s46 offen offset:1024 lds
    s_add_u32 s46, s46, 4096
    s_cmp_eq_u32 s46, s60
    s_cselect_b32 s46, s62, s46
    s_add_u32 m0, s45, 81920
    s_nop 0
    buffer_load_dwordx4 v8, s[16:19], s47 offen offset:0 lds
    buffer_load_dwordx4 v9, s[16:19], s47 offen offset:1024 lds
    s_add_u32 s47, s47, 65536
    s_cmp_eq_u32 s47, s61
    s_cselect_b32 s47, s63, s47
    s_add_u32 m0, s44, 98304
    s_nop 0
    buffer_load_dwordx4 v1, s[12:15], s46 offen offset:0 lds
    buffer_load_dwordx4 v1, s[12:15], s46 offen offset:1024 lds
    s_add_u32 s46, s46, 4096
    s_cmp_eq_u32 s46, s60
    s_cselect_b32 s46, s62, s46
    s_add_u32 m0, s45, 98304
    s_nop 0
    buffer_load_dwordx4 v8, s[16:19], s47 offen offset:0 lds
    buffer_load_dwordx4 v9, s[16:19], s47 offen offset:1024 lds
    s_add_u32 s47, s47, 65536
    s_cmp_eq_u32 s47, s61
    s_cselect_b32 s47, s63, s47
    s_waitcnt vmcnt(24)
    s_barrier
    ds_read_b64_tr_b16 v[16:17], v4 offset:8192
    ds_read_b64_tr_b16 v[18:19], v4 offset:9216
    ds_read_b128 v[12:15], v2 offset:0
    ds_read_b64_tr_b16 v[24:25], v4 offset:10240
    ds_read_b64_tr_b16 v[26:27], v4 offset:11264
    ds_read_b128 v[20:23], v2 offset:1024
    ds_read_b64_tr_b16 v[32:33], v4 offset:12288
    ds_read_b64_tr_b16 v[34:35], v4 offset:13312
    ds_read_b128 v[28:31], v2 offset:2048
    ds_read_b64_tr_b16 v[40:41], v4 offset:14336
    ds_read_b64_tr_b16 v[42:43], v4 offset:15360
    ds_read_b128 v[36:39], v2 offset:3072
    s_waitcnt vmcnt(20) lgkmcnt(0)
    s_barrier
    ds_read_b64_tr_b16 v[48:49], v4 offset:24576
    ds_read_b64_tr_b16 v[50:51], v4 offset:25600
    ds_read_b128 v[44:47], v2 offset:16384
    ds_read_b64_tr_b16 v[56:57], v4 offset:26624
    ds_read_b64_tr_b16 v[58:59], v4 offset:27648
    ds_read_b128 v[52:55], v2 offset:17408
    ds_read_b64_tr_b16 v[64:65], v4 offset:28672
    ds_read_b64_tr_b16 v[66:67], v4 offset:29696
    ds_read_b128 v[60:63], v2 offset:18432
    ds_read_b64_tr_b16 v[72:73], v4 offset:30720
    ds_read_b64_tr_b16 v[74:75], v4 offset:31744
    ds_read_b128 v[68:71], v2 offset:19456
    v_mfma_f32_32x32x16_bf16 v[76:91], v[16:19], v[12:15], 0
    s_add_u32 m0, s44, 0
    s_nop 0
    buffer_load_dwordx4 v1, s[12:15], s46 offen offset:0 lds
    v_mfma_f32_32x32x16_bf16 v[76:91], v[24:27], v[20:23], v[76:91]
    buffer_load_dwordx4 v1, s[12:15], s46 offen offset:1024 lds
    s_add_u32 s46, s46, 4096
    s_cmp_eq_u32 s46, s60
    s_cselect_b32 s46, s62, s46
    v_mfma_f32_32x32x16_bf16 v[76:91], v[32:35], v[28:31], v[76:91]
    s_add_u32 m0, s45, 0
    s_nop 0
    buffer_load_dwordx4 v8, s[16:19], s47 offen offset:0 lds
    v_mfma_f32_32x32x16_bf16 v[76:91], v[40:43], v[36:39], v[76:91]
    buffer_load_dwordx4 v9, s[16:19], s47 offen offset:1024 lds
    s_add_u32 s47, s47, 65536
    s_cmp_eq_u32 s47, s61
    s_cselect_b32 s47, s63, s47
    s_waitcnt vmcnt(20) lgkmcnt(0)
    s_barrier
    ds_read_b64_tr_b16 v[16:17], v4 offset:40960
    ds_read_b64_tr_b16 v[18:19], v4 offset:41984
    ds_read_b128 v[12:15], v2 offset:32768
    ds_read_b64_tr_b16 v[24:25], v4 offset:43008
    ds_read_b64_tr_b16 v[26:27], v4 offset:44032
    ds_read_b128 v[20:23], v2 offset:33792
    ds_read_b64_tr_b16 v[32:33], v4 offset:45056
    ds_read_b64_tr_b16 v[34:35], v4 offset:46080
    ds_read_b128 v[28:31], v2 offset:34816
    ds_read_b64_tr_b16 v[40:41], v4 offset:47104
    ds_read_b64_tr_b16 v[42:43], v4 offset:48128
    ds_read_b128 v[36:39], v2 offset:35840
    v_mfma_f32_32x32x16_bf16 v[76:91], v[48:51], v[44:47], v[76:91]
    s_add_u32 m0, s44, 16384
    s_nop 0
    buffer_load_dwordx4 v1, s[12:15], s46 offen offset:0 lds
    v_mfma_f32_32x32x16_bf16 v[76:91], v[56:59], v[52:55], v[76:91]
    buffer_load_dwordx4 v1, s[12:15], s46 offen offset:1024 lds
    s_add_u32 s46, s46, 4096
    s_cmp_eq_u32 s46, s60
    s_cselect_b32 s46, s62, s46
    v_mfma_f32_32x32x16_bf16 v[76:91], v[64:67], v[60:63], v[76:91]
    s_add_u32 m0, s45, 16384
    s_nop 0
    buffer_load_dwordx4 v8, s[16:19], s47 offen offset:0 lds
    v_mfma_f32_32x32x16_bf16 v[76:91], v[72:75], v[68:71], v[76:91]
    buffer_load_dwordx4 v9, s[16:19], s47 offen offset:1024 lds
    s_add_u32 s47, s47, 65536
    s_cmp_eq_u32 s47, s61
    s_cselect_b32 s47, s63, s47
    s_waitcnt vmcnt(20) lgkmcnt(0)
    s_barrier
    ds_read_b64_tr_b16 v[48:49], v4 offset:57344
    ds_read_b64_tr_b16 v[50:51], v4 offset:58368
    ds_read_b128 v[44:47], v2 offset:49152
    ds_read_b64_tr_b16 v[56:57], v4 offset:59392
    ds_read_b64_tr_b16 v[58:59], v4 offset:60416
    ds_read_b128 v[52:55], v2 offset:50176
    ds_read_b64_tr_b16 v[64:65], v4 offset:61440
    ds_read_b64_tr_b16 v[66:67], v4 offset:62464
    ds_read_b128 v[60:63], v2 offset:51200
    ds_read_b64_tr_b16 v[72:73], v4 offset:63488
    ds_read_b64_tr_b16 v[74:75], v4 offset:64512
    ds_read_b128 v[68:71], v2 offset:52224
    v_mfma_f32_32x32x16_bf16 v[76:91], v[16:19], v[12:15], v[76:91]
    s_add_u32 m0, s44, 32768
    s_nop 0
    buffer_load_dwordx4 v1, s[12:15], s46 offen offset:0 lds
    v_mfma_f32_32x32x16_bf16 v[76:91], v[24:27], v[20:23], v[76:91]
    buffer_load_dwordx4 v1, s[12:15], s46 offen offset:1024 lds
    s_add_u32 s46, s46, 4096
    s_cmp_eq_u32 s46, s60
    s_cselect_b32 s46, s62, s46
    v_mfma_f32_32x32x16_bf16 v[76:91], v[32:35], v[28:31], v[76:91]
    s_add_u32 m0, s45, 32768
    s_nop 0
    buffer_load_dwordx4 v8, s[16:19], s47 offen offset:0 lds
    v_mfma_f32_32x32x16_bf16 v[76:91], v[40:43], v[36:39], v[76:91]
    buffer_load_dwordx4 v9, s[16:19], s47 offen offset:1024 lds
    s_add_u32 s47, s47, 65536
    s_cmp_eq_u32 s47, s61
    s_cselect_b32 s47, s63, s47
    s_waitcnt vmcnt(20) lgkmcnt(0)
    s_barrier
    ds_read_b64_tr_b16 v[16:17], v5 offset:8192
    ds_read_b64_tr_b16 v[18:19], v5 offset:9216
    ds_read_b128 v[12:15], v3 offset:0
    ds_read_b64_tr_b16 v[24:25], v5 offset:10240
    ds_read_b64_tr_b16 v[26:27], v5 offset:11264
    ds_read_b128 v[20:23], v3 offset:1024
    ds_read_b64_tr_b16 v[32:33], v5 offset:12288
    ds_read_b64_tr_b16 v[34:35], v5 offset:13312
    ds_read_b128 v[28:31], v3 offset:2048
    ds_read_b64_tr_b16 v[40:41], v5 offset:14336
    ds_read_b64_tr_b16 v[42:43], v5 offset:15360
    ds_read_b128 v[36:39], v3 offset:3072
    v_mfma_f32_32x32x16_bf16 v[76:91], v[48:51], v[44:47], v[76:91]
    s_add_u32 m0, s44, 49152
    s_nop 0
    buffer_load_dwordx4 v1, s[12:15], s46 offen offset:0 lds
    v_mfma_f32_32x32x16_bf16 v[76:91], v[56:59], v[52:55], v[76:91]
    buffer_load_dwordx4 v1, s[12:15], s46 offen offset:1024 lds
    s_add_u32 s46, s46, 4096
    s_cmp_eq_u32 s46, s60
    s_cselect_b32 s46, s62, s46
    v_mfma_f32_32x32x16_bf16 v[76:91], v[64:67], v[60:63], v[76:91]
    s_add_u32 m0, s45, 49152
    s_nop 0
    buffer_load_dwordx4 v8, s[16:19], s47 offen offset:0 lds
    v_mfma_f32_32x32x16_bf16 v[76:91], v[72:75], v[68:71], v[76:91]
    buffer_load_dwordx4 v9, s[16:19], s47 offen offset:1024 lds
    s_add_u32 s47, s47, 65536
    s_cmp_eq_u32 s47, s61
    s_cselect_b32 s47, s63, s47
    s_waitcnt vmcnt(20) lgkmcnt(0)
    s_barrier
    ds_read_b64_tr_b16 v[48:49], v5 offset:24576
    ds_read_b64_tr_b16 v[50:51], v5 offset:25600
    ds_read_b128 v[44:47], v3 offset:16384
    ds_read_b64_tr_b16 v[56:57], v5 offset:26624
    ds_read_b64_tr_b16 v[58:59], v5 offset:27648
    ds_read_b128 v[52:55], v3 offset:17408
    ds_read_b64_tr_b16 v[64:65], v5 offset:28672
    ds_read_b64_tr_b16 v[66:67], v5 offset:29696
    ds_read_b128 v[60:63], v3 offset:18432
    ds_read_b64_tr_b16 v[72:73], v5 offset:30720
    ds_read_b64_tr_b16 v[74:75], v5 offset:31744
    ds_read_b128 v[68:71], v3 offset:19456
    v_mfma_f32_32x32x16_bf16 v[76:91], v[16:19], v[12:15], v[76:91]
    s_add_u32 m0, s44, 65536
    s_nop 0
    buffer_load_dwordx4 v1, s[12:15], s46 offen offset:0 lds
    v_mfma_f32_32x32x16_bf16 v[76:91], v[24:27], v[20:23], v[76:91]
    buffer_load_dwordx4 v1, s[12:15], s46 offen offset:1024 lds
    s_add_u32 s46, s46, 4096
    s_cmp_eq_u32 s46, s60
    s_cselect_b32 s46, s62, s46
    v_mfma_f32_32x32x16_bf16 v[76:91], v[32:35], v[28:31], v[76:91]
    s_add_u32 m0, s45, 65536
    s_nop 0
    buffer_load_dwordx4 v8, s[16:19], s47 offen offset:0 lds
    v_mfma_f32_32x32x16_bf16 v[76:91], v[40:43], v[36:39], v[76:91]
    buffer_load_dwordx4 v9, s[16:19], s47 offen offset:1024 lds
    s_add_u32 s47, s47, 65536
    s_cmp_eq_u32 s47, s61
    s_cselect_b32 s47, s63, s47
    s_waitcnt vmcnt(20) lgkmcnt(0)
    s_barrier
    ds_read_b64_tr_b16 v[16:17], v5 offset:40960
    ds_read_b64_tr_b16 v[18:19], v5 offset:41984
    ds_read_b128 v[12:15], v3 offset:32768
    ds_read_b64_tr_b16 v[24:25], v5 offset:43008
    ds_read_b64_tr_b16 v[26:27], v5 offset:44032
    ds_read_b128 v[20:23], v3 offset:33792
    ds_read_b64_tr_b16 v[32:33], v5 offset:45056
    ds_read_b64_tr_b16 v[34:35], v5 offset:46080
    ds_read_b128 v[28:31], v3 offset:34816
    ds_read_b64_tr_b16 v[40:41], v5 offset:47104
    ds_read_b64_tr_b16 v[42:43], v5 offset:48128
    ds_read_b128 v[36:39], v3 offset:35840
    v_mfma_f32_32x32x16_bf16 v[76:91], v[48:51], v[44:47], v[76:91]
    s_add_u32 m0, s44, 81920
    s_nop 0
    buffer_load_dwordx4 v1, s[12:15], s46 offen offset:0 lds
    v_mfma_f32_32x32x16_bf16 v[76:91], v[56:59], v[52:55], v[76:91]
    buffer_load_dwordx4 v1, s[12:15], s46 offen offset:1024 lds
    s_add_u32 s46, s46, 4096
    s_cmp_eq_u32 s46, s60
    s_cselect_b32 s46, s62, s46
    v_mfma_f32_32x32x16_bf16 v[76:91], v[64:67], v[60:63], v[76:91]
    s_add_u32 m0, s45, 81920
    s_nop 0
    buffer_load_dwordx4 v8, s[16:19], s47 offen offset:0 lds
    v_mfma_f32_32x32x16_bf16 v[76:91], v[72:75], v[68:71], v[76:91]
    buffer_load_dwordx4 v9, s[16:19], s47 offen offset:1024 lds
    s_add_u32 s47, s47, 65536
    s_cmp_eq_u32 s47, s61
    s_cselect_b32 s47, s63, s47
    s_waitcnt vmcnt(20) lgkmcnt(0)
    s_barrier
    ds_read_b64_tr_b16 v[48:49], v4 offset:8192
    ds_read_b64_tr_b16 v[50:51], v4 offset:9216
    ds_read_b128 v[44:47], v2 offset:0
    ds_read_b64_tr_b16 v[56:57], v4 offset:10240
    ds_read_b64_tr_b16 v[58:59], v4 offset:11264
    ds_read_b128 v[52:55], v2 offset:1024
    ds_read_b64_tr_b16 v[64:65], v4 offset:12288
    ds_read_b64_tr_b16 v[66:67], v4 offset:13312
    ds_read_b128 v[60:63], v2 offset:2048
    ds_read_b64_tr_b16 v[72:73], v4 offset:14336
    ds_read_b64_tr_b16 v[74:75], v4 offset:15360
    ds_read_b128 v[68:71], v2 offset:3072
    v_mfma_f32_32x32x16_bf16 v[76:91], v[16:19], v[12:15], v[76:91]
    s_add_u32 m0, s44, 98304
    s_nop 0
    buffer_load_dwordx4 v1, s[12:15], s46 offen offset:0 lds
    v_mfma_f32_32x32x16_bf16 v[76:91], v[24:27], v[20:23], v[76:91]
    buffer_load_dwordx4 v1, s[12:15], s46 offen offset:1024 lds
    s_add_u32 s46, s46, 4096
    s_cmp_eq_u32 s46, s60
    s_cselect_b32 s46, s62, s46
    v_mfma_f32_32x32x16_bf16 v[76:91], v[32:35], v[28:31], v[76:91]
    s_add_u32 m0, s45, 98304
    s_nop 0
    buffer_load_dwordx4 v8, s[16:19], s47 offen offset:0 lds
    v_mfma_f32_32x32x16_bf16 v[76:91], v[40:43], v[36:39], v[76:91]
    buffer_load_dwordx4 v9, s[16:19], s47 offen offset:1024 lds
    s_add_u32 s47, s47, 65536
    s_cmp_eq_u32 s47, s61
    s_cselect_b32 s47, s63, s47
    s_waitcnt vmcnt(20) lgkmcnt(0)
    s_barrier
    ds_read_b64_tr_b16 v[16:17], v4 offset:24576
    ds_read_b64_tr_b16 v[18:19], v4 offset:25600
    ds_read_b128 v[12:15], v2 offset:16384
    ds_read_b64_tr_b16 v[24:25], v4 offset:26624
    ds_read_b64_tr_b16 v[26:27], v4 offset:27648
    ds_read_b128 v[20:23], v2 offset:17408
    ds_read_b64_tr_b16 v[32:33], v4 offset:28672
    ds_read_b64_tr_b16 v[34:35], v4 offset:29696
    ds_read_b128 v[28:31], v2 offset:18432
    ds_read_b64_tr_b16 v[40:41], v4 offset:30720
    ds_read_b64_tr_b16 v[42:43], v4 offset:31744
    ds_read_b128 v[36:39], v2 offset:19456
    v_mfma_f32_32x32x16_bf16 v[76:91], v[48:51], v[44:47], v[76:91]
    s_add_u32 m0, s44, 0
    s_nop 0
    buffer_load_dwordx4 v1, s[12:15], s46 offen offset:0 lds
    v_mfma_f32_32x32x16_bf16 v[76:91], v[56:59], v[52:55], v[76:91]
    buffer_load_dwordx4 v1, s[12:15], s46 offen offset:1024 lds
    s_add_u32 s46, s46, 4096
    s_cmp_eq_u32 s46, s60
    s_cselect_b32 s46, s62, s46
    v_mfma_f32_32x32x16_bf16 v[76:91], v[64:67], v[60:63], v[76:91]
    s_add_u32 m0, s45, 0
    s_nop 0
    buffer_load_dwordx4 v8, s[16:19], s47 offen offset:0 lds
    v_mfma_f32_32x32x16_bf16 v[76:91], v[72:75], v[68:71], v[76:91]
    buffer_load_dwordx4 v9, s[16:19], s47 offen offset:1024 lds
    s_add_u32 s47, s47, 65536
    s_cmp_eq_u32 s47, s61
    s_cselect_b32 s47, s63, s47
    s_waitcnt vmcnt(20) lgkmcnt(0)
    s_barrier
    ds_read_b64_tr_b16 v[48:49], v4 offset:40960
    ds_read_b64_tr_b16 v[50:51], v4 offset:41984
    ds_read_b128 v[44:47], v2 offset:32768
    ds_read_b64_tr_b16 v[56:57], v4 offset:43008
    ds_read_b64_tr_b16 v[58:59], v4 offset:44032
    ds_read_b128 v[52:55], v2 offset:33792
    ds_read_b64_tr_b16 v[64:65], v4 offset:45056
    ds_read_b64_tr_b16 v[66:67], v4 offset:46080
    ds_read_b128 v[60:63], v2 offset:34816
    ds_read_b64_tr_b16 v[72:73], v4 offset:47104
    ds_read_b64_tr_b16 v[74:75], v4 offset:48128
    ds_read_b128 v[68:71], v2 offset:35840
    v_mfma_f32_32x32x16_bf16 v[76:91], v[16:19], v[12:15], v[76:91]
    s_add_u32 m0, s44, 16384
    s_nop 0
    buffer_load_dwordx4 v1, s[12:15], s46 offen offset:0 lds
    v_mfma_f32_32x32x16_bf16 v[76:91], v[24:27], v[20:23], v[76:91]
    buffer_load_dwordx4 v1, s[12:15], s46 offen offset:1024 lds
    s_add_u32 s46, s46, 4096
    s_cmp_eq_u32 s46, s60
    s_cselect_b32 s46, s62, s46
    v_mfma_f32_32x32x16_bf16 v[76:91], v[32:35], v[28:31], v[76:91]
    s_add_u32 m0, s45, 16384
    s_nop 0
    buffer_load_dwordx4 v8, s[16:19], s47 offen offset:0 lds
    v_mfma_f32_32x32x16_bf16 v[76:91], v[40:43], v[36:39], v[76:91]
    buffer_load_dwordx4 v9, s[16:19], s47 offen offset:1024 lds
    s_add_u32 s47, s47, 65536
    s_cmp_eq_u32 s47, s61
    s_cselect_b32 s47, s63, s47
    s_waitcnt vmcnt(20) lgkmcnt(0)
    s_barrier
    ds_read_b64_tr_b16 v[16:17], v4 offset:57344
    ds_read_b64_tr_b16 v[18:19], v4 offset:58368
    ds_read_b128 v[12:15], v2 offset:49152
    ds_read_b64_tr_b16 v[24:25], v4 offset:59392
    ds_read_b64_tr_b16 v[26:27], v4 offset:60416
    ds_read_b128 v[20:23], v2 offset:50176
    ds_read_b64_tr_b16 v[32:33], v4 offset:61440
    ds_read_b64_tr_b16 v[34:35], v4 offset:62464
    ds_read_b128 v[28:31], v2 offset:51200
    ds_read_b64_tr_b16 v[40:41], v4 offset:63488
    ds_read_b64_tr_b16 v[42:43], v4 offset:64512
    ds_read_b128 v[36:39], v2 offset:52224
    v_mfma_f32_32x32x16_bf16 v[76:91], v[48:51], v[44:47], v[76:91]
    s_add_u32 m0, s44, 32768
    s_nop 0
    buffer_load_dwordx4 v1, s[12:15], s46 offen offset:0 lds
    v_mfma_f32_32x32x16_bf16 v[76:91], v[56:59], v[52:55], v[76:91]
    buffer_load_dwordx4 v1, s[12:15], s46 offen offset:1024 lds
    s_add_u32 s46, s46, 4096
    s_cmp_eq_u32 s46, s60
    s_cselect_b32 s46, s62, s46
    v_mfma_f32_32x32x16_bf16 v[76:91], v[64:67], v[60:63], v[76:91]
    s_add_u32 m0, s45, 32768
    s_nop 0
    buffer_load_dwordx4 v8, s[16:19], s47 offen offset:0 lds
    v_mfma_f32_32x32x16_bf16 v[76:91], v[72:75], v[68:71], v[76:91]
    buffer_load_dwordx4 v9, s[16:19], s47 offen offset:1024 lds
    s_add_u32 s47, s47, 65536
    s_cmp_eq_u32 s47, s61
    s_cselect_b32 s47, s63, s47
    s_waitcnt vmcnt(20) lgkmcnt(0)
    s_barrier
    ds_read_b64_tr_b16 v[48:49], v5 offset:8192
    ds_read_b64_tr_b16 v[50:51], v5 offset:9216
    ds_read_b128 v[44:47], v3 offset:0
    ds_read_b64_tr_b16 v[56:57], v5 offset:10240
    ds_read_b64_tr_b16 v[58:59], v5 offset:11264
    ds_read_b128 v[52:55], v3 offset:1024
    ds_read_b64_tr_b16 v[64:65], v5 offset:12288
    ds_read_b64_tr_b16 v[66:67], v5 offset:13312
    ds_read_b128 v[60:63], v3 offset:2048
    ds_read_b64_tr_b16 v[72:73], v5 offset:14336
    ds_read_b64_tr_b16 v[74:75], v5 offset:15360
    ds_read_b128 v[68:71], v3 offset:3072
    v_mfma_f32_32x32x16_bf16 v[76:91], v[16:19], v[12:15], v[76:91]
    s_add_u32 m0, s44, 49152
    s_nop 0
    buffer_load_dwordx4 v1, s[12:15], s46 offen offset:0 lds
    v_mfma_f32_32x32x16_bf16 v[76:91], v[24:27], v[20:23], v[76:91]
    buffer_load_dwordx4 v1, s[12:15], s46 offen offset:1024 lds
    s_add_u32 s46, s46, 4096
    s_cmp_eq_u32 s46, s60
    s_cselect_b32 s46, s62, s46
    v_mfma_f32_32x32x16_bf16 v[76:91], v[32:35], v[28:31], v[76:91]
    s_add_u32 m0, s45, 49152
    s_nop 0
    buffer_load_dwordx4 v8, s[16:19], s47 offen offset:0 lds
    v_mfma_f32_32x32x16_bf16 v[76:91], v[40:43], v[36:39], v[76:91]
    buffer_load_dwordx4 v9, s[16:19], s47 offen offset:1024 lds
    s_add_u32 s47, s47, 65536
    s_cmp_eq_u32 s47, s61
    s_cselect_b32 s47, s63, s47
    s_waitcnt vmcnt(20) lgkmcnt(0)
    s_barrier
    ds_read_b64_tr_b16 v[16:17], v5 offset:24576
    ds_read_b64_tr_b16 v[18:19], v5 offset:25600
    ds_read_b128 v[12:15], v3 offset:16384
    ds_read_b64_tr_b16 v[24:25], v5 offset:26624
    ds_read_b64_tr_b16 v[26:27], v5 offset:27648
    ds_read_b128 v[20:23], v3 offset:17408
    ds_read_b64_tr_b16 v[32:33], v5 offset:28672
    ds_read_b64_tr_b16 v[34:35], v5 offset:29696
    ds_read_b128 v[28:31], v3 offset:18432
    ds_read_b64_tr_b16 v[40:41], v5 offset:30720
    ds_read_b64_tr_b16 v[42:43], v5 offset:31744
    ds_read_b128 v[36:39], v3 offset:19456
    v_mfma_f32_32x32x16_bf16 v[76:91], v[48:51], v[44:47], v[76:91]
    s_add_u32 m0, s44, 65536
    s_nop 0
    buffer_load_dwordx4 v1, s[12:15], s46 offen offset:0 lds
    v_mfma_f32_32x32x16_bf16 v[76:91], v[56:59], v[52:55], v[76:91]
    buffer_load_dwordx4 v1, s[12:15], s46 offen offset:1024 lds
    s_add_u32 s46, s46, 4096
    s_cmp_eq_u32 s46, s60
    s_cselect_b32 s46, s62, s46
    v_mfma_f32_32x32x16_bf16 v[76:91], v[64:67], v[60:63], v[76:91]
    s_add_u32 m0, s45, 65536
    s_nop 0
    buffer_load_dwordx4 v8, s[16:19], s47 offen offset:0 lds
    v_mfma_f32_32x32x16_bf16 v[76:91], v[72:75], v[68:71], v[76:91]
    buffer_load_dwordx4 v9, s[16:19], s47 offen offset:1024 lds
    s_add_u32 s47, s47, 65536
    s_cmp_eq_u32 s47, s61
    s_cselect_b32 s47, s63, s47
    s_waitcnt vmcnt(20) lgkmcnt(0)
    s_barrier
    ds_read_b64_tr_b16 v[48:49], v5 offset:40960
    ds_read_b64_tr_b16 v[50:51], v5 offset:41984
    ds_read_b128 v[44:47], v3 offset:32768
    ds_read_b64_tr_b16 v[56:57], v5 offset:43008
    ds_read_b64_tr_b16 v[58:59], v5 offset:44032
    ds_read_b128 v[52:55], v3 offset:33792
    ds_read_b64_tr_b16 v[64:65], v5 offset:45056
    ds_read_b64_tr_b16 v[66:67], v5 offset:46080
    ds_read_b128 v[60:63], v3 offset:34816
    ds_read_b64_tr_b16 v[72:73], v5 offset:47104
    ds_read_b64_tr_b16 v[74:75], v5 offset:48128
    ds_read_b128 v[68:71], v3 offset:35840
    v_mfma_f32_32x32x16_bf16 v[76:91], v[16:19], v[12:15], v[76:91]
    s_add_u32 m0, s44, 81920
    s_nop 0
    buffer_load_dwordx4 v1, s[12:15], s46 offen offset:0 lds
    v_mfma_f32_32x32x16_bf16 v[76:91], v[24:27], v[20:23], v[76:91]
    buffer_load_dwordx4 v1, s[12:15], s46 offen offset:1024 lds
    s_add_u32 s46, s46, 4096
    s_cmp_eq_u32 s46, s60
    s_cselect_b32 s46, s62, s46
    v_mfma_f32_32x32x16_bf16 v[76:91], v[32:35], v[28:31], v[76:91]
    s_add_u32 m0, s45, 81920
    s_nop 0
    buffer_load_dwordx4 v8, s[16:19], s47 offen offset:0 lds
    v_mfma_f32_32x32x16_bf16 v[76:91], v[40:43], v[36:39], v[76:91]
    buffer_load_dwordx4 v9, s[16:19], s47 offen offset:1024 lds
    s_add_u32 s47, s47, 65536
    s_cmp_eq_u32 s47, s61
    s_cselect_b32 s47, s63, s47
    s_waitcnt vmcnt(20) lgkmcnt(0)
    s_barrier
    ds_read_b64_tr_b16 v[16:17], v4 offset:8192
    ds_read_b64_tr_b16 v[18:19], v4 offset:9216
    ds_read_b128 v[12:15], v2 offset:0
    ds_read_b64_tr_b16 v[24:25], v4 offset:10240
    ds_read_b64_tr_b16 v[26:27], v4 offset:11264
    ds_read_b128 v[20:23], v2 offset:1024
    ds_read_b64_tr_b16 v[32:33], v4 offset:12288
    ds_read_b64_tr_b16 v[34:35], v4 offset:13312
    ds_read_b128 v[28:31], v2 offset:2048
    ds_read_b64_tr_b16 v[40:41], v4 offset:14336
    ds_read_b64_tr_b16 v[42:43], v4 offset:15360
    ds_read_b128 v[36:39], v2 offset:3072
    v_mfma_f32_32x32x16_bf16 v[76:91], v[48:51], v[44:47], v[76:91]
    s_add_u32 m0, s44, 98304
    s_nop 0
    buffer_load_dwordx4 v1, s[12:15], s46 offen offset:0 lds
    v_mfma_f32_32x32x16_bf16 v[76:91], v[56:59], v[52:55], v[76:91]
    buffer_load_dwordx4 v1, s[12:15], s46 offen offset:1024 lds
    s_add_u32 s46, s46, 4096
    s_cmp_eq_u32 s46, s60
    s_cselect_b32 s46, s62, s46
    v_mfma_f32_32x32x16_bf16 v[76:91], v[64:67], v[60:63], v[76:91]
    s_add_u32 m0, s45, 98304
    s_nop 0
    buffer_load_dwordx4 v8, s[16:19], s47 offen offset:0 lds
    v_mfma_f32_32x32x16_bf16 v[76:91], v[72:75], v[68:71], v[76:91]
    buffer_load_dwordx4 v9, s[16:19], s47 offen offset:1024 lds
    s_add_u32 s47, s47, 65536
    s_cmp_eq_u32 s47, s61
    s_cselect_b32 s47, s63, s47
    s_waitcnt vmcnt(20) lgkmcnt(0)
    s_barrier
    ds_read_b64_tr_b16 v[48:49], v4 offset:24576
    ds_read_b64_tr_b16 v[50:51], v4 offset:25600
    ds_read_b128 v[44:47], v2 offset:16384
    ds_read_b64_tr_b16 v[56:57], v4 offset:26624
    ds_read_b64_tr_b16 v[58:59], v4 offset:27648
    ds_read_b128 v[52:55], v2 offset:17408
    ds_read_b64_tr_b16 v[64:65], v4 offset:28672
    ds_read_b64_tr_b16 v[66:67], v4 offset:29696
    ds_read_b128 v[60:63], v2 offset:18432
    ds_read_b64_tr_b16 v[72:73], v4 offset:30720
    ds_read_b64_tr_b16 v[74:75], v4 offset:31744
    ds_read_b128 v[68:71], v2 offset:19456
    v_mfma_f32_32x32x16_bf16 v[76:91], v[16:19], v[12:15], v[76:91]
    s_add_u32 m0, s44, 0
    s_nop 0
    buffer_load_dwordx4 v1, s[12:15], s46 offen offset:0 lds
    v_mfma_f32_32x32x16_bf16 v[76:91], v[24:27], v[20:23], v[76:91]
    buffer_load_dwordx4 v1, s[12:15], s46 offen offset:1024 lds
    s_add_u32 s46, s46, 4096
    s_cmp_eq_u32 s46, s60
    s_cselect_b32 s46, s62, s46
    v_mfma_f32_32x32x16_bf16 v[76:91], v[32:35], v[28:31], v[76:91]
    s_add_u32 m0, s45, 0
    s_nop 0
    buffer_load_dwordx4 v8, s[16:19], s47 offen offset:0 lds
    v_mfma_f32_32x32x16_bf16 v[76:91], v[40:43], v[36:39], v[76:91]
    buffer_load_dwordx4 v9, s[16:19], s47 offen offset:1024 lds
    s_add_u32 s47, s47, 65536
    s_cmp_eq_u32 s47, s61
    s_cselect_b32 s47, s63, s47
    s_waitcnt vmcnt(20) lgkmcnt(0)
    s_barrier
    ds_read_b64_tr_b16 v[16:17], v4 offset:40960
    ds_read_b64_tr_b16 v[18:19], v4 offset:41984
    ds_read_b128 v[12:15], v2 offset:32768
    ds_read_b64_tr_b16 v[24:25], v4 offset:43008
    ds_read_b64_tr_b16 v[26:27], v4 offset:44032
    ds_read_b128 v[20:23], v2 offset:33792
    ds_read_b64_tr_b16 v[32:33], v4 offset:45056
    ds_read_b64_tr_b16 v[34:35], v4 offset:46080
    ds_read_b128 v[28:31], v2 offset:34816
    ds_read_b64_tr_b16 v[40:41], v4 offset:47104
    ds_read_b64_tr_b16 v[42:43], v4 offset:48128
    ds_read_b128 v[36:39], v2 offset:35840
    v_mfma_f32_32x32x16_bf16 v[76:91], v[48:51], v[44:47], v[76:91]
    s_add_u32 m0, s44, 16384
    s_nop 0
    buffer_load_dwordx4 v1, s[12:15], s46 offen offset:0 lds
    v_mfma_f32_32x32x16_bf16 v[76:91], v[56:59], v[52:55], v[76:91]
    buffer_load_dwordx4 v1, s[12:15], s46 offen offset:1024 lds
    s_add_u32 s46, s46, 4096
    s_cmp_eq_u32 s46, s60
    s_cselect_b32 s46, s62, s46
    v_mfma_f32_32x32x16_bf16 v[76:91], v[64:67], v[60:63], v[76:91]
    s_add_u32 m0, s45, 16384
    s_nop 0
    buffer_load_dwordx4 v8, s[16:19], s47 offen offset:0 lds
    v_mfma_f32_32x32x16_bf16 v[76:91], v[72:75], v[68:71], v[76:91]
    buffer_load_dwordx4 v9, s[16:19], s47 offen offset:1024 lds
    s_add_u32 s47, s47, 65536
    s_cmp_eq_u32 s47, s61
    s_cselect_b32 s47, s63, s47
    s_waitcnt vmcnt(20) lgkmcnt(0)
    s_barrier
    ds_read_b64_tr_b16 v[48:49], v4 offset:57344
    ds_read_b64_tr_b16 v[50:51], v4 offset:58368
    ds_read_b128 v[44:47], v2 offset:49152
    ds_read_b64_tr_b16 v[56:57], v4 offset:59392
    ds_read_b64_tr_b16 v[58:59], v4 offset:60416
    ds_read_b128 v[52:55], v2 offset:50176
    ds_read_b64_tr_b16 v[64:65], v4 offset:61440
    ds_read_b64_tr_b16 v[66:67], v4 offset:62464
    ds_read_b128 v[60:63], v2 offset:51200
    ds_read_b64_tr_b16 v[72:73], v4 offset:63488
    ds_read_b64_tr_b16 v[74:75], v4 offset:64512
    ds_read_b128 v[68:71], v2 offset:52224
    v_mfma_f32_32x32x16_bf16 v[76:91], v[16:19], v[12:15], v[76:91]
    s_add_u32 m0, s44, 32768
    s_nop 0
    buffer_load_dwordx4 v1, s[12:15], s46 offen offset:0 lds
    v_mfma_f32_32x32x16_bf16 v[76:91], v[24:27], v[20:23], v[76:91]
    buffer_load_dwordx4 v1, s[12:15], s46 offen offset:1024 lds
    s_add_u32 s46, s46, 4096
    s_cmp_eq_u32 s46, s60
    s_cselect_b32 s46, s62, s46
    v_mfma_f32_32x32x16_bf16 v[76:91], v[32:35], v[28:31], v[76:91]
    s_add_u32 m0, s45, 32768
    s_nop 0
    buffer_load_dwordx4 v8, s[16:19], s47 offen offset:0 lds
    v_mfma_f32_32x32x16_bf16 v[76:91], v[40:43], v[36:39], v[76:91]
    buffer_load_dwordx4 v9, s[16:19], s47 offen offset:1024 lds
    s_add_u32 s47, s47, 65536
    s_cmp_eq_u32 s47, s61
    s_cselect_b32 s47, s63, s47
    s_waitcnt vmcnt(20) lgkmcnt(0)
    s_barrier
    ds_read_b64_tr_b16 v[16:17], v5 offset:8192
    ds_read_b64_tr_b16 v[18:19], v5 offset:9216
    ds_read_b128 v[12:15], v3 offset:0
    ds_read_b64_tr_b16 v[24:25], v5 offset:10240
    ds_read_b64_tr_b16 v[26:27], v5 offset:11264
    ds_read_b128 v[20:23], v3 offset:1024
    ds_read_b64_tr_b16 v[32:33], v5 offset:12288
    ds_read_b64_tr_b16 v[34:35], v5 offset:13312
    ds_read_b128 v[28:31], v3 offset:2048
    ds_read_b64_tr_b16 v[40:41], v5 offset:14336
    ds_read_b64_tr_b16 v[42:43], v5 offset:15360
    ds_read_b128 v[36:39], v3 offset:3072
    v_mfma_f32_32x32x16_bf16 v[76:91], v[48:51], v[44:47], v[76:91]
    s_add_u32 m0, s44, 49152
    s_nop 0
    buffer_load_dwordx4 v1, s[12:15], s46 offen offset:0 lds
    v_mfma_f32_32x32x16_bf16 v[76:91], v[56:59], v[52:55], v[76:91]
    buffer_load_dwordx4 v1, s[12:15], s46 offen offset:1024 lds
    s_add_u32 s46, s46, 4096
    s_cmp_eq_u32 s46, s60
    s_cselect_b32 s46, s62, s46
    v_mfma_f32_32x32x16_bf16 v[76:91], v[64:67], v[60:63], v[76:91]
    s_add_u32 m0, s45, 49152
    s_nop 0
    buffer_load_dwordx4 v8, s[16:19], s47 offen offset:0 lds
    v_mfma_f32_32x32x16_bf16 v[76:91], v[72:75], v[68:71], v[76:91]
    buffer_load_dwordx4 v9, s[16:19], s47 offen offset:1024 lds
    s_add_u32 s47, s47, 65536
    s_cmp_eq_u32 s47, s61
    s_cselect_b32 s47, s63, s47
    s_waitcnt vmcnt(20) lgkmcnt(0)
    s_barrier
    ds_read_b64_tr_b16 v[48:49], v5 offset:24576
    ds_read_b64_tr_b16 v[50:51], v5 offset:25600
    ds_read_b128 v[44:47], v3 offset:16384
    ds_read_b64_tr_b16 v[56:57], v5 offset:26624
    ds_read_b64_tr_b16 v[58:59], v5 offset:27648
    ds_read_b128 v[52:55], v3 offset:17408
    ds_read_b64_tr_b16 v[64:65], v5 offset:28672
    ds_read_b64_tr_b16 v[66:67], v5 offset:29696
    ds_read_b128 v[60:63], v3 offset:18432
    ds_read_b64_tr_b16 v[72:73], v5 offset:30720
    ds_read_b64_tr_b16 v[74:75], v5 offset:31744
    ds_read_b128 v[68:71], v3 offset:19456
    v_mfma_f32_32x32x16_bf16 v[76:91], v[16:19], v[12:15], v[76:91]
    s_add_u32 m0, s44, 65536
    s_nop 0
    buffer_load_dwordx4 v1, s[12:15], s46 offen offset:0 lds
    v_mfma_f32_32x32x16_bf16 v[76:91], v[24:27], v[20:23], v[76:91]
    buffer_load_dwordx4 v1, s[12:15], s46 offen offset:1024 lds
    s_add_u32 s46, s46, 4096
    s_cmp_eq_u32 s46, s60
    s_cselect_b32 s46, s62, s46
    v_mfma_f32_32x32x16_bf16 v[76:91], v[32:35], v[28:31], v[76:91]
    s_add_u32 m0, s45, 65536
    s_nop 0
    buffer_load_dwordx4 v8, s[16:19], s47 offen offset:0 lds
    v_mfma_f32_32x32x16_bf16 v[76:91], v[40:43], v[36:39], v[76:91]
    buffer_load_dwordx4 v9, s[16:19], s47 offen offset:1024 lds
    s_add_u32 s47, s47, 65536
    s_cmp_eq_u32 s47, s61
    s_cselect_b32 s47, s63, s47
    s_waitcnt vmcnt(20) lgkmcnt(0)
    s_barrier
    ds_read_b64_tr_b16 v[16:17], v5 offset:40960
    ds_read_b64_tr_b16 v[18:19], v5 offset:41984
    ds_read_b128 v[12:15], v3 offset:32768
    ds_read_b64_tr_b16 v[24:25], v5 offset:43008
    ds_read_b64_tr_b16 v[26:27], v5 offset:44032
    ds_read_b128 v[20:23], v3 offset:33792
    ds_read_b64_tr_b16 v[32:33], v5 offset:45056
    ds_read_b64_tr_b16 v[34:35], v5 offset:46080
    ds_read_b128 v[28:31], v3 offset:34816
    ds_read_b64_tr_b16 v[40:41], v5 offset:47104
    ds_read_b64_tr_b16 v[42:43], v5 offset:48128
    ds_read_b128 v[36:39], v3 offset:35840
    v_mfma_f32_32x32x16_bf16 v[76:91], v[48:51], v[44:47], v[76:91]
    s_add_u32 m0, s44, 81920
    s_nop 0
    buffer_load_dwordx4 v1, s[12:15], s46 offen offset:0 lds
    v_mfma_f32_32x32x16_bf16 v[76:91], v[56:59], v[52:55], v[76:91]
    buffer_load_dwordx4 v1, s[12:15], s46 offen offset:1024 lds
    s_add_u32 s46, s46, 4096
    s_cmp_eq_u32 s46, s60
    s_cselect_b32 s46, s62, s46
    v_mfma_f32_32x32x16_bf16 v[76:91], v[64:67], v[60:63], v[76:91]
    s_add_u32 m0, s45, 81920
    s_nop 0
    buffer_load_dwordx4 v8, s[16:19], s47 offen offset:0 lds
    v_mfma_f32_32x32x16_bf16 v[76:91], v[72:75], v[68:71], v[76:91]
    buffer_load_dwordx4 v9, s[16:19], s47 offen offset:1024 lds
    s_add_u32 s47, s47, 65536
    s_cmp_eq_u32 s47, s61
    s_cselect_b32 s47, s63, s47
    s_waitcnt vmcnt(20) lgkmcnt(0)
    s_barrier
    ds_read_b64_tr_b16 v[48:49], v4 offset:8192
    ds_read_b64_tr_b16 v[50:51], v4 offset:9216
    ds_read_b128 v[44:47], v2 offset:0
    ds_read_b64_tr_b16 v[56:57], v4 offset:10240
    ds_read_b64_tr_b16 v[58:59], v4 offset:11264
    ds_read_b128 v[52:55], v2 offset:1024
    ds_read_b64_tr_b16 v[64:65], v4 offset:12288
    ds_read_b64_tr_b16 v[66:67], v4 offset:13312
    ds_read_b128 v[60:63], v2 offset:2048
    ds_read_b64_tr_b16 v[72:73], v4 offset:14336
    ds_read_b64_tr_b16 v[74:75], v4 offset:15360
    ds_read_b128 v[68:71], v2 offset:3072
    v_mfma_f32_32x32x16_bf16 v[76:91], v[16:19], v[12:15], v[76:91]
    s_add_u32 m0, s44, 98304
    s_nop 0
    buffer_load_dwordx4 v1, s[12:15], s46 offen offset:0 lds
    v_mfma_f32_32x32x16_bf16 v[76:91], v[24:27], v[20:23], v[76:91]
    buffer_load_dwordx4 v1, s[12:15], s46 offen offset:1024 lds
    s_add_u32 s46, s46, 4096
    s_cmp_eq_u32 s46, s60
    s_cselect_b32 s46, s62, s46
    v_mfma_f32_32x32x16_bf16 v[76:91], v[32:35], v[28:31], v[76:91]
    s_add_u32 m0, s45, 98304
    s_nop 0
    buffer_load_dwordx4 v8, s[16:19], s47 offen offset:0 lds
    v_mfma_f32_32x32x16_bf16 v[76:91], v[40:43], v[36:39], v[76:91]
    buffer_load_dwordx4 v9, s[16:19], s47 offen offset:1024 lds
    s_add_u32 s47, s47, 65536
    s_cmp_eq_u32 s47, s61
    s_cselect_b32 s47, s63, s47
    s_waitcnt vmcnt(20) lgkmcnt(0)
    s_barrier
    ds_read_b64_tr_b16 v[16:17], v4 offset:24576
    ds_read_b64_tr_b16 v[18:19], v4 offset:25600
    ds_read_b128 v[12:15], v2 offset:16384
    ds_read_b64_tr_b16 v[24:25], v4 offset:26624
    ds_read_b64_tr_b16 v[26:27], v4 offset:27648
    ds_read_b128 v[20:23], v2 offset:17408
    ds_read_b64_tr_b16 v[32:33], v4 offset:28672
    ds_read_b64_tr_b16 v[34:35], v4 offset:29696
    ds_read_b128 v[28:31], v2 offset:18432
    ds_read_b64_tr_b16 v[40:41], v4 offset:30720
    ds_read_b64_tr_b16 v[42:43], v4 offset:31744
    ds_read_b128 v[36:39], v2 offset:19456
    v_mfma_f32_32x32x16_bf16 v[76:91], v[48:51], v[44:47], v[76:91]
    v_mfma_f32_32x32x16_bf16 v[76:91], v[56:59], v[52:55], v[76:91]
    v_mfma_f32_32x32x16_bf16 v[76:91], v[64:67], v[60:63], v[76:91]
    v_mfma_f32_32x32x16_bf16 v[76:91], v[72:75], v[68:71], v[76:91]
    s_waitcnt vmcnt(16) lgkmcnt(0)
    s_barrier
    ds_read_b64_tr_b16 v[48:49], v4 offset:40960
    ds_read_b64_tr_b16 v[50:51], v4 offset:41984
    ds_read_b128 v[44:47], v2 offset:32768
    ds_read_b64_tr_b16 v[56:57], v4 offset:43008
    ds_read_b64_tr_b16 v[58:59], v4 offset:44032
    ds_read_b128 v[52:55], v2 offset:33792
    ds_read_b64_tr_b16 v[64:65], v4 offset:45056
    ds_read_b64_tr_b16 v[66:67], v4 offset:46080
    ds_read_b128 v[60:63], v2 offset:34816
    ds_read_b64_tr_b16 v[72:73], v4 offset:47104
    ds_read_b64_tr_b16 v[74:75], v4 offset:48128
    ds_read_b128 v[68:71], v2 offset:35840
    v_mfma_f32_32x32x16_bf16 v[76:91], v[16:19], v[12:15], v[76:91]
    v_mfma_f32_32x32x16_bf16 v[76:91], v[24:27], v[20:23], v[76:91]
    v_mfma_f32_32x32x16_bf16 v[76:91], v[32:35], v[28:31], v[76:91]
    v_mfma_f32_32x32x16_bf16 v[76:91], v[40:43], v[36:39], v[76:91]
    s_waitcnt vmcnt(12) lgkmcnt(0)
    s_barrier
    ds_read_b64_tr_b16 v[16:17], v4 offset:57344
    ds_read_b64_tr_b16 v[18:19], v4 offset:58368
    ds_read_b128 v[12:15], v2 offset:49152
    ds_read_b64_tr_b16 v[24:25], v4 offset:59392
    ds_read_b64_tr_b16 v[26:27], v4 offset:60416
    ds_read_b128 v[20:23], v2 offset:50176
    ds_read_b64_tr_b16 v[32:33], v4 offset:61440
    ds_read_b64_tr_b16 v[34:35], v4 offset:62464
    ds_read_b128 v[28:31], v2 offset:51200
    ds_read_b64_tr_b16 v[40:41], v4 offset:63488
    ds_read_b64_tr_b16 v[42:43], v4 offset:64512
    ds_read_b128 v[36:39], v2 offset:52224
    v_mfma_f32_32x32x16_bf16 v[76:91], v[48:51], v[44:47], v[76:91]
    v_mfma_f32_32x32x16_bf16 v[76:91], v[56:59], v[52:55], v[76:91]
    v_mfma_f32_32x32x16_bf16 v[76:91], v[64:67], v[60:63], v[76:91]
    v_mfma_f32_32x32x16_bf16 v[76:91], v[72:75], v[68:71], v[76:91]
    s_waitcnt vmcnt(8) lgkmcnt(0)
    s_barrier
    ds_read_b64_tr_b16 v[48:49], v5 offset:8192
    ds_read_b64_tr_b16 v[50:51], v5 offset:9216
    ds_read_b128 v[44:47], v3 offset:0
    ds_read_b64_tr_b16 v[56:57], v5 offset:10240
    ds_read_b64_tr_b16 v[58:59], v5 offset:11264
    ds_read_b128 v[52:55], v3 offset:1024
    ds_read_b64_tr_b16 v[64:65], v5 offset:12288
    ds_read_b64_tr_b16 v[66:67], v5 offset:13312
    ds_read_b128 v[60:63], v3 offset:2048
    ds_read_b64_tr_b16 v[72:73], v5 offset:14336
    ds_read_b64_tr_b16 v[74:75], v5 offset:15360
    ds_read_b128 v[68:71], v3 offset:3072
    v_mfma_f32_32x32x16_bf16 v[76:91], v[16:19], v[12:15], v[76:91]
    v_mfma_f32_32x32x16_bf16 v[76:91], v[24:27], v[20:23], v[76:91]
    v_mfma_f32_32x32x16_bf16 v[76:91], v[32:35], v[28:31], v[76:91]
    v_mfma_f32_32x32x16_bf16 v[76:91], v[40:43], v[36:39], v[76:91]
    s_waitcnt vmcnt(4) lgkmcnt(0)
    s_barrier
    ds_read_b64_tr_b16 v[16:17], v5 offset:24576
    ds_read_b64_tr_b16 v[18:19], v5 offset:25600
    ds_read_b128 v[12:15], v3 offset:16384
    ds_read_b64_tr_b16 v[24:25], v5 offset:26624
    ds_read_b64_tr_b16 v[26:27], v5 offset:27648
    ds_read_b128 v[20:23], v3 offset:17408
    ds_read_b64_tr_b16 v[32:33], v5 offset:28672
    ds_read_b64_tr_b16 v[34:35], v5 offset:29696
    ds_read_b128 v[28:31], v3 offset:18432
    ds_read_b64_tr_b16 v[40:41], v5 offset:30720
    ds_read_b64_tr_b16 v[42:43], v5 offset:31744
    ds_read_b128 v[36:39], v3 offset:19456
    v_mfma_f32_32x32x16_bf16 v[76:91], v[48:51], v[44:47], v[76:91]
    v_mfma_f32_32x32x16_bf16 v[76:91], v[56:59], v[52:55], v[76:91]
    v_mfma_f32_32x32x16_bf16 v[76:91], v[64:67], v[60:63], v[76:91]
    v_mfma_f32_32x32x16_bf16 v[76:91], v[72:75], v[68:71], v[76:91]
    s_waitcnt vmcnt(0) lgkmcnt(0)
    s_barrier
    ds_read_b64_tr_b16 v[48:49], v5 offset:40960
    ds_read_b64_tr_b16 v[50:51], v5 offset:41984
    ds_read_b128 v[44:47], v3 offset:32768
    ds_read_b64_tr_b16 v[56:57], v5 offset:43008
    ds_read_b64_tr_b16 v[58:59], v5 offset:44032
    ds_read_b128 v[52:55], v3 offset:33792
    ds_read_b64_tr_b16 v[64:65], v5 offset:45056
    ds_read_b64_tr_b16 v[66:67], v5 offset:46080
    ds_read_b128 v[60:63], v3 offset:34816
    ds_read_b64_tr_b16 v[72:73], v5 offset:47104
    ds_read_b64_tr_b16 v[74:75], v5 offset:48128
    ds_read_b128 v[68:71], v3 offset:35840
    v_mfma_f32_32x32x16_bf16 v[76:91], v[16:19], v[12:15], v[76:91]
    v_mfma_f32_32x32x16_bf16 v[76:91], v[24:27], v[20:23], v[76:91]
    v_mfma_f32_32x32x16_bf16 v[76:91], v[32:35], v[28:31], v[76:91]
    v_mfma_f32_32x32x16_bf16 v[76:91], v[40:43], v[36:39], v[76:91]
    s_waitcnt lgkmcnt(0)
    v_mfma_f32_32x32x16_bf16 v[76:91], v[48:51], v[44:47], v[76:91]
    v_mfma_f32_32x32x16_bf16 v[76:91], v[56:59], v[52:55], v[76:91]
    v_mfma_f32_32x32x16_bf16 v[76:91], v[64:67], v[60:63], v[76:91]
    v_mfma_f32_32x32x16_bf16 v[76:91], v[72:75], v[68:71], v[76:91]
    s_nop 7
    s_nop 7
    v_and_b32 v13, 0xffff0000, v92
    v_lshlrev_b32 v12, 16, v92
    v_and_b32 v15, 0xffff0000, v93
    v_lshlrev_b32 v14, 16, v93
    v_and_b32 v17, 0xffff0000, v94
    v_lshlrev_b32 v16, 16, v94
    v_and_b32 v19, 0xffff0000, v95
    v_lshlrev_b32 v18, 16, v95
    v_and_b32 v21, 0xffff0000, v96
    v_lshlrev_b32 v20, 16, v96
    v_and_b32 v23, 0xffff0000, v97
    v_lshlrev_b32 v22, 16, v97
    v_and_b32 v25, 0xffff0000, v98
    v_lshlrev_b32 v24, 16, v98
    v_and_b32 v27, 0xffff0000, v99
    v_lshlrev_b32 v26, 16, v99
    v_fmac_f32 v12, v76, v100
    v_fmac_f32 v13, v77, v101
    v_fmac_f32 v14, v78, v102
    v_fmac_f32 v15, v79, v103
    v_fmac_f32 v16, v80, v104
    v_fmac_f32 v17, v81, v105
    v_fmac_f32 v18, v82, v106
    v_fmac_f32 v19, v83, v107
    v_fmac_f32 v20, v84, v108
    v_fmac_f32 v21, v85, v109
    v_fmac_f32 v22, v86, v110
    v_fmac_f32 v23, v87, v111
    v_fmac_f32 v24, v88, v112
    v_fmac_f32 v25, v89, v113
    v_fmac_f32 v26, v90, v114
    v_fmac_f32 v27, v91, v115
    v_cvt_pk_bf16_f32 v92, v12, v13
    v_cvt_pk_bf16_f32 v93, v14, v15
    v_cvt_pk_bf16_f32 v94, v16, v17
    v_cvt_pk_bf16_f32 v95, v18, v19
    v_cvt_pk_bf16_f32 v96, v20, v21
    v_cvt_pk_bf16_f32 v97, v22, v23
    v_cvt_pk_bf16_f32 v98, v24, v25
    v_cvt_pk_bf16_f32 v99, v26, v27
    s_nop 1
    v_permlane32_swap_b32 v92, v94
    v_permlane32_swap_b32 v93, v95
    v_permlane32_swap_b32 v96, v98
    v_permlane32_swap_b32 v97, v99
    s_nop 1
    buffer_store_dwordx4 v[92:95], v10, s[20:23], s38 offen
    buffer_store_dwordx4 v[96:99], v10, s[20:23], s38 offen offset:32
dn_end:
    s_endpgm
code_end:
.section .rodata,"a"
.p2align 6
.amdhsa_kernel prep_kernel
  .amdhsa_next_free_vgpr 96
  .amdhsa_next_free_sgpr 48
  .amdhsa_accum_offset 96
  .amdhsa_group_segment_fixed_size 0
  .amdhsa_kernarg_size 120
  .amdhsa_user_sgpr_count 2
  .amdhsa_user_sgpr_kernarg_segment_ptr 1
  .amdhsa_system_sgpr_workgroup_id_x 1
.end_amdhsa_kernel
.section .rodata,"a"
.p2align 6
.amdhsa_kernel kv_kernel
  .amdhsa_next_free_vgpr 248
  .amdhsa_next_free_sgpr 102
  .amdhsa_accum_offset 248
  .amdhsa_group_segment_fixed_size 0
  .amdhsa_kernarg_size 120
  .amdhsa_user_sgpr_count 2
  .amdhsa_user_sgpr_kernarg_segment_ptr 1
  .amdhsa_system_sgpr_workgroup_id_x 1
.end_amdhsa_kernel
.section .rodata,"a"
.p2align 6
.amdhsa_kernel attn_kernel
  .amdhsa_next_free_vgpr 240
  .amdhsa_next_free_sgpr 102
  .amdhsa_accum_offset 240
  .amdhsa_group_segment_fixed_size 0
  .amdhsa_kernarg_size 120
  .amdhsa_user_sgpr_count 2
  .amdhsa_user_sgpr_kernarg_segment_ptr 1
  .amdhsa_system_sgpr_workgroup_id_x 1
.end_amdhsa_kernel
.section .rodata,"a"
.p2align 6
.amdhsa_kernel op_kernel
  .amdhsa_next_free_vgpr 92
  .amdhsa_next_free_sgpr 102
  .amdhsa_accum_offset 92
  .amdhsa_group_segment_fixed_size 0
  .amdhsa_kernarg_size 120
  .amdhsa_user_sgpr_count 2
  .amdhsa_user_sgpr_kernarg_segment_ptr 1
  .amdhsa_system_sgpr_workgroup_id_x 1
.end_amdhsa_kernel
.section .rodata,"a"
.p2align 6
.amdhsa_kernel ln2_kernel
  .amdhsa_next_free_vgpr 128
  .amdhsa_next_free_sgpr 40
  .amdhsa_accum_offset 128
  .amdhsa_group_segment_fixed_size 0
  .amdhsa_kernarg_size 120
  .amdhsa_user_sgpr_count 2
  .amdhsa_user_sgpr_kernarg_segment_ptr 1
  .amdhsa_system_sgpr_workgroup_id_x 1
.end_amdhsa_kernel
.section .rodata,"a"
.p2align 6
.amdhsa_kernel gu_kernel
  .amdhsa_next_free_vgpr 108
  .amdhsa_next_free_sgpr 102
  .amdhsa_accum_offset 108
  .amdhsa_group_segment_fixed_size 0
  .amdhsa_kernarg_size 120
  .amdhsa_user_sgpr_count 2
  .amdhsa_user_sgpr_kernarg_segment_ptr 1
  .amdhsa_system_sgpr_workgroup_id_x 1
.end_amdhsa_kernel
.section .rodata,"a"
.p2align 6
.amdhsa_kernel dn_kernel
  .amdhsa_next_free_vgpr 116
  .amdhsa_next_free_sgpr 102
  .amdhsa_accum_offset 116
  .amdhsa_group_segment_fixed_size 0
  .amdhsa_kernarg_size 120
  .amdhsa_user_sgpr_count 2
  .amdhsa_user_sgpr_kernarg_segment_ptr 1
  .amdhsa_system_sgpr_workgroup_id_x 1
.end_amdhsa_kernel
```
